```python
import torch

def _softmax(x, axis=-1):
    return torch.softmax(x, dim=axis)
def _gelu(x):
    return torch.nn.functional.gelu(x, approximate="tanh")
def _silu(x):
    return torch.nn.functional.silu(x)
def _sigmoid(x):
    return torch.sigmoid(x)
def _layernorm(x, axis=-1, eps=1e-5):
    m = x.mean(dim=axis, keepdim=True)
    v = x.var(dim=axis, keepdim=True, unbiased=False)
    return (x - m) / torch.sqrt(v + eps)
def _scatter_add(tgt, idx, src, axis=0):
    return tgt.clone().index_add_(axis, idx, src)
def _segment_sum(src, seg, n):
    out = torch.zeros((n,) + src.shape[1:], dtype=src.dtype)
    return out.index_add_(0, seg, src)
def _pad(x, pw):
    flat = tuple(v for pair in reversed(pw) for v in pair)
    return torch.nn.functional.pad(x, flat)

kernel_name = 'interleave_layers__ssm_conv_h3__linear_kernel_hedgehog__prompt'

def setup_inputs():

    _w = (lambda a: (lambda t: t.to(torch.bfloat16) if t.is_floating_point() else t)(torch.as_tensor(a)))
    def _A_setup():
        B, S, D = 1, 2048, 576
        ks = 4
        return {
            "q": _w((lambda *s: torch.randn(*s, dtype=torch.bfloat16) * 0.05)(B, S, D)),
            "k": _w((lambda *s: torch.randn(*s, dtype=torch.bfloat16) * 0.8)(B, S, D)),
            "v": _w((lambda *s: torch.randn(*s, dtype=torch.bfloat16) * 0.8)(B, S, D)),
            "shift_k": _w((lambda *s: torch.randn(*s, dtype=torch.bfloat16) * 0.8)(D, ks) * 0.5),
            "ssm_k": _w((lambda *s: torch.randn(*s, dtype=torch.bfloat16) * 0.8)(D, S) * (1.0 / S ** 0.5)),
            "ssm_D": _w((lambda *s: torch.randn(*s, dtype=torch.bfloat16) * 0.8)(D)),
        }
    _A_in = _A_setup()

    def _B_setup():
        B, S, D, H = 1, 2048, 576, 32
        Dh = D // H
        return {
            "x": _w((lambda *s: torch.randn(*s, dtype=torch.bfloat16) * 0.05)(B, S, D)),
            "wqkv": _w((lambda *s: torch.randn(*s, dtype=torch.bfloat16) * 0.4)(D, 3 * D)),
            "w_phi": _w((lambda *s: torch.randn(*s, dtype=torch.bfloat16) * 0.4)(H, Dh, Dh) * (Dh ** -0.5)),
            "wo": _w((lambda *s: torch.randn(*s, dtype=torch.bfloat16) * 0.2)(D, D)),
        }
    _B_in = _B_setup()

    return {
        "A_q": _A_in["q"],
        "A_k": _A_in["k"],
        "A_v": _A_in["v"],
        "A_shift_k": _A_in["shift_k"],
        "A_ssm_k": _A_in["ssm_k"],
        "A_ssm_D": _A_in["ssm_D"],
        "B_x": _B_in["x"],
        "B_wqkv": _B_in["wqkv"],
        "B_w_phi": _B_in["w_phi"],
        "B_wo": _B_in["wo"],
    }

def reference(A_q, A_k, A_v, A_shift_k, A_ssm_k, A_ssm_D, B_x, B_wqkv, B_w_phi, B_wo):
    def _A_ref(q, k, v, shift_k, ssm_k, ssm_D):
        B, S, D = q.shape
        ks = shift_k.shape[-1]
        k_pad = _pad(k, ((0, 0), (ks - 1, 0), (0, 0)))
        k_shift = torch.zeros_like(k)
        for t in range(ks):
            k_shift = k_shift + k_pad[:, t:t + S, :] * shift_k[:, ks - 1 - t][None, None, :]
        kv = k_shift * v
        L = 2 * S
        kv_pad = _pad(kv, ((0, 0), (0, S), (0, 0)))
        kf_pad = _pad(ssm_k, ((0, 0), (0, S)))
        kv_f = (lambda x, axes=(-2,-1): torch.fft.rfft2(x.float(), dim=axes))(kv_pad[:, None, :, :], axes=(1, 2))
        kf_f = (lambda x, axes=(-2,-1): torch.fft.rfft2(x.float(), dim=axes))(kf_pad[:, None, :], axes=(1, 2))
        kf_f = (lambda x, *d: x.permute(*d))(kf_f, 1, 2, 0)
        y_f = kv_f * kf_f[None, :, :, :]
        y = (lambda x, s, axes=(-2,-1): torch.fft.irfft2(x, s=s, dim=axes).to(torch.bfloat16))(y_f, (1, L), axes=(1, 2))[:, 0, :S, :]
        y = y + kv * ssm_D[None, None, :]
        return q * y

    def _B_ref(x, wqkv, w_phi, wo):
        B, S, D = x.shape
        H = 32; Dh = D // H
        qkv = (lambda x, *d: x.permute(*d))((x @ wqkv).reshape(B, S, 3, H, Dh), 2, 0, 3, 1, 4)
        q, k, v = qkv[0], qkv[1], qkv[2]
        pq = torch.einsum("bhsd,hdf->bhsf", q, w_phi)
        pk = torch.einsum("bhsd,hdf->bhsf", k, w_phi)
        phi_q = torch.concatenate([_softmax(pq, axis=-1), _softmax(-pq, axis=-1)], axis=-1)
        phi_k = torch.concatenate([_softmax(pk, axis=-1), _softmax(-pk, axis=-1)], axis=-1)
        kv = torch.einsum("bhsf,bhsd->bhfd", phi_k, v)
        z  = torch.einsum("bhsf->bhf", phi_k)
        num = torch.einsum("bhqf,bhfd->bhqd", phi_q, kv)
        den = torch.einsum("bhqf,bhf->bhq", phi_q, z)[..., None] + 1e-6
        o = num / den
        return (lambda x, *d: x.permute(*d))(o, 0, 2, 1, 3).reshape(B, S, D) @ wo

    x = A_q
    x = x + _A_ref(_layernorm(x, axis=-1), A_k, A_v, A_shift_k, A_ssm_k, A_ssm_D)
    x = x + _B_ref(_layernorm(x, axis=-1), B_wqkv, B_w_phi, B_wo)
    x = x + _A_ref(_layernorm(x, axis=-1), A_k, A_v, A_shift_k, A_ssm_k, A_ssm_D)
    x = x + _B_ref(_layernorm(x, axis=-1), B_wqkv, B_w_phi, B_wo)
    return x
```

```asm
; @launch grid=(256,1,1) block=(256,1,1) lds=163840
.amdgcn_target "amdgcn-amd-amdhsa--gfx950"
.text
.globl interleave_layers__ssm_conv_h3__linear_kernel_hedgehog__prompt_kernel
.p2align 8
.type interleave_layers__ssm_conv_h3__linear_kernel_hedgehog__prompt_kernel,@function
interleave_layers__ssm_conv_h3__linear_kernel_hedgehog__prompt_kernel:
s_cmp_ge_u32 s2, 256
s_cbranch_scc1 L_end
s_load_dwordx16 s[8:23], s[0:1], 0
s_load_dwordx8 s[24:31], s[0:1], 64
s_load_dwordx2 s[32:33], s[0:1], 96
s_getpc_b64 s[86:87]
Lpc0:
s_sub_u32 s86, s86, Lpc0-interleave_layers__ssm_conv_h3__linear_kernel_hedgehog__prompt_kernel
s_subb_u32 s87, s87, 0
s_lshr_b32 s67, s2, 3
s_mul_i32 s67, s67, 1536
v_lshl_add_u32 v8, v0, 7, s67
v_min_u32 v8, L_code_end-interleave_layers__ssm_conv_h3__linear_kernel_hedgehog__prompt_kernel-4, v8
v_cmp_gt_u32 vcc, 12, v0
s_and_saveexec_b64 s[64:65], vcc
s_cbranch_execz Lpc1
global_load_dword v222, v8, s[86:87]
Lpc1:
s_mov_b64 exec, s[64:65]
v_and_b32 v1, 63, v0
v_lshrrev_b32 v2, 6, v0
s_and_b32 s56, s2, 7
v_readfirstlane_b32 s61, v2
s_lshr_b32 s57, s2, 3
s_and_b32 s59, s57, 7
s_lshr_b32 s60, s57, 3
s_lshl_b32 s58, s56, 2
s_add_u32 s58, s58, s60
v_add_u32 v5, 0, v0
v_mul_u32_u24 v6, 7282, v5
v_lshrrev_b32 v6, 16, v6
v_mul_u32_u24 v7, 9, v6
v_sub_u32 v7, v5, v7
v_mul_u32_u24 v6, 1152, v6
v_lshl_add_u32 v2, v7, 4, v6
v_add_u32 v5, 256, v0
v_mul_u32_u24 v6, 7282, v5
v_lshrrev_b32 v6, 16, v6
v_mul_u32_u24 v7, 9, v6
v_sub_u32 v7, v5, v7
v_mul_u32_u24 v6, 1152, v6
v_lshl_add_u32 v3, v7, 4, v6
v_add_u32 v5, 512, v0
v_mul_u32_u24 v6, 7282, v5
v_lshrrev_b32 v6, 16, v6
v_mul_u32_u24 v7, 9, v6
v_sub_u32 v7, v5, v7
v_mul_u32_u24 v6, 1152, v6
v_lshl_add_u32 v4, v7, 4, v6
s_mul_i32 s66, s57, 73728
s_mul_i32 s67, s56, 144
s_add_u32 s66, s66, s67
s_sub_u32 s68, s66, 4608
v_add_u32 v6, s68, v2
v_add_u32 v7, s68, v3
v_add_u32 v8, s68, v4
s_lshl_b32 s95, s61, 10
s_waitcnt lgkmcnt(0)
s_add_u32 s4, s32, 0
s_addc_u32 s5, s33, 0
s_mov_b32 s6, 18612224
s_mov_b32 s7, 0x20000
s_mov_b32 s36, s10
s_mov_b32 s37, s11
s_mov_b32 s38, 2359296
s_mov_b32 s39, 0x20000
s_mov_b32 s40, s12
s_mov_b32 s41, s13
s_mov_b32 s42, 2359296
s_mov_b32 s43, 0x20000
s_add_u32 m0, s95, 0
s_nop 0
buffer_load_dwordx4 v6, s[36:39], 0 offen lds
s_add_u32 m0, s95, 10240
s_nop 0
buffer_load_dwordx4 v2, s[40:43], s66 offen lds
s_add_u32 m0, s95, 4096
s_nop 0
buffer_load_dwordx4 v7, s[36:39], 0 offen lds
s_add_u32 m0, s95, 14336
s_nop 0
buffer_load_dwordx4 v3, s[40:43], s66 offen lds
s_cmp_ge_u32 s61, 2
s_cbranch_scc1 t3_1
s_add_u32 m0, s95, 8192
s_nop 0
buffer_load_dwordx4 v8, s[36:39], 0 offen lds
s_cmp_ge_u32 s61, 1
s_cbranch_scc1 t3_1
s_mov_b32 m0, 18432
s_nop 0
buffer_load_dwordx4 v4, s[40:43], s66 offen lds
t3_1:
s_mov_b32 s48, s14
s_mov_b32 s49, s15
s_mov_b32 s50, 4608
s_mov_b32 s51, 0x20000
s_mov_b32 s63, 0xffff0000
s_mov_b32 s76, 0x0033ffff
s_mov_b32 s77, 0x0033ffff
s_mov_b32 s78, 0x00ffffff
s_mov_b32 s79, 0x00ffffff
s_mov_b32 s82, 0x3f80
s_mov_b32 s83, 0x3f800000
s_mov_b32 s84, 0x3f803f80
s_cmp_eq_u32 s61, 2
s_cselect_b64 s[80:81], -1, 0
v_and_b32 v40, 15, v1
v_lshrrev_b32 v41, 4, v1
v_and_b32 v42, 3, v1
v_bfe_u32 v43, v1, 2, 2
v_lshl_add_u32 v43, v41, 3, v43
s_mul_i32 s69, s56, 72
s_lshl_b32 s70, s57, 6
s_cmp_eq_u32 s61, 2
s_cselect_b32 s67, 0, s95
s_cselect_b32 s68, 48, 0
s_cbranch_scc0 Lu0
s_lshl_b32 s67, s67, 5
Lu0:
s_lshr_b32 s67, s67, 5
v_add_u32 v44, s67, v43
v_lshl_add_u32 v45, v42, 2, s68
v_lshl_add_u32 v46, v41, 3, s67
v_add_u32 v47, s68, v40
v_add_u32 v47, s69, v47
v_lshlrev_b32 v5, 3, v47
buffer_load_dwordx2 v[26:27], v5, s[48:51], 0 offen
v_mul_u32_u24 v44, 144, v44
v_lshl_add_u32 v32, v45, 1, v44
v_add_u32 v46, s70, v46
v_sub_u32 v46, 2040, v46
v_lshlrev_b32 v46, 1, v46
v_lshl_add_u32 v36, v47, 12, v46
s_cmp_eq_u32 s61, 2
s_cselect_b32 s67, 32, s95
s_cselect_b32 s68, 48, 16
s_cbranch_scc0 Lu1
s_lshl_b32 s67, s67, 5
Lu1:
s_lshr_b32 s67, s67, 5
v_add_u32 v44, s67, v43
v_lshl_add_u32 v45, v42, 2, s68
v_lshl_add_u32 v46, v41, 3, s67
v_add_u32 v47, s68, v40
v_add_u32 v47, s69, v47
v_lshlrev_b32 v5, 3, v47
buffer_load_dwordx2 v[28:29], v5, s[48:51], 0 offen
v_mul_u32_u24 v44, 144, v44
v_lshl_add_u32 v33, v45, 1, v44
v_add_u32 v46, s70, v46
v_sub_u32 v46, 2040, v46
v_lshlrev_b32 v46, 1, v46
v_lshl_add_u32 v37, v47, 12, v46
s_cmp_eq_u32 s61, 2
s_cselect_b32 s67, 64, s95
s_cselect_b32 s68, 48, 32
s_cbranch_scc0 Lu2
s_lshl_b32 s67, s67, 5
Lu2:
s_lshr_b32 s67, s67, 5
v_lshrrev_b32 v5, 1, v42
v_lshlrev_b32 v5, 5, v5
v_mov_b32 v6, s67
v_cndmask_b32 v5, v6, v5, s[80:81]
v_add_u32 v44, v5, v43
v_and_b32 v5, 1, v42
v_lshl_add_u32 v5, v5, 2, 64
v_lshl_add_u32 v45, v42, 2, 32
v_cndmask_b32 v45, v45, v5, s[80:81]
v_lshrrev_b32 v5, 3, v40
v_lshlrev_b32 v5, 5, v5
v_cndmask_b32 v5, v6, v5, s[80:81]
v_lshl_add_u32 v46, v41, 3, v5
v_and_b32 v5, 7, v40
v_add_u32 v5, 64, v5
v_add_u32 v47, 32, v40
v_cndmask_b32 v47, v47, v5, s[80:81]
v_add_u32 v47, s69, v47
v_lshlrev_b32 v5, 3, v47
buffer_load_dwordx2 v[30:31], v5, s[48:51], 0 offen
v_mul_u32_u24 v44, 144, v44
v_lshl_add_u32 v34, v45, 1, v44
v_add_u32 v46, s70, v46
v_sub_u32 v46, 2040, v46
v_lshlrev_b32 v46, 1, v46
v_lshl_add_u32 v38, v47, 12, v46
buffer_load_dword v9, off, s[4:7], 0 sc1
v_lshlrev_b32 v6, 2, v1
v_add_u32 v6, 157696, v6
v_mov_b32 v7, 0
ds_write_b32 v6, v7
s_waitcnt lgkmcnt(0)
s_barrier
s_mov_b32 s36, s16
s_mov_b32 s37, s17
s_mov_b32 s38, 2359296
s_mov_b32 s39, 0x20000
s_mov_b32 s40, s18
s_mov_b32 s41, s19
s_mov_b32 s42, 1152
s_mov_b32 s43, 0x20000
s_lshl_b32 s67, s61, 5
s_add_u32 s67, s67, s57
s_add_u32 s72, s69, s67
s_mul_i32 s73, s61, 21248
s_add_u32 s73, s73, 73728
v_lshlrev_b32 v14, 4, v1
s_cmp_ge_u32 s67, 72
s_cselect_b32 s85, 0, 1
v_mov_b32 v216, 0x40000000
v_mov_b32 v217, 0x40000000
v_mov_b32 v218, 0x40000000
v_mov_b32 v219, 0x40000000
s_cmp_eq_u32 s85, 0
s_cbranch_scc1 nc_3
v_and_b32 v5, 15, v1
s_lshl_b32 s67, s61, 4
v_add_u32 v7, s67, v5
v_lshrrev_b32 v5, 4, v1
v_lshlrev_b32 v13, 3, v7
v_lshl_add_u32 v13, v5, 2, v13
v_and_b32 v7, 31, v7
v_lshlrev_b32 v7, 4, v7
s_lshr_b32 s67, s61, 1
s_mul_i32 s67, s67, 36864
v_add_u32 v7, s67, v7
v_lshl_add_u32 v12, v5, 9, v7
s_lshl_b32 s74, s59, 2
s_add_u32 s74, s74, s61
s_mul_i32 s93, s74, 73728
s_add_u32 s93, s93, 11534336
s_mul_i32 s94, s58, 73728
s_add_u32 s94, s94, 6815744
s_lshl_b32 s98, s58, 10
s_add_u32 s98, s98, 65536
s_lshl_b32 s99, s56, 3
s_add_u32 s99, s99, s59
s_lshl_b32 s99, s99, 2
v_mov_b32 v160, 0x40000000
v_mov_b32 v214, v160
v_mov_b32 v212, 0
v_mov_b32 v213, 0
v_cndmask_b32 v15, v160, v14, s[78:79]
v_bfe_u32 v5, v1, 3, 2
v_and_b32 v6, 3, v1
v_lshl_add_u32 v190, v5, 2, v6
v_bfe_u32 v191, v1, 2, 1
v_mul_u32_u24 v5, 9, v191
v_add_u32 v5, v5, v190
s_mul_i32 s66, s61, 648
s_add_u32 s66, s66, 32768
v_lshl_add_u32 v161, v5, 1, s66
v_lshrrev_b32 v7, 5, v1
v_mul_u32_u24 v8, 288, v7
v_add_u32 v162, v161, v8
v_bfe_u32 v8, v1, 4, 1
v_lshl_add_u32 v8, v8, 1, v191
v_lshl_add_u32 v6, v8, 3, v6
v_bfe_u32 v8, v1, 3, 1
v_lshl_add_u32 v6, v8, 2, v6
v_mul_u32_u24 v6, 144, v6
s_mul_i32 s66, s61, 36
s_add_u32 s66, s66, 40960
v_add_u32 v163, s66, v6
v_lshl_add_u32 v164, v7, 4, v163
v_lshl_add_u32 v8, v7, 5, s58
v_and_b32 v6, 31, v1
v_lshlrev_b32 v6, 4, v6
v_lshrrev_b32 v167, 1, v8
v_lshl_add_u32 v6, v167, 10, v6
v_and_b32 v8, 1, v8
v_lshl_add_u32 v167, v8, 9, v6
v_lshlrev_b32 v7, 3, v7
v_sub_u32 v5, v5, v7
v_mov_b32 v7, -64
v_add_u32 v8, -9, v5
v_cmp_gt_u32 vcc, 9, v190
s_nop 1
v_cndmask_b32 v8, v8, v7, vcc
v_and_b32 v168, 1, v8
v_cmp_eq_u32 vcc, 1, v168
v_mov_b32 v168, s82
v_mov_b32 v169, s83
v_cndmask_b32 v168, v168, v169, vcc
v_ashrrev_i32 v169, 1, v8
v_cmp_eq_u32 vcc, 0, v169
s_nop 1
v_cndmask_b32 v174, 0, v168, vcc
v_cmp_eq_u32 vcc, 1, v169
s_nop 1
v_cndmask_b32 v175, 0, v168, vcc
v_cmp_eq_u32 vcc, 2, v169
s_nop 1
v_cndmask_b32 v176, 0, v168, vcc
v_cmp_eq_u32 vcc, 3, v169
s_nop 1
v_cndmask_b32 v177, 0, v168, vcc
v_add_u32 v8, -2, v5
v_add_u32 v6, -9, v190
v_cmp_lt_u32 vcc, 1, v6
s_nop 1
v_cndmask_b32 v8, v8, v7, vcc
v_and_b32 v168, 1, v8
v_cmp_eq_u32 vcc, 1, v168
v_mov_b32 v168, s82
v_mov_b32 v169, s83
v_cndmask_b32 v168, v168, v169, vcc
v_ashrrev_i32 v169, 1, v8
v_cmp_eq_u32 vcc, 0, v169
s_nop 1
v_cndmask_b32 v178, 0, v168, vcc
v_cmp_eq_u32 vcc, 1, v169
s_nop 1
v_cndmask_b32 v179, 0, v168, vcc
v_cmp_eq_u32 vcc, 2, v169
s_nop 1
v_cndmask_b32 v180, 0, v168, vcc
v_cmp_eq_u32 vcc, 3, v169
s_nop 1
v_cndmask_b32 v181, 0, v168, vcc
v_add_u32 v8, -16, v8
v_cmp_gt_u32 vcc, 32, v1
s_nop 1
v_cndmask_b32 v8, v7, v8, vcc
v_and_b32 v168, 1, v8
v_cmp_eq_u32 vcc, 1, v168
v_mov_b32 v168, s82
v_mov_b32 v169, s83
v_cndmask_b32 v168, v168, v169, vcc
v_ashrrev_i32 v169, 1, v8
v_cmp_eq_u32 vcc, 0, v169
s_nop 1
v_cndmask_b32 v182, 0, v168, vcc
v_cmp_eq_u32 vcc, 1, v169
s_nop 1
v_cndmask_b32 v183, 0, v168, vcc
v_cmp_eq_u32 vcc, 2, v169
s_nop 1
v_cndmask_b32 v184, 0, v168, vcc
v_cmp_eq_u32 vcc, 3, v169
s_nop 1
v_cndmask_b32 v185, 0, v168, vcc
v_mov_b32 v188, v182
v_mov_b32 v182, 0
v_mov_b32 v187, 0
v_mov_b32 v189, 0
v_mov_b32 v207, 0
v_add_u32 v165, 4096, v164
v_add_u32 v166, 8192, v164
v_and_b32 v216, 15, v1
v_lshrrev_b32 v217, 4, v1
v_add_u32 v218, 1, v216
v_and_b32 v219, 3, v218
v_mul_u32_u24 v219, 4160, v219
v_lshrrev_b32 v218, 2, v218
v_lshl_add_u32 v219, v218, 3, v219
v_lshl_add_u32 v219, v217, 4, v219
v_add_u32 v212, s73, v219
v_lshlrev_b32 v218, 5, v216
v_lshlrev_b32 v219, 4, v217
v_sub_u32 v219, v219, v218
s_add_u32 s71, s73, 17120
v_add_u32 v213, s71, v219
v_and_b32 v218, 1, v217
v_lshlrev_b32 v218, 2, v218
v_lshrrev_b32 v219, 2, v216
v_add_u32 v218, v218, v219
v_mul_u32_u24 v218, 73728, v218
v_and_b32 v219, 3, v216
v_lshl_add_u32 v218, v219, 5, v218
v_lshrrev_b32 v219, 1, v217
v_lshl_add_u32 v214, v219, 4, v218
s_waitcnt vmcnt(0)
s_branch j_4
nc_3:
s_cmp_eq_u32 s61, 3
s_cbranch_scc1 w3_2
v_and_b32 v5, 15, v1
s_lshl_b32 s67, s61, 4
v_add_u32 v7, s67, v5
v_lshrrev_b32 v5, 4, v1
v_lshlrev_b32 v13, 3, v7
v_lshl_add_u32 v13, v5, 2, v13
v_and_b32 v7, 31, v7
v_lshlrev_b32 v7, 4, v7
s_lshr_b32 s67, s61, 1
s_mul_i32 s67, s67, 36864
v_add_u32 v7, s67, v7
v_lshl_add_u32 v12, v5, 9, v7
s_lshl_b32 s74, s59, 2
s_add_u32 s74, s74, s61
s_mul_i32 s93, s74, 73728
s_add_u32 s93, s93, 11534336
s_mul_i32 s94, s58, 73728
s_add_u32 s94, s94, 6815744
s_lshl_b32 s98, s58, 10
s_add_u32 s98, s98, 65536
s_lshl_b32 s99, s56, 3
s_add_u32 s99, s99, s59
s_lshl_b32 s99, s99, 2
v_mov_b32 v160, 0x40000000
v_mov_b32 v214, v160
v_mov_b32 v212, 0
v_mov_b32 v213, 0
v_cndmask_b32 v15, v160, v14, s[78:79]
v_bfe_u32 v5, v1, 3, 2
v_and_b32 v6, 3, v1
v_lshl_add_u32 v190, v5, 2, v6
v_bfe_u32 v191, v1, 2, 1
v_mul_u32_u24 v5, 9, v191
v_add_u32 v5, v5, v190
s_mul_i32 s66, s61, 648
s_add_u32 s66, s66, 32768
v_lshl_add_u32 v161, v5, 1, s66
v_lshrrev_b32 v7, 5, v1
v_mul_u32_u24 v8, 288, v7
v_add_u32 v162, v161, v8
v_bfe_u32 v8, v1, 4, 1
v_lshl_add_u32 v8, v8, 1, v191
v_lshl_add_u32 v6, v8, 3, v6
v_bfe_u32 v8, v1, 3, 1
v_lshl_add_u32 v6, v8, 2, v6
v_mul_u32_u24 v6, 144, v6
s_mul_i32 s66, s61, 36
s_add_u32 s66, s66, 40960
v_add_u32 v163, s66, v6
v_lshl_add_u32 v164, v7, 4, v163
v_lshl_add_u32 v8, v7, 5, s58
v_and_b32 v6, 31, v1
v_lshlrev_b32 v6, 4, v6
v_lshrrev_b32 v167, 1, v8
v_lshl_add_u32 v6, v167, 10, v6
v_and_b32 v8, 1, v8
v_lshl_add_u32 v167, v8, 9, v6
v_lshlrev_b32 v7, 3, v7
v_sub_u32 v5, v5, v7
v_mov_b32 v7, -64
v_add_u32 v8, -9, v5
v_cmp_gt_u32 vcc, 9, v190
s_nop 1
v_cndmask_b32 v8, v8, v7, vcc
v_and_b32 v168, 1, v8
v_cmp_eq_u32 vcc, 1, v168
v_mov_b32 v168, s82
v_mov_b32 v169, s83
v_cndmask_b32 v168, v168, v169, vcc
v_ashrrev_i32 v169, 1, v8
v_cmp_eq_u32 vcc, 0, v169
s_nop 1
v_cndmask_b32 v174, 0, v168, vcc
v_cmp_eq_u32 vcc, 1, v169
s_nop 1
v_cndmask_b32 v175, 0, v168, vcc
v_cmp_eq_u32 vcc, 2, v169
s_nop 1
v_cndmask_b32 v176, 0, v168, vcc
v_cmp_eq_u32 vcc, 3, v169
s_nop 1
v_cndmask_b32 v177, 0, v168, vcc
v_add_u32 v8, -2, v5
v_add_u32 v6, -9, v190
v_cmp_lt_u32 vcc, 1, v6
s_nop 1
v_cndmask_b32 v8, v8, v7, vcc
v_and_b32 v168, 1, v8
v_cmp_eq_u32 vcc, 1, v168
v_mov_b32 v168, s82
v_mov_b32 v169, s83
v_cndmask_b32 v168, v168, v169, vcc
v_ashrrev_i32 v169, 1, v8
v_cmp_eq_u32 vcc, 0, v169
s_nop 1
v_cndmask_b32 v178, 0, v168, vcc
v_cmp_eq_u32 vcc, 1, v169
s_nop 1
v_cndmask_b32 v179, 0, v168, vcc
v_cmp_eq_u32 vcc, 2, v169
s_nop 1
v_cndmask_b32 v180, 0, v168, vcc
v_cmp_eq_u32 vcc, 3, v169
s_nop 1
v_cndmask_b32 v181, 0, v168, vcc
v_add_u32 v8, -16, v8
v_cmp_gt_u32 vcc, 32, v1
s_nop 1
v_cndmask_b32 v8, v7, v8, vcc
v_and_b32 v168, 1, v8
v_cmp_eq_u32 vcc, 1, v168
v_mov_b32 v168, s82
v_mov_b32 v169, s83
v_cndmask_b32 v168, v168, v169, vcc
v_ashrrev_i32 v169, 1, v8
v_cmp_eq_u32 vcc, 0, v169
s_nop 1
v_cndmask_b32 v182, 0, v168, vcc
v_cmp_eq_u32 vcc, 1, v169
s_nop 1
v_cndmask_b32 v183, 0, v168, vcc
v_cmp_eq_u32 vcc, 2, v169
s_nop 1
v_cndmask_b32 v184, 0, v168, vcc
v_cmp_eq_u32 vcc, 3, v169
s_nop 1
v_cndmask_b32 v185, 0, v168, vcc
v_mov_b32 v188, v182
v_mov_b32 v182, 0
v_mov_b32 v187, 0
v_mov_b32 v189, 0
v_mov_b32 v207, 0
v_add_u32 v165, 4096, v164
v_add_u32 v166, 8192, v164
s_waitcnt vmcnt(0)
s_branch j_4
w3_2:
s_mov_b32 s44, s22
s_mov_b32 s45, s23
s_mov_b32 s46, 1990656
s_mov_b32 s47, 0x20000
s_mov_b32 s48, s24
s_mov_b32 s49, s25
s_mov_b32 s50, 20736
s_mov_b32 s51, 0x20000
s_lshl_b32 s67, s56, 7
s_add_u32 s67, s67, 13312
buffer_load_dword v221, off, s[4:7], s67
s_mul_i32 s67, s59, 2592
s_mov_b32 m0, 32768
s_nop 0
buffer_load_dwordx4 v14, s[48:51], s67 offen offset:0 lds
buffer_load_dwordx4 v14, s[48:51], s67 offen offset:1024 lds
buffer_load_dwordx4 v14, s[48:51], s67 offen offset:2048 lds
s_mul_i32 s67, s59, 144
s_add_u32 s68, s67, 1152
s_add_u32 s69, s67, 2304
v_mov_b32 v47, 0x40000000
v_add_u32 v5, 0, v1
v_mul_u32_u24 v6, 7282, v5
v_lshrrev_b32 v6, 16, v6
v_mul_u32_u24 v7, 9, v6
v_sub_u32 v5, v5, v7
v_and_b32 v7, 7, v6
v_lshrrev_b32 v6, 3, v6
v_lshl_add_u32 v6, v6, 5, s58
v_cmp_gt_u32 vcc, 72, v6
v_mul_u32_u24 v8, 57, v6
s_mov_b64 s[86:87], vcc
v_lshrrev_b32 v8, 9, v8
v_mul_u32_u24 v8, 9, v8
v_sub_u32 v6, v6, v8
v_cmp_eq_u32 vcc, 8, v6
v_lshlrev_b32 v8, 3, v8
v_lshrrev_b32 v40, 2, v6
v_and_b32 v41, 3, v6
v_lshlrev_b32 v41, 2, v41
v_lshl_add_u32 v40, v40, 5, v41
v_lshrrev_b32 v41, 2, v7
v_lshl_add_u32 v40, v41, 4, v40
v_and_b32 v41, 3, v7
v_add_u32 v40, v40, v41
v_add_u32 v41, 64, v7
v_cndmask_b32 v40, v40, v41, vcc
v_add_u32 v40, v40, v8
v_mul_u32_u24 v40, 3456, v40
v_lshl_add_u32 v40, v5, 4, v40
v_cndmask_b32 v40, v47, v40, s[86:87]
s_mov_b32 m0, 40960
s_nop 0
buffer_load_dwordx4 v40, s[44:47], s67 offen lds
s_mov_b32 m0, 45056
s_nop 0
buffer_load_dwordx4 v40, s[44:47], s68 offen lds
s_mov_b32 m0, 49152
v_mad_u32_u24 v41, v6, 9, v7
v_mad_u32_u24 v42, v7, 9, 8
v_cndmask_b32 v41, v41, v42, vcc
v_add_u32 v41, v41, v8
v_mul_u32_u24 v41, 1152, v41
v_lshl_add_u32 v41, v5, 4, v41
v_cndmask_b32 v216, v47, v41, s[86:87]
buffer_load_dwordx4 v40, s[44:47], s69 offen lds
v_add_u32 v5, 64, v1
v_mul_u32_u24 v6, 7282, v5
v_lshrrev_b32 v6, 16, v6
v_mul_u32_u24 v7, 9, v6
v_sub_u32 v5, v5, v7
v_and_b32 v7, 7, v6
v_lshrrev_b32 v6, 3, v6
v_lshl_add_u32 v6, v6, 5, s58
v_cmp_gt_u32 vcc, 72, v6
v_mul_u32_u24 v8, 57, v6
s_mov_b64 s[86:87], vcc
v_lshrrev_b32 v8, 9, v8
v_mul_u32_u24 v8, 9, v8
v_sub_u32 v6, v6, v8
v_cmp_eq_u32 vcc, 8, v6
v_lshlrev_b32 v8, 3, v8
v_lshrrev_b32 v40, 2, v6
v_and_b32 v41, 3, v6
v_lshlrev_b32 v41, 2, v41
v_lshl_add_u32 v40, v40, 5, v41
v_lshrrev_b32 v41, 2, v7
v_lshl_add_u32 v40, v41, 4, v40
v_and_b32 v41, 3, v7
v_add_u32 v40, v40, v41
v_add_u32 v41, 64, v7
v_cndmask_b32 v40, v40, v41, vcc
v_add_u32 v40, v40, v8
v_mul_u32_u24 v40, 3456, v40
v_lshl_add_u32 v40, v5, 4, v40
v_cndmask_b32 v40, v47, v40, s[86:87]
s_mov_b32 m0, 41984
s_nop 0
buffer_load_dwordx4 v40, s[44:47], s67 offen lds
s_mov_b32 m0, 46080
s_nop 0
buffer_load_dwordx4 v40, s[44:47], s68 offen lds
s_mov_b32 m0, 50176
v_mad_u32_u24 v41, v6, 9, v7
v_mad_u32_u24 v42, v7, 9, 8
v_cndmask_b32 v41, v41, v42, vcc
v_add_u32 v41, v41, v8
v_mul_u32_u24 v41, 1152, v41
v_lshl_add_u32 v41, v5, 4, v41
v_cndmask_b32 v217, v47, v41, s[86:87]
buffer_load_dwordx4 v40, s[44:47], s69 offen lds
v_add_u32 v5, 128, v1
v_mul_u32_u24 v6, 7282, v5
v_lshrrev_b32 v6, 16, v6
v_mul_u32_u24 v7, 9, v6
v_sub_u32 v5, v5, v7
v_and_b32 v7, 7, v6
v_lshrrev_b32 v6, 3, v6
v_lshl_add_u32 v6, v6, 5, s58
v_cmp_gt_u32 vcc, 72, v6
v_mul_u32_u24 v8, 57, v6
s_mov_b64 s[86:87], vcc
v_lshrrev_b32 v8, 9, v8
v_mul_u32_u24 v8, 9, v8
v_sub_u32 v6, v6, v8
v_cmp_eq_u32 vcc, 8, v6
v_lshlrev_b32 v8, 3, v8
v_lshrrev_b32 v40, 2, v6
v_and_b32 v41, 3, v6
v_lshlrev_b32 v41, 2, v41
v_lshl_add_u32 v40, v40, 5, v41
v_lshrrev_b32 v41, 2, v7
v_lshl_add_u32 v40, v41, 4, v40
v_and_b32 v41, 3, v7
v_add_u32 v40, v40, v41
v_add_u32 v41, 64, v7
v_cndmask_b32 v40, v40, v41, vcc
v_add_u32 v40, v40, v8
v_mul_u32_u24 v40, 3456, v40
v_lshl_add_u32 v40, v5, 4, v40
v_cndmask_b32 v40, v47, v40, s[86:87]
s_mov_b32 m0, 43008
s_nop 0
buffer_load_dwordx4 v40, s[44:47], s67 offen lds
s_mov_b32 m0, 47104
s_nop 0
buffer_load_dwordx4 v40, s[44:47], s68 offen lds
s_mov_b32 m0, 51200
v_mad_u32_u24 v41, v6, 9, v7
v_mad_u32_u24 v42, v7, 9, 8
v_cndmask_b32 v41, v41, v42, vcc
v_add_u32 v41, v41, v8
v_mul_u32_u24 v41, 1152, v41
v_lshl_add_u32 v41, v5, 4, v41
v_cndmask_b32 v218, v47, v41, s[86:87]
buffer_load_dwordx4 v40, s[44:47], s69 offen lds
v_add_u32 v5, 192, v1
v_mul_u32_u24 v6, 7282, v5
v_lshrrev_b32 v6, 16, v6
v_mul_u32_u24 v7, 9, v6
v_sub_u32 v5, v5, v7
v_and_b32 v7, 7, v6
v_lshrrev_b32 v6, 3, v6
v_lshl_add_u32 v6, v6, 5, s58
v_cmp_gt_u32 vcc, 72, v6
v_mul_u32_u24 v8, 57, v6
s_mov_b64 s[86:87], vcc
v_lshrrev_b32 v8, 9, v8
v_mul_u32_u24 v8, 9, v8
v_sub_u32 v6, v6, v8
v_cmp_eq_u32 vcc, 8, v6
v_lshlrev_b32 v8, 3, v8
v_lshrrev_b32 v40, 2, v6
v_and_b32 v41, 3, v6
v_lshlrev_b32 v41, 2, v41
v_lshl_add_u32 v40, v40, 5, v41
v_lshrrev_b32 v41, 2, v7
v_lshl_add_u32 v40, v41, 4, v40
v_and_b32 v41, 3, v7
v_add_u32 v40, v40, v41
v_add_u32 v41, 64, v7
v_cndmask_b32 v40, v40, v41, vcc
v_add_u32 v40, v40, v8
v_mul_u32_u24 v40, 3456, v40
v_lshl_add_u32 v40, v5, 4, v40
v_cndmask_b32 v40, v47, v40, s[86:87]
s_mov_b32 m0, 44032
s_nop 0
buffer_load_dwordx4 v40, s[44:47], s67 offen lds
s_mov_b32 m0, 48128
s_nop 0
buffer_load_dwordx4 v40, s[44:47], s68 offen lds
s_mov_b32 m0, 52224
v_mad_u32_u24 v41, v6, 9, v7
v_mad_u32_u24 v42, v7, 9, 8
v_cndmask_b32 v41, v41, v42, vcc
v_add_u32 v41, v41, v8
v_mul_u32_u24 v41, 1152, v41
v_lshl_add_u32 v41, v5, 4, v41
v_cndmask_b32 v219, v47, v41, s[86:87]
buffer_load_dwordx4 v40, s[44:47], s69 offen lds
v_and_b32 v5, 15, v1
s_lshl_b32 s67, s61, 4
v_add_u32 v7, s67, v5
v_lshrrev_b32 v5, 4, v1
v_lshlrev_b32 v13, 3, v7
v_lshl_add_u32 v13, v5, 2, v13
v_and_b32 v7, 31, v7
v_lshlrev_b32 v7, 4, v7
s_lshr_b32 s67, s61, 1
s_mul_i32 s67, s67, 36864
v_add_u32 v7, s67, v7
v_lshl_add_u32 v12, v5, 9, v7
s_lshl_b32 s74, s59, 2
s_add_u32 s74, s74, s61
s_mul_i32 s93, s74, 73728
s_add_u32 s93, s93, 11534336
s_mul_i32 s94, s58, 73728
s_add_u32 s94, s94, 6815744
s_lshl_b32 s98, s58, 10
s_add_u32 s98, s98, 65536
s_lshl_b32 s99, s56, 3
s_add_u32 s99, s99, s59
s_lshl_b32 s99, s99, 2
v_mov_b32 v160, 0x40000000
v_mov_b32 v214, v160
v_mov_b32 v212, 0
v_mov_b32 v213, 0
v_cndmask_b32 v15, v160, v14, s[78:79]
v_bfe_u32 v5, v1, 3, 2
v_and_b32 v6, 3, v1
v_lshl_add_u32 v190, v5, 2, v6
v_bfe_u32 v191, v1, 2, 1
v_mul_u32_u24 v5, 9, v191
v_add_u32 v5, v5, v190
s_mul_i32 s66, s61, 648
s_add_u32 s66, s66, 32768
v_lshl_add_u32 v161, v5, 1, s66
v_lshrrev_b32 v7, 5, v1
v_mul_u32_u24 v8, 288, v7
v_add_u32 v162, v161, v8
v_bfe_u32 v8, v1, 4, 1
v_lshl_add_u32 v8, v8, 1, v191
v_lshl_add_u32 v6, v8, 3, v6
v_bfe_u32 v8, v1, 3, 1
v_lshl_add_u32 v6, v8, 2, v6
v_mul_u32_u24 v6, 144, v6
s_mul_i32 s66, s61, 36
s_add_u32 s66, s66, 40960
v_add_u32 v163, s66, v6
v_lshl_add_u32 v164, v7, 4, v163
v_lshl_add_u32 v8, v7, 5, s58
v_and_b32 v6, 31, v1
v_lshlrev_b32 v6, 4, v6
v_lshrrev_b32 v167, 1, v8
v_lshl_add_u32 v6, v167, 10, v6
v_and_b32 v8, 1, v8
v_lshl_add_u32 v167, v8, 9, v6
v_lshlrev_b32 v7, 3, v7
v_sub_u32 v5, v5, v7
v_mov_b32 v7, -64
v_add_u32 v8, -9, v5
v_cmp_gt_u32 vcc, 9, v190
s_nop 1
v_cndmask_b32 v8, v8, v7, vcc
v_and_b32 v168, 1, v8
v_cmp_eq_u32 vcc, 1, v168
v_mov_b32 v168, s82
v_mov_b32 v169, s83
v_cndmask_b32 v168, v168, v169, vcc
v_ashrrev_i32 v169, 1, v8
v_cmp_eq_u32 vcc, 0, v169
s_nop 1
v_cndmask_b32 v174, 0, v168, vcc
v_cmp_eq_u32 vcc, 1, v169
s_nop 1
v_cndmask_b32 v175, 0, v168, vcc
v_cmp_eq_u32 vcc, 2, v169
s_nop 1
v_cndmask_b32 v176, 0, v168, vcc
v_cmp_eq_u32 vcc, 3, v169
s_nop 1
v_cndmask_b32 v177, 0, v168, vcc
v_add_u32 v8, -2, v5
v_add_u32 v6, -9, v190
v_cmp_lt_u32 vcc, 1, v6
s_nop 1
v_cndmask_b32 v8, v8, v7, vcc
v_and_b32 v168, 1, v8
v_cmp_eq_u32 vcc, 1, v168
v_mov_b32 v168, s82
v_mov_b32 v169, s83
v_cndmask_b32 v168, v168, v169, vcc
v_ashrrev_i32 v169, 1, v8
v_cmp_eq_u32 vcc, 0, v169
s_nop 1
v_cndmask_b32 v178, 0, v168, vcc
v_cmp_eq_u32 vcc, 1, v169
s_nop 1
v_cndmask_b32 v179, 0, v168, vcc
v_cmp_eq_u32 vcc, 2, v169
s_nop 1
v_cndmask_b32 v180, 0, v168, vcc
v_cmp_eq_u32 vcc, 3, v169
s_nop 1
v_cndmask_b32 v181, 0, v168, vcc
v_add_u32 v8, -16, v8
v_cmp_gt_u32 vcc, 32, v1
s_nop 1
v_cndmask_b32 v8, v7, v8, vcc
v_and_b32 v168, 1, v8
v_cmp_eq_u32 vcc, 1, v168
v_mov_b32 v168, s82
v_mov_b32 v169, s83
v_cndmask_b32 v168, v168, v169, vcc
v_ashrrev_i32 v169, 1, v8
v_cmp_eq_u32 vcc, 0, v169
s_nop 1
v_cndmask_b32 v182, 0, v168, vcc
v_cmp_eq_u32 vcc, 1, v169
s_nop 1
v_cndmask_b32 v183, 0, v168, vcc
v_cmp_eq_u32 vcc, 2, v169
s_nop 1
v_cndmask_b32 v184, 0, v168, vcc
v_cmp_eq_u32 vcc, 3, v169
s_nop 1
v_cndmask_b32 v185, 0, v168, vcc
v_mov_b32 v188, v182
v_mov_b32 v182, 0
v_mov_b32 v187, 0
v_mov_b32 v189, 0
v_mov_b32 v207, 0
v_add_u32 v165, 4096, v164
v_add_u32 v166, 8192, v164
s_waitcnt vmcnt(16)
j_4:
v_add_u32 v9, 1, v9
s_barrier
v_readfirstlane_b32 s62, v9
s_getreg_b32 s70, hwreg(HW_REG_XCC_ID, 0, 4)
s_lshl_b32 s67, s62, 4
s_or_b32 s70, s70, s67
s_cmp_eq_u32 s61, 3
s_cbranch_scc1 u3_5
ds_read_b64_tr_b16 v[48:49], v32 offset:0
ds_read_b64_tr_b16 v[50:51], v32 offset:576
ds_read_b64_tr_b16 v[52:53], v32 offset:1152
ds_read_b64_tr_b16 v[54:55], v32 offset:10240
ds_read_b64_tr_b16 v[56:57], v32 offset:10816
ds_read_b64_tr_b16 v[58:59], v33 offset:0
ds_read_b64_tr_b16 v[60:61], v33 offset:576
ds_read_b64_tr_b16 v[62:63], v33 offset:1152
ds_read_b64_tr_b16 v[64:65], v33 offset:10240
ds_read_b64_tr_b16 v[66:67], v33 offset:10816
ds_read_b64_tr_b16 v[68:69], v34 offset:0
ds_read_b64_tr_b16 v[70:71], v34 offset:576
ds_read_b64_tr_b16 v[72:73], v34 offset:1152
ds_read_b64_tr_b16 v[74:75], v34 offset:10240
ds_read_b64_tr_b16 v[76:77], v34 offset:10816
s_mov_b32 s66, 6815744
v_lshlrev_b32 v94, 16, v26
v_and_b32 v95, s63, v26
v_lshlrev_b32 v96, 16, v27
v_and_b32 v97, s63, v27
s_waitcnt lgkmcnt(10)
v_and_b32 v80, s63, v48
v_and_b32 v81, s63, v50
v_lshlrev_b32 v82, 16, v49
v_lshlrev_b32 v83, 16, v51
v_and_b32 v84, s63, v49
v_and_b32 v85, s63, v51
v_lshlrev_b32 v86, 16, v50
v_lshlrev_b32 v87, 16, v52
v_and_b32 v88, s63, v50
v_and_b32 v89, s63, v52
v_lshlrev_b32 v90, 16, v51
v_lshlrev_b32 v91, 16, v53
v_and_b32 v92, s63, v51
v_and_b32 v93, s63, v53
v_pk_mul_f32 v[98:99], v[86:87], v[94:95] op_sel_hi:[1,0]
v_pk_mul_f32 v[100:101], v[88:89], v[94:95] op_sel_hi:[1,0]
v_pk_mul_f32 v[102:103], v[90:91], v[94:95] op_sel_hi:[1,0]
v_pk_mul_f32 v[104:105], v[92:93], v[94:95] op_sel_hi:[1,0]
v_pk_fma_f32 v[98:99], v[84:85], v[94:95], v[98:99] op_sel:[0,1,0]
v_pk_fma_f32 v[100:101], v[86:87], v[94:95], v[100:101] op_sel:[0,1,0]
v_pk_fma_f32 v[102:103], v[88:89], v[94:95], v[102:103] op_sel:[0,1,0]
v_pk_fma_f32 v[104:105], v[90:91], v[94:95], v[104:105] op_sel:[0,1,0]
v_lshlrev_b32 v106, 16, v54
v_lshlrev_b32 v107, 16, v56
v_and_b32 v108, s63, v54
v_and_b32 v109, s63, v56
v_lshlrev_b32 v110, 16, v55
v_lshlrev_b32 v111, 16, v57
v_and_b32 v112, s63, v55
v_and_b32 v113, s63, v57
v_pk_fma_f32 v[98:99], v[82:83], v[96:97], v[98:99] op_sel_hi:[1,0,1]
v_pk_fma_f32 v[100:101], v[84:85], v[96:97], v[100:101] op_sel_hi:[1,0,1]
v_pk_fma_f32 v[102:103], v[86:87], v[96:97], v[102:103] op_sel_hi:[1,0,1]
v_pk_fma_f32 v[104:105], v[88:89], v[96:97], v[104:105] op_sel_hi:[1,0,1]
v_pk_fma_f32 v[98:99], v[80:81], v[96:97], v[98:99] op_sel:[0,1,0]
v_pk_fma_f32 v[100:101], v[82:83], v[96:97], v[100:101] op_sel:[0,1,0]
v_pk_fma_f32 v[102:103], v[84:85], v[96:97], v[102:103] op_sel:[0,1,0]
v_pk_fma_f32 v[104:105], v[86:87], v[96:97], v[104:105] op_sel:[0,1,0]
v_pk_mul_f32 v[98:99], v[98:99], v[106:107]
v_pk_mul_f32 v[100:101], v[100:101], v[108:109]
v_pk_mul_f32 v[102:103], v[102:103], v[110:111]
v_pk_mul_f32 v[104:105], v[104:105], v[112:113]
v_cvt_pk_bf16_f32 v114, v105, v103
v_cvt_pk_bf16_f32 v115, v101, v99
v_cvt_pk_bf16_f32 v116, v104, v102
v_cvt_pk_bf16_f32 v117, v100, v98
buffer_store_dwordx4 v[114:117], v36, s[4:7], s66 offen sc1
v_lshlrev_b32 v94, 16, v28
v_and_b32 v95, s63, v28
v_lshlrev_b32 v96, 16, v29
v_and_b32 v97, s63, v29
s_waitcnt lgkmcnt(5)
v_and_b32 v80, s63, v58
v_and_b32 v81, s63, v60
v_lshlrev_b32 v82, 16, v59
v_lshlrev_b32 v83, 16, v61
v_and_b32 v84, s63, v59
v_and_b32 v85, s63, v61
v_lshlrev_b32 v86, 16, v60
v_lshlrev_b32 v87, 16, v62
v_and_b32 v88, s63, v60
v_and_b32 v89, s63, v62
v_lshlrev_b32 v90, 16, v61
v_lshlrev_b32 v91, 16, v63
v_and_b32 v92, s63, v61
v_and_b32 v93, s63, v63
v_pk_mul_f32 v[98:99], v[86:87], v[94:95] op_sel_hi:[1,0]
v_pk_mul_f32 v[100:101], v[88:89], v[94:95] op_sel_hi:[1,0]
v_pk_mul_f32 v[102:103], v[90:91], v[94:95] op_sel_hi:[1,0]
v_pk_mul_f32 v[104:105], v[92:93], v[94:95] op_sel_hi:[1,0]
v_pk_fma_f32 v[98:99], v[84:85], v[94:95], v[98:99] op_sel:[0,1,0]
v_pk_fma_f32 v[100:101], v[86:87], v[94:95], v[100:101] op_sel:[0,1,0]
v_pk_fma_f32 v[102:103], v[88:89], v[94:95], v[102:103] op_sel:[0,1,0]
v_pk_fma_f32 v[104:105], v[90:91], v[94:95], v[104:105] op_sel:[0,1,0]
v_lshlrev_b32 v106, 16, v64
v_lshlrev_b32 v107, 16, v66
v_and_b32 v108, s63, v64
v_and_b32 v109, s63, v66
v_lshlrev_b32 v110, 16, v65
v_lshlrev_b32 v111, 16, v67
v_and_b32 v112, s63, v65
v_and_b32 v113, s63, v67
v_pk_fma_f32 v[98:99], v[82:83], v[96:97], v[98:99] op_sel_hi:[1,0,1]
v_pk_fma_f32 v[100:101], v[84:85], v[96:97], v[100:101] op_sel_hi:[1,0,1]
v_pk_fma_f32 v[102:103], v[86:87], v[96:97], v[102:103] op_sel_hi:[1,0,1]
v_pk_fma_f32 v[104:105], v[88:89], v[96:97], v[104:105] op_sel_hi:[1,0,1]
v_pk_fma_f32 v[98:99], v[80:81], v[96:97], v[98:99] op_sel:[0,1,0]
v_pk_fma_f32 v[100:101], v[82:83], v[96:97], v[100:101] op_sel:[0,1,0]
v_pk_fma_f32 v[102:103], v[84:85], v[96:97], v[102:103] op_sel:[0,1,0]
v_pk_fma_f32 v[104:105], v[86:87], v[96:97], v[104:105] op_sel:[0,1,0]
v_pk_mul_f32 v[98:99], v[98:99], v[106:107]
v_pk_mul_f32 v[100:101], v[100:101], v[108:109]
v_pk_mul_f32 v[102:103], v[102:103], v[110:111]
v_pk_mul_f32 v[104:105], v[104:105], v[112:113]
v_cvt_pk_bf16_f32 v118, v105, v103
v_cvt_pk_bf16_f32 v119, v101, v99
v_cvt_pk_bf16_f32 v120, v104, v102
v_cvt_pk_bf16_f32 v121, v100, v98
buffer_store_dwordx4 v[118:121], v37, s[4:7], s66 offen sc1
v_lshlrev_b32 v94, 16, v30
v_and_b32 v95, s63, v30
v_lshlrev_b32 v96, 16, v31
v_and_b32 v97, s63, v31
s_waitcnt lgkmcnt(0)
v_and_b32 v80, s63, v68
v_and_b32 v81, s63, v70
v_lshlrev_b32 v82, 16, v69
v_lshlrev_b32 v83, 16, v71
v_and_b32 v84, s63, v69
v_and_b32 v85, s63, v71
v_lshlrev_b32 v86, 16, v70
v_lshlrev_b32 v87, 16, v72
v_and_b32 v88, s63, v70
v_and_b32 v89, s63, v72
v_lshlrev_b32 v90, 16, v71
v_lshlrev_b32 v91, 16, v73
v_and_b32 v92, s63, v71
v_and_b32 v93, s63, v73
v_pk_mul_f32 v[98:99], v[86:87], v[94:95] op_sel_hi:[1,0]
v_pk_mul_f32 v[100:101], v[88:89], v[94:95] op_sel_hi:[1,0]
v_pk_mul_f32 v[102:103], v[90:91], v[94:95] op_sel_hi:[1,0]
v_pk_mul_f32 v[104:105], v[92:93], v[94:95] op_sel_hi:[1,0]
v_pk_fma_f32 v[98:99], v[84:85], v[94:95], v[98:99] op_sel:[0,1,0]
v_pk_fma_f32 v[100:101], v[86:87], v[94:95], v[100:101] op_sel:[0,1,0]
v_pk_fma_f32 v[102:103], v[88:89], v[94:95], v[102:103] op_sel:[0,1,0]
v_pk_fma_f32 v[104:105], v[90:91], v[94:95], v[104:105] op_sel:[0,1,0]
v_lshlrev_b32 v106, 16, v74
v_lshlrev_b32 v107, 16, v76
v_and_b32 v108, s63, v74
v_and_b32 v109, s63, v76
v_lshlrev_b32 v110, 16, v75
v_lshlrev_b32 v111, 16, v77
v_and_b32 v112, s63, v75
v_and_b32 v113, s63, v77
v_pk_fma_f32 v[98:99], v[82:83], v[96:97], v[98:99] op_sel_hi:[1,0,1]
v_pk_fma_f32 v[100:101], v[84:85], v[96:97], v[100:101] op_sel_hi:[1,0,1]
v_pk_fma_f32 v[102:103], v[86:87], v[96:97], v[102:103] op_sel_hi:[1,0,1]
v_pk_fma_f32 v[104:105], v[88:89], v[96:97], v[104:105] op_sel_hi:[1,0,1]
v_pk_fma_f32 v[98:99], v[80:81], v[96:97], v[98:99] op_sel:[0,1,0]
v_pk_fma_f32 v[100:101], v[82:83], v[96:97], v[100:101] op_sel:[0,1,0]
v_pk_fma_f32 v[102:103], v[84:85], v[96:97], v[102:103] op_sel:[0,1,0]
v_pk_fma_f32 v[104:105], v[86:87], v[96:97], v[104:105] op_sel:[0,1,0]
v_pk_mul_f32 v[98:99], v[98:99], v[106:107]
v_pk_mul_f32 v[100:101], v[100:101], v[108:109]
v_pk_mul_f32 v[102:103], v[102:103], v[110:111]
v_pk_mul_f32 v[104:105], v[104:105], v[112:113]
v_cvt_pk_bf16_f32 v122, v105, v103
v_cvt_pk_bf16_f32 v123, v101, v99
v_cvt_pk_bf16_f32 v124, v104, v102
v_cvt_pk_bf16_f32 v125, v100, v98
buffer_store_dwordx4 v[122:125], v38, s[4:7], s66 offen sc1
s_cmp_eq_u32 s85, 0
s_cbranch_scc1 h_7
s_lshl_b32 s67, s72, 12
s_lshl_b32 s68, s72, 1
s_add_u32 m0, s73, 32
s_nop 0
buffer_load_dwordx4 v14, s[36:39], s67 offen offset:0 lds
buffer_load_dwordx4 v14, s[36:39], s67 offen offset:1024 lds
buffer_load_dwordx4 v14, s[36:39], s67 offen offset:2048 lds
buffer_load_dwordx4 v14, s[36:39], s67 offen offset:3072 lds
buffer_load_ushort v45, off, s[40:43], s68
s_waitcnt vmcnt(5)
s_branch h2_8
h_7:
s_waitcnt vmcnt(0)
h2_8:
s_mov_b32 s89, 0
s_mov_b64 exec, 1
v_mov_b32 v5, 157716
v_mov_b32 v6, 1
ds_add_rtn_u32 v6, v5, v6
s_mov_b64 exec, -1
s_waitcnt lgkmcnt(0)
v_readfirstlane_b32 s71, v6
s_cmp_lg_u32 s71, 2
s_cbranch_scc1 nl_9
s_lshl_b32 s66, s56, 7
s_lshl_b32 s67, s57, 2
s_add_u32 s66, s66, s67
s_add_u32 s66, s66, 4096
s_mov_b64 exec, 1
v_mov_b32 v5, s70
s_mov_b32 s89, 1
s_add_u32 s67, s66, 9216
buffer_store_dword v5, off, s[4:7], s67
buffer_store_dword v5, off, s[4:7], s66 sc1
s_mov_b64 exec, -1
nl_9:
v_mov_b32 v26, 157720
s_mov_b32 s75, 0
lw_10:
ds_read_b32 v27, v26
s_add_u32 s75, s75, 1
s_waitcnt lgkmcnt(0)
v_readfirstlane_b32 s71, v27
s_cmp_gt_u32 s75, 4000000
s_cbranch_scc1 lwe_11
s_cmp_lt_u32 s71, 1
s_cbranch_scc1 lw_10
lwe_11:
s_branch ue_6
u3_5:
s_waitcnt vmcnt(0)
s_mov_b64 exec, 1
v_mov_b32 v26, 157720
v_mov_b32 v27, 1
ds_add_u32 v26, v27
s_mov_b64 exec, -1
s_mov_b32 s89, 0
ue_6:
ds_read_u16 v32, v162 offset:0
ds_read_u16 v33, v162 offset:36
ds_read_u16 v34, v162 offset:72
ds_read_u16 v35, v162 offset:108
ds_read_u16 v36, v162 offset:144
ds_read_u16 v37, v162 offset:180
ds_read_u16 v38, v162 offset:216
ds_read_u16 v39, v162 offset:252
ds_read_u16 v40, v161 offset:576
ds_read_u16 v41, v161 offset:612
ds_read2_b32 v[192:193], v164 offset0:0 offset1:1
ds_read2_b32 v[194:195], v164 offset0:2 offset1:3
ds_read2_b32 v[196:197], v165 offset0:0 offset1:1
ds_read2_b32 v[198:199], v165 offset0:2 offset1:3
ds_read2_b32 v[200:201], v166 offset0:0 offset1:1
ds_read2_b32 v[202:203], v166 offset0:2 offset1:3
ds_read_b32 v204, v163 offset:32
ds_read_b32 v205, v163 offset:4128
ds_read_b32 v206, v163 offset:8224
s_waitcnt lgkmcnt(9)
v_cmp_gt_u32 vcc, 9, v190
v_lshl_or_b32 v170, v33, 16, v32
v_lshl_or_b32 v171, v35, 16, v34
v_lshl_or_b32 v172, v37, 16, v36
v_lshl_or_b32 v173, v39, 16, v38
v_lshl_or_b32 v183, v41, 16, v40
v_cndmask_b32 v170, 0, v170, vcc
v_cndmask_b32 v171, 0, v171, vcc
v_cndmask_b32 v172, 0, v172, vcc
v_cndmask_b32 v173, 0, v173, vcc
v_cndmask_b32 v183, 0, v183, vcc
s_mov_b32 exec_lo, 0
v_mov_b32 v183, 0
s_mov_b32 exec_lo, -1
v_mov_b32 v186, v183
s_waitcnt lgkmcnt(0)
v_mfma_f32_32x32x16_bf16 v[128:143], v[196:199], v[170:173], 0
v_mfma_f32_32x32x16_bf16 v[144:159], v[192:195], v[170:173], 0
v_mfma_f32_32x32x16_bf16 v[128:143], v[200:203], v[174:177], v[128:143]
v_mfma_f32_32x32x16_bf16 v[144:159], v[200:203], v[178:181], v[144:159]
v_mfma_f32_32x32x16_bf16 v[128:143], v[204:207], v[182:185], v[128:143]
v_mfma_f32_32x32x16_bf16 v[144:159], v[204:207], v[186:189], v[144:159]
s_lshl_b32 s67, s74, 5
s_add_u32 s67, s67, s58
s_lshl_b32 s67, s67, 8
s_add_u32 s67, s67, 1835008
s_add_u32 s68, s93, 32768
s_add_u32 s66, s93, 36864
s_add_u32 s69, s93, 69632
v_mov_b32 v64, 0
v_mov_b32 v65, 0
v_lshlrev_b32 v26, 2, v1
s_nop 0
v_cvt_pk_bf16_f32 v48, v128, v129
v_cvt_pk_bf16_f32 v49, v130, v131
v_cvt_pk_bf16_f32 v50, v132, v133
v_cvt_pk_bf16_f32 v51, v134, v135
v_cvt_pk_bf16_f32 v52, v136, v137
v_cvt_pk_bf16_f32 v53, v138, v139
v_cvt_pk_bf16_f32 v54, v140, v141
v_cvt_pk_bf16_f32 v55, v142, v143
v_cvt_pk_bf16_f32 v56, v144, v145
v_cvt_pk_bf16_f32 v57, v146, v147
v_cvt_pk_bf16_f32 v58, v148, v149
v_cvt_pk_bf16_f32 v59, v150, v151
v_cvt_pk_bf16_f32 v60, v152, v153
v_cvt_pk_bf16_f32 v61, v154, v155
v_cvt_pk_bf16_f32 v62, v156, v157
v_cvt_pk_bf16_f32 v63, v158, v159
s_cmp_eq_u32 s89, 0
s_cbranch_scc1 hw_12
s_waitcnt vmcnt(2)
s_branch hwe_13
hw_12:
s_waitcnt vmcnt(0)
hwe_13:
v_bfe_u32 v66, v1, 2, 1
v_and_b32 v67, 3, v1
v_lshl_add_u32 v66, v66, 1, v67
v_lshlrev_b32 v66, 4, v66
v_lshrrev_b32 v67, 5, v1
v_lshl_add_u32 v66, v67, 13, v66
s_mul_i32 s92, s59, 18432
s_lshl_b32 s71, s58, 8
s_add_u32 s92, s92, s71
s_lshl_b32 s71, s61, 6
s_add_u32 s92, s92, s71
s_add_u32 s92, s92, 2883568
s_mov_b32 exec_lo, 0x660000
s_mov_b32 exec_hi, 0x660000
buffer_store_dwordx4 v[56:59], v66, s[4:7], s92 offen sc1
s_mov_b64 exec, -1
buffer_store_dwordx4 v[48:51], v167, s[4:7], s93 offen sc1
buffer_store_dwordx4 v[56:59], v167, s[4:7], s66 offen sc1
s_cmp_ge_u32 s58, 8
s_cbranch_scc1 n3_14
s_mov_b32 exec_hi, 0
buffer_store_dwordx4 v[52:55], v167, s[4:7], s68 offen sc1
buffer_store_dwordx4 v[60:63], v167, s[4:7], s69 offen sc1
s_add_u32 s92, s92, 16384
s_mov_b32 exec_lo, 0x660000
buffer_store_dwordx4 v[60:63], v66, s[4:7], s92 offen sc1
s_mov_b64 exec, -1
n3_14:
v_dot2c_f32_bf16 v64, s84, v48
v_dot2c_f32_bf16 v65, s84, v56
v_dot2c_f32_bf16 v64, s84, v49
v_dot2c_f32_bf16 v65, s84, v57
v_dot2c_f32_bf16 v64, s84, v50
v_dot2c_f32_bf16 v65, s84, v58
v_dot2c_f32_bf16 v64, s84, v51
v_dot2c_f32_bf16 v65, s84, v59
s_mov_b32 exec_hi, 0
v_dot2c_f32_bf16 v64, s84, v52
v_dot2c_f32_bf16 v65, s84, v60
v_dot2c_f32_bf16 v64, s84, v53
v_dot2c_f32_bf16 v65, s84, v61
v_dot2c_f32_bf16 v64, s84, v54
v_dot2c_f32_bf16 v65, s84, v62
v_dot2c_f32_bf16 v64, s84, v55
v_dot2c_f32_bf16 v65, s84, v63
s_mov_b32 exec_hi, -1
s_nop 1
v_permlane32_swap_b32 v64, v65
v_add_f32 v64, v64, v65
buffer_store_dword v64, v26, s[4:7], s67 offen sc1
s_cmp_eq_u32 s85, 0
s_cbranch_scc1 noconv2_15
v_add_u32 v27, s73, v14
ds_read_b128 v[224:227], v27 offset:32
ds_read_b64 v[228:229], v27 offset:48
ds_read_b128 v[230:233], v27 offset:1056
ds_read_b64 v[234:235], v27 offset:1072
ds_read_b128 v[236:239], v27 offset:2080
ds_read_b64 v[240:241], v27 offset:2096
ds_read_b128 v[242:245], v27 offset:3104
ds_read_b64 v[246:247], v27 offset:3120
v_mov_b32 v32, 0
v_mov_b32 v33, 0
v_mov_b32 v34, 0
v_mov_b32 v35, 0
v_lshlrev_b32 v26, 3, v1
v_add_u32 v26, s73, v26
ds_write_b64 v26, v[32:33] offset:20736
s_waitcnt lgkmcnt(7)
v_readfirstlane_b32 s86, v224
v_readfirstlane_b32 s87, v225
v_alignbit_b32 v64, v225, v224, 16
v_alignbit_b32 v65, v226, v225, 16
v_alignbit_b32 v66, v227, v226, 16
v_alignbit_b32 v67, v228, v227, 16
ds_write_b128 v27, v[64:67] offset:4192
v_mov_b32 v68, v225
v_mov_b32 v69, v226
v_mov_b32 v70, v227
v_mov_b32 v71, v228
ds_write_b128 v27, v[68:71] offset:8352
v_mov_b32 v72, v65
v_mov_b32 v73, v66
v_mov_b32 v74, v67
v_alignbit_b32 v75, v229, v228, 16
ds_write_b128 v27, v[72:75] offset:12512
s_waitcnt lgkmcnt(8)
v_alignbit_b32 v76, v231, v230, 16
v_alignbit_b32 v77, v232, v231, 16
v_alignbit_b32 v78, v233, v232, 16
v_alignbit_b32 v79, v234, v233, 16
ds_write_b128 v27, v[76:79] offset:5216
v_mov_b32 v80, v231
v_mov_b32 v81, v232
v_mov_b32 v82, v233
v_mov_b32 v83, v234
ds_write_b128 v27, v[80:83] offset:9376
v_mov_b32 v84, v77
v_mov_b32 v85, v78
v_mov_b32 v86, v79
v_alignbit_b32 v87, v235, v234, 16
ds_write_b128 v27, v[84:87] offset:13536
s_waitcnt lgkmcnt(9)
v_alignbit_b32 v64, v237, v236, 16
v_alignbit_b32 v65, v238, v237, 16
v_alignbit_b32 v66, v239, v238, 16
v_alignbit_b32 v67, v240, v239, 16
ds_write_b128 v27, v[64:67] offset:6240
v_mov_b32 v68, v237
v_mov_b32 v69, v238
v_mov_b32 v70, v239
v_mov_b32 v71, v240
ds_write_b128 v27, v[68:71] offset:10400
v_mov_b32 v72, v65
v_mov_b32 v73, v66
v_mov_b32 v74, v67
v_alignbit_b32 v75, v241, v240, 16
ds_write_b128 v27, v[72:75] offset:14560
s_waitcnt lgkmcnt(10)
v_alignbit_b32 v76, v243, v242, 16
v_alignbit_b32 v77, v244, v243, 16
v_alignbit_b32 v78, v245, v244, 16
v_alignbit_b32 v79, v246, v245, 16
ds_write_b128 v27, v[76:79] offset:7264
v_mov_b32 v80, v243
v_mov_b32 v81, v244
v_mov_b32 v82, v245
v_mov_b32 v83, v246
ds_write_b128 v27, v[80:83] offset:11424
v_mov_b32 v84, v77
v_mov_b32 v85, v78
v_mov_b32 v86, v79
v_alignbit_b32 v87, v247, v246, 16
ds_write_b128 v27, v[84:87] offset:15584
v_lshlrev_b32 v28, 4, v1
v_sub_u32 v28, 48, v28
v_lshlrev_b64 v[36:37], v28, s[86:87]
v_lshlrev_b64 v[36:37], 16, v[36:37]
v_mul_u32_u24 v26, 4160, v1
v_add_u32 v26, s73, v26
s_mov_b64 exec, 15
ds_write_b128 v26, v[32:35]
ds_write_b128 v26, v[34:37] offset:16
s_mov_b64 exec, -1
v_and_b32 v26, 15, v1
v_lshrrev_b32 v27, 4, v1
v_lshlrev_b32 v28, 3, v27
v_add_u32 v28, v28, v26
v_sub_u32 v29, 15, v28
v_lshlrev_b32 v44, 16, v45
v_and_b32 v30, 1, v29
v_cmp_eq_u32 vcc, 1, v30
v_mov_b32 v30, v45
v_mov_b32 v31, v44
v_cndmask_b32 v30, v30, v31, vcc
v_ashrrev_i32 v31, 1, v29
v_cmp_eq_u32 vcc, 0, v31
s_nop 1
v_cndmask_b32 v208, 0, v30, vcc
v_cmp_eq_u32 vcc, 1, v31
s_nop 1
v_cndmask_b32 v209, 0, v30, vcc
v_cmp_eq_u32 vcc, 2, v31
s_nop 1
v_cndmask_b32 v210, 0, v30, vcc
v_cmp_eq_u32 vcc, 3, v31
s_nop 1
v_cndmask_b32 v211, 0, v30, vcc
noconv2_15:
s_cmp_eq_u32 s85, 0
s_cbranch_scc1 noconv3_16
s_waitcnt vmcnt(0) lgkmcnt(0)
s_lshl_b32 s66, s59, 7
s_lshl_b32 s67, s58, 2
s_add_u32 s67, s67, s66
s_add_u32 s67, s67, 5120
s_mov_b64 exec, 1
v_mov_b32 v26, 157696
v_mov_b32 v27, 1
ds_add_rtn_u32 v27, v26, v27
s_mov_b64 exec, -1
s_waitcnt lgkmcnt(0)
v_readfirstlane_b32 s71, v27
s_cmp_lg_u32 s71, 3
s_cbranch_scc1 nl_18
v_lshlrev_b32 v26, 10, v1
v_mov_b32 v27, s62
s_mov_b64 exec, 3
buffer_store_dword v27, v26, s[4:7], s67 offen sc1
s_mov_b64 exec, -1
nl_18:
v_mov_b32 v26, 157700
s_mov_b32 s75, 0
lw_19:
ds_read_b32 v27, v26
s_add_u32 s75, s75, 1
s_waitcnt lgkmcnt(0)
v_readfirstlane_b32 s71, v27
s_cmp_gt_u32 s75, 4000000
s_cbranch_scc1 lwe_20
s_cmp_lt_u32 s71, 1
s_cbranch_scc1 lw_19
lwe_20:
s_lshl_b32 s67, s72, 12
s_add_u32 s67, s67, 6815744
s_add_u32 m0, s73, 16640
s_nop 0
buffer_load_dwordx4 v14, s[4:7], s67 offen offset:0 sc1 lds
buffer_load_dwordx4 v14, s[4:7], s67 offen offset:1024 sc1 lds
buffer_load_dwordx4 v14, s[4:7], s67 offen offset:2048 sc1 lds
buffer_load_dwordx4 v14, s[4:7], s67 offen offset:3072 sc1 lds
ds_read_b64 v[64:65], v212 offset:0
ds_read_b64 v[66:67], v212 offset:8
ds_read_b64 v[68:69], v212 offset:512
ds_read_b64 v[70:71], v212 offset:520
ds_read_b64 v[72:73], v212 offset:1024
ds_read_b64 v[74:75], v212 offset:1032
ds_read_b64 v[76:77], v212 offset:1536
ds_read_b64 v[78:79], v212 offset:1544
ds_read_b64 v[80:81], v212 offset:2048
ds_read_b64 v[82:83], v212 offset:2056
ds_read_b64 v[84:85], v212 offset:2560
ds_read_b64 v[86:87], v212 offset:2568
ds_read_b64 v[88:89], v212 offset:3072
ds_read_b64 v[90:91], v212 offset:3080
ds_read_b64 v[92:93], v212 offset:3584
ds_read_b64 v[94:95], v212 offset:3592
s_waitcnt vmcnt(0)
s_mov_b64 exec, 1
v_mov_b32 v26, 157708
v_mov_b32 v27, 1
ds_add_u32 v26, v27
s_mov_b64 exec, -1
ds_read_b128 v[128:131], v213 offset:3584
ds_read_b128 v[132:135], v213 offset:3072
ds_read_b128 v[136:139], v213 offset:2560
ds_read_b128 v[140:143], v213 offset:2048
ds_read_b128 v[144:147], v213 offset:1536
ds_read_b128 v[148:151], v213 offset:1024
ds_read_b128 v[152:155], v213 offset:512
ds_read_b128 v[156:159], v213 offset:0
s_waitcnt lgkmcnt(7)
v_mfma_f32_16x16x32_bf16 v[32:35], v[208:211], v[128:131], 0
ds_read_b128 v[160:163], v213 offset:3648
s_waitcnt lgkmcnt(7)
v_mfma_f32_16x16x32_bf16 v[36:39], v[208:211], v[132:135], 0
ds_read_b64 v[96:97], v212 offset:64
ds_read_b64 v[98:99], v212 offset:72
s_waitcnt lgkmcnt(8)
v_mfma_f32_16x16x32_bf16 v[40:43], v[208:211], v[136:139], 0
ds_read_b128 v[164:167], v213 offset:3136
s_waitcnt lgkmcnt(8)
v_mfma_f32_16x16x32_bf16 v[44:47], v[208:211], v[140:143], 0
ds_read_b64 v[100:101], v212 offset:576
ds_read_b64 v[102:103], v212 offset:584
s_waitcnt lgkmcnt(9)
v_mfma_f32_16x16x32_bf16 v[48:51], v[208:211], v[144:147], 0
ds_read_b128 v[168:171], v213 offset:2624
s_waitcnt lgkmcnt(9)
v_mfma_f32_16x16x32_bf16 v[52:55], v[208:211], v[148:151], 0
ds_read_b64 v[104:105], v212 offset:1088
ds_read_b64 v[106:107], v212 offset:1096
s_waitcnt lgkmcnt(10)
v_mfma_f32_16x16x32_bf16 v[56:59], v[208:211], v[152:155], 0
ds_read_b128 v[172:175], v213 offset:2112
s_waitcnt lgkmcnt(10)
v_mfma_f32_16x16x32_bf16 v[60:63], v[208:211], v[156:159], 0
ds_read_b64 v[108:109], v212 offset:1600
ds_read_b64 v[110:111], v212 offset:1608
v_mfma_f32_16x16x32_bf16 v[32:35], v[64:67], v[128:131], v[32:35]
ds_read_b128 v[176:179], v213 offset:1600
v_mfma_f32_16x16x32_bf16 v[36:39], v[64:67], v[132:135], v[36:39]
ds_read_b64 v[112:113], v212 offset:2112
ds_read_b64 v[114:115], v212 offset:2120
v_mfma_f32_16x16x32_bf16 v[36:39], v[68:71], v[128:131], v[36:39]
ds_read_b128 v[180:183], v213 offset:1088
v_mfma_f32_16x16x32_bf16 v[40:43], v[68:71], v[132:135], v[40:43]
ds_read_b64 v[116:117], v212 offset:2624
ds_read_b64 v[118:119], v212 offset:2632
v_mfma_f32_16x16x32_bf16 v[40:43], v[64:67], v[136:139], v[40:43]
ds_read_b128 v[184:187], v213 offset:576
v_mfma_f32_16x16x32_bf16 v[40:43], v[72:75], v[128:131], v[40:43]
ds_read_b64 v[120:121], v212 offset:3136
ds_read_b64 v[122:123], v212 offset:3144
v_mfma_f32_16x16x32_bf16 v[44:47], v[68:71], v[136:139], v[44:47]
ds_read_b128 v[188:191], v213 offset:64
v_mfma_f32_16x16x32_bf16 v[44:47], v[72:75], v[132:135], v[44:47]
ds_read_b64 v[124:125], v212 offset:3648
ds_read_b64 v[126:127], v212 offset:3656
v_mfma_f32_16x16x32_bf16 v[48:51], v[72:75], v[136:139], v[48:51]
v_mfma_f32_16x16x32_bf16 v[44:47], v[64:67], v[140:143], v[44:47]
v_mfma_f32_16x16x32_bf16 v[44:47], v[76:79], v[128:131], v[44:47]
v_mfma_f32_16x16x32_bf16 v[48:51], v[68:71], v[140:143], v[48:51]
v_mfma_f32_16x16x32_bf16 v[48:51], v[76:79], v[132:135], v[48:51]
v_mfma_f32_16x16x32_bf16 v[52:55], v[72:75], v[140:143], v[52:55]
v_mfma_f32_16x16x32_bf16 v[52:55], v[76:79], v[136:139], v[52:55]
v_mfma_f32_16x16x32_bf16 v[56:59], v[76:79], v[140:143], v[56:59]
v_mfma_f32_16x16x32_bf16 v[48:51], v[64:67], v[144:147], v[48:51]
v_mfma_f32_16x16x32_bf16 v[48:51], v[80:83], v[128:131], v[48:51]
v_mfma_f32_16x16x32_bf16 v[52:55], v[68:71], v[144:147], v[52:55]
v_mfma_f32_16x16x32_bf16 v[52:55], v[80:83], v[132:135], v[52:55]
v_mfma_f32_16x16x32_bf16 v[56:59], v[72:75], v[144:147], v[56:59]
v_mfma_f32_16x16x32_bf16 v[56:59], v[80:83], v[136:139], v[56:59]
v_mfma_f32_16x16x32_bf16 v[60:63], v[76:79], v[144:147], v[60:63]
v_mfma_f32_16x16x32_bf16 v[60:63], v[80:83], v[140:143], v[60:63]
v_mfma_f32_16x16x32_bf16 v[52:55], v[64:67], v[148:151], v[52:55]
v_mfma_f32_16x16x32_bf16 v[52:55], v[84:87], v[128:131], v[52:55]
v_mfma_f32_16x16x32_bf16 v[56:59], v[68:71], v[148:151], v[56:59]
v_mfma_f32_16x16x32_bf16 v[56:59], v[84:87], v[132:135], v[56:59]
v_mfma_f32_16x16x32_bf16 v[60:63], v[72:75], v[148:151], v[60:63]
v_mfma_f32_16x16x32_bf16 v[60:63], v[84:87], v[136:139], v[60:63]
v_mfma_f32_16x16x32_bf16 v[56:59], v[64:67], v[152:155], v[56:59]
v_mfma_f32_16x16x32_bf16 v[56:59], v[88:91], v[128:131], v[56:59]
v_mfma_f32_16x16x32_bf16 v[60:63], v[68:71], v[152:155], v[60:63]
v_mfma_f32_16x16x32_bf16 v[60:63], v[88:91], v[132:135], v[60:63]
v_mfma_f32_16x16x32_bf16 v[60:63], v[64:67], v[156:159], v[60:63]
v_mfma_f32_16x16x32_bf16 v[60:63], v[92:95], v[128:131], v[60:63]
s_waitcnt lgkmcnt(15)
v_mfma_f32_16x16x32_bf16 v[32:35], v[96:99], v[160:163], v[32:35]
ds_read_b128 v[128:131], v213 offset:3712
v_mfma_f32_16x16x32_bf16 v[36:39], v[96:99], v[164:167], v[36:39]
ds_read_b64 v[64:65], v212 offset:128
ds_read_b64 v[66:67], v212 offset:136
v_mfma_f32_16x16x32_bf16 v[36:39], v[100:103], v[160:163], v[36:39]
ds_read_b128 v[132:135], v213 offset:3200
v_mfma_f32_16x16x32_bf16 v[40:43], v[100:103], v[164:167], v[40:43]
ds_read_b64 v[68:69], v212 offset:640
ds_read_b64 v[70:71], v212 offset:648
v_mfma_f32_16x16x32_bf16 v[40:43], v[96:99], v[168:171], v[40:43]
ds_read_b128 v[136:139], v213 offset:2688
v_mfma_f32_16x16x32_bf16 v[40:43], v[104:107], v[160:163], v[40:43]
ds_read_b64 v[72:73], v212 offset:1152
ds_read_b64 v[74:75], v212 offset:1160
v_mfma_f32_16x16x32_bf16 v[44:47], v[100:103], v[168:171], v[44:47]
ds_read_b128 v[140:143], v213 offset:2176
v_mfma_f32_16x16x32_bf16 v[44:47], v[104:107], v[164:167], v[44:47]
ds_read_b64 v[76:77], v212 offset:1664
ds_read_b64 v[78:79], v212 offset:1672
v_mfma_f32_16x16x32_bf16 v[48:51], v[104:107], v[168:171], v[48:51]
ds_read_b128 v[144:147], v213 offset:1664
s_waitcnt lgkmcnt(15)
v_mfma_f32_16x16x32_bf16 v[44:47], v[96:99], v[172:175], v[44:47]
ds_read_b64 v[80:81], v212 offset:2176
ds_read_b64 v[82:83], v212 offset:2184
v_mfma_f32_16x16x32_bf16 v[44:47], v[108:111], v[160:163], v[44:47]
ds_read_b128 v[148:151], v213 offset:1152
v_mfma_f32_16x16x32_bf16 v[48:51], v[100:103], v[172:175], v[48:51]
ds_read_b64 v[84:85], v212 offset:2688
ds_read_b64 v[86:87], v212 offset:2696
v_mfma_f32_16x16x32_bf16 v[48:51], v[108:111], v[164:167], v[48:51]
ds_read_b128 v[152:155], v213 offset:640
v_mfma_f32_16x16x32_bf16 v[52:55], v[104:107], v[172:175], v[52:55]
ds_read_b64 v[88:89], v212 offset:3200
ds_read_b64 v[90:91], v212 offset:3208
v_mfma_f32_16x16x32_bf16 v[52:55], v[108:111], v[168:171], v[52:55]
ds_read_b128 v[156:159], v213 offset:128
v_mfma_f32_16x16x32_bf16 v[56:59], v[108:111], v[172:175], v[56:59]
ds_read_b64 v[92:93], v212 offset:3712
ds_read_b64 v[94:95], v212 offset:3720
v_mfma_f32_16x16x32_bf16 v[48:51], v[96:99], v[176:179], v[48:51]
v_mfma_f32_16x16x32_bf16 v[48:51], v[112:115], v[160:163], v[48:51]
v_mfma_f32_16x16x32_bf16 v[52:55], v[100:103], v[176:179], v[52:55]
v_mfma_f32_16x16x32_bf16 v[52:55], v[112:115], v[164:167], v[52:55]
v_mfma_f32_16x16x32_bf16 v[56:59], v[104:107], v[176:179], v[56:59]
v_mfma_f32_16x16x32_bf16 v[56:59], v[112:115], v[168:171], v[56:59]
v_mfma_f32_16x16x32_bf16 v[60:63], v[108:111], v[176:179], v[60:63]
v_mfma_f32_16x16x32_bf16 v[60:63], v[112:115], v[172:175], v[60:63]
v_mfma_f32_16x16x32_bf16 v[52:55], v[96:99], v[180:183], v[52:55]
v_mfma_f32_16x16x32_bf16 v[52:55], v[116:119], v[160:163], v[52:55]
v_mfma_f32_16x16x32_bf16 v[56:59], v[100:103], v[180:183], v[56:59]
v_mfma_f32_16x16x32_bf16 v[56:59], v[116:119], v[164:167], v[56:59]
v_mfma_f32_16x16x32_bf16 v[60:63], v[104:107], v[180:183], v[60:63]
v_mfma_f32_16x16x32_bf16 v[60:63], v[116:119], v[168:171], v[60:63]
v_mfma_f32_16x16x32_bf16 v[56:59], v[96:99], v[184:187], v[56:59]
v_mfma_f32_16x16x32_bf16 v[56:59], v[120:123], v[160:163], v[56:59]
v_mfma_f32_16x16x32_bf16 v[60:63], v[100:103], v[184:187], v[60:63]
v_mfma_f32_16x16x32_bf16 v[60:63], v[120:123], v[164:167], v[60:63]
v_mfma_f32_16x16x32_bf16 v[60:63], v[96:99], v[188:191], v[60:63]
s_waitcnt lgkmcnt(15)
v_mfma_f32_16x16x32_bf16 v[60:63], v[124:127], v[160:163], v[60:63]
v_mfma_f32_16x16x32_bf16 v[32:35], v[64:67], v[128:131], v[32:35]
ds_read_b128 v[160:163], v213 offset:3776
v_mfma_f32_16x16x32_bf16 v[36:39], v[64:67], v[132:135], v[36:39]
ds_read_b64 v[96:97], v212 offset:192
ds_read_b64 v[98:99], v212 offset:200
v_mfma_f32_16x16x32_bf16 v[36:39], v[68:71], v[128:131], v[36:39]
ds_read_b128 v[164:167], v213 offset:3264
v_mfma_f32_16x16x32_bf16 v[40:43], v[68:71], v[132:135], v[40:43]
ds_read_b64 v[100:101], v212 offset:704
ds_read_b64 v[102:103], v212 offset:712
v_mfma_f32_16x16x32_bf16 v[40:43], v[64:67], v[136:139], v[40:43]
ds_read_b128 v[168:171], v213 offset:2752
v_mfma_f32_16x16x32_bf16 v[40:43], v[72:75], v[128:131], v[40:43]
ds_read_b64 v[104:105], v212 offset:1216
ds_read_b64 v[106:107], v212 offset:1224
v_mfma_f32_16x16x32_bf16 v[44:47], v[68:71], v[136:139], v[44:47]
ds_read_b128 v[172:175], v213 offset:2240
v_mfma_f32_16x16x32_bf16 v[44:47], v[72:75], v[132:135], v[44:47]
ds_read_b64 v[108:109], v212 offset:1728
ds_read_b64 v[110:111], v212 offset:1736
v_mfma_f32_16x16x32_bf16 v[48:51], v[72:75], v[136:139], v[48:51]
ds_read_b128 v[176:179], v213 offset:1728
s_waitcnt lgkmcnt(15)
v_mfma_f32_16x16x32_bf16 v[44:47], v[64:67], v[140:143], v[44:47]
ds_read_b64 v[112:113], v212 offset:2240
ds_read_b64 v[114:115], v212 offset:2248
v_mfma_f32_16x16x32_bf16 v[44:47], v[76:79], v[128:131], v[44:47]
ds_read_b128 v[180:183], v213 offset:1216
v_mfma_f32_16x16x32_bf16 v[48:51], v[68:71], v[140:143], v[48:51]
ds_read_b64 v[116:117], v212 offset:2752
ds_read_b64 v[118:119], v212 offset:2760
v_mfma_f32_16x16x32_bf16 v[48:51], v[76:79], v[132:135], v[48:51]
ds_read_b128 v[184:187], v213 offset:704
v_mfma_f32_16x16x32_bf16 v[52:55], v[72:75], v[140:143], v[52:55]
ds_read_b64 v[120:121], v212 offset:3264
ds_read_b64 v[122:123], v212 offset:3272
v_mfma_f32_16x16x32_bf16 v[52:55], v[76:79], v[136:139], v[52:55]
ds_read_b128 v[188:191], v213 offset:192
v_mfma_f32_16x16x32_bf16 v[56:59], v[76:79], v[140:143], v[56:59]
ds_read_b64 v[124:125], v212 offset:3776
ds_read_b64 v[126:127], v212 offset:3784
v_mfma_f32_16x16x32_bf16 v[48:51], v[64:67], v[144:147], v[48:51]
v_mfma_f32_16x16x32_bf16 v[48:51], v[80:83], v[128:131], v[48:51]
v_mfma_f32_16x16x32_bf16 v[52:55], v[68:71], v[144:147], v[52:55]
v_mfma_f32_16x16x32_bf16 v[52:55], v[80:83], v[132:135], v[52:55]
v_mfma_f32_16x16x32_bf16 v[56:59], v[72:75], v[144:147], v[56:59]
v_mfma_f32_16x16x32_bf16 v[56:59], v[80:83], v[136:139], v[56:59]
v_mfma_f32_16x16x32_bf16 v[60:63], v[76:79], v[144:147], v[60:63]
v_mfma_f32_16x16x32_bf16 v[60:63], v[80:83], v[140:143], v[60:63]
v_mfma_f32_16x16x32_bf16 v[52:55], v[64:67], v[148:151], v[52:55]
v_mfma_f32_16x16x32_bf16 v[52:55], v[84:87], v[128:131], v[52:55]
v_mfma_f32_16x16x32_bf16 v[56:59], v[68:71], v[148:151], v[56:59]
v_mfma_f32_16x16x32_bf16 v[56:59], v[84:87], v[132:135], v[56:59]
v_mfma_f32_16x16x32_bf16 v[60:63], v[72:75], v[148:151], v[60:63]
v_mfma_f32_16x16x32_bf16 v[60:63], v[84:87], v[136:139], v[60:63]
v_mfma_f32_16x16x32_bf16 v[56:59], v[64:67], v[152:155], v[56:59]
v_mfma_f32_16x16x32_bf16 v[56:59], v[88:91], v[128:131], v[56:59]
v_mfma_f32_16x16x32_bf16 v[60:63], v[68:71], v[152:155], v[60:63]
v_mfma_f32_16x16x32_bf16 v[60:63], v[88:91], v[132:135], v[60:63]
v_mfma_f32_16x16x32_bf16 v[60:63], v[64:67], v[156:159], v[60:63]
s_waitcnt lgkmcnt(15)
v_mfma_f32_16x16x32_bf16 v[60:63], v[92:95], v[128:131], v[60:63]
v_mfma_f32_16x16x32_bf16 v[32:35], v[96:99], v[160:163], v[32:35]
ds_read_b128 v[128:131], v213 offset:3840
v_mfma_f32_16x16x32_bf16 v[36:39], v[96:99], v[164:167], v[36:39]
ds_read_b64 v[64:65], v212 offset:256
ds_read_b64 v[66:67], v212 offset:264
v_mfma_f32_16x16x32_bf16 v[36:39], v[100:103], v[160:163], v[36:39]
ds_read_b128 v[132:135], v213 offset:3328
v_mfma_f32_16x16x32_bf16 v[40:43], v[100:103], v[164:167], v[40:43]
ds_read_b64 v[68:69], v212 offset:768
ds_read_b64 v[70:71], v212 offset:776
v_mfma_f32_16x16x32_bf16 v[40:43], v[96:99], v[168:171], v[40:43]
ds_read_b128 v[136:139], v213 offset:2816
v_mfma_f32_16x16x32_bf16 v[40:43], v[104:107], v[160:163], v[40:43]
ds_read_b64 v[72:73], v212 offset:1280
ds_read_b64 v[74:75], v212 offset:1288
v_mfma_f32_16x16x32_bf16 v[44:47], v[100:103], v[168:171], v[44:47]
ds_read_b128 v[140:143], v213 offset:2304
v_mfma_f32_16x16x32_bf16 v[44:47], v[104:107], v[164:167], v[44:47]
ds_read_b64 v[76:77], v212 offset:1792
ds_read_b64 v[78:79], v212 offset:1800
v_mfma_f32_16x16x32_bf16 v[48:51], v[104:107], v[168:171], v[48:51]
ds_read_b128 v[144:147], v213 offset:1792
s_waitcnt lgkmcnt(15)
v_mfma_f32_16x16x32_bf16 v[44:47], v[96:99], v[172:175], v[44:47]
ds_read_b64 v[80:81], v212 offset:2304
ds_read_b64 v[82:83], v212 offset:2312
v_mfma_f32_16x16x32_bf16 v[44:47], v[108:111], v[160:163], v[44:47]
ds_read_b128 v[148:151], v213 offset:1280
v_mfma_f32_16x16x32_bf16 v[48:51], v[100:103], v[172:175], v[48:51]
ds_read_b64 v[84:85], v212 offset:2816
ds_read_b64 v[86:87], v212 offset:2824
v_mfma_f32_16x16x32_bf16 v[48:51], v[108:111], v[164:167], v[48:51]
ds_read_b128 v[152:155], v213 offset:768
v_mfma_f32_16x16x32_bf16 v[52:55], v[104:107], v[172:175], v[52:55]
ds_read_b64 v[88:89], v212 offset:3328
ds_read_b64 v[90:91], v212 offset:3336
v_mfma_f32_16x16x32_bf16 v[52:55], v[108:111], v[168:171], v[52:55]
ds_read_b128 v[156:159], v213 offset:256
v_mfma_f32_16x16x32_bf16 v[56:59], v[108:111], v[172:175], v[56:59]
ds_read_b64 v[92:93], v212 offset:3840
ds_read_b64 v[94:95], v212 offset:3848
v_mfma_f32_16x16x32_bf16 v[48:51], v[96:99], v[176:179], v[48:51]
v_mfma_f32_16x16x32_bf16 v[48:51], v[112:115], v[160:163], v[48:51]
v_mfma_f32_16x16x32_bf16 v[52:55], v[100:103], v[176:179], v[52:55]
v_mfma_f32_16x16x32_bf16 v[52:55], v[112:115], v[164:167], v[52:55]
v_mfma_f32_16x16x32_bf16 v[56:59], v[104:107], v[176:179], v[56:59]
v_mfma_f32_16x16x32_bf16 v[56:59], v[112:115], v[168:171], v[56:59]
v_mfma_f32_16x16x32_bf16 v[60:63], v[108:111], v[176:179], v[60:63]
v_mfma_f32_16x16x32_bf16 v[60:63], v[112:115], v[172:175], v[60:63]
v_mfma_f32_16x16x32_bf16 v[52:55], v[96:99], v[180:183], v[52:55]
v_mfma_f32_16x16x32_bf16 v[52:55], v[116:119], v[160:163], v[52:55]
v_mfma_f32_16x16x32_bf16 v[56:59], v[100:103], v[180:183], v[56:59]
v_mfma_f32_16x16x32_bf16 v[56:59], v[116:119], v[164:167], v[56:59]
v_mfma_f32_16x16x32_bf16 v[60:63], v[104:107], v[180:183], v[60:63]
v_mfma_f32_16x16x32_bf16 v[60:63], v[116:119], v[168:171], v[60:63]
v_mfma_f32_16x16x32_bf16 v[56:59], v[96:99], v[184:187], v[56:59]
v_mfma_f32_16x16x32_bf16 v[56:59], v[120:123], v[160:163], v[56:59]
v_mfma_f32_16x16x32_bf16 v[60:63], v[100:103], v[184:187], v[60:63]
v_mfma_f32_16x16x32_bf16 v[60:63], v[120:123], v[164:167], v[60:63]
v_mfma_f32_16x16x32_bf16 v[60:63], v[96:99], v[188:191], v[60:63]
s_waitcnt lgkmcnt(15)
v_mfma_f32_16x16x32_bf16 v[60:63], v[124:127], v[160:163], v[60:63]
v_mfma_f32_16x16x32_bf16 v[32:35], v[64:67], v[128:131], v[32:35]
ds_read_b128 v[160:163], v213 offset:3904
v_mfma_f32_16x16x32_bf16 v[36:39], v[64:67], v[132:135], v[36:39]
ds_read_b64 v[96:97], v212 offset:320
ds_read_b64 v[98:99], v212 offset:328
v_mfma_f32_16x16x32_bf16 v[36:39], v[68:71], v[128:131], v[36:39]
ds_read_b128 v[164:167], v213 offset:3392
v_mfma_f32_16x16x32_bf16 v[40:43], v[68:71], v[132:135], v[40:43]
ds_read_b64 v[100:101], v212 offset:832
ds_read_b64 v[102:103], v212 offset:840
v_mfma_f32_16x16x32_bf16 v[40:43], v[64:67], v[136:139], v[40:43]
ds_read_b128 v[168:171], v213 offset:2880
v_mfma_f32_16x16x32_bf16 v[40:43], v[72:75], v[128:131], v[40:43]
ds_read_b64 v[104:105], v212 offset:1344
ds_read_b64 v[106:107], v212 offset:1352
v_mfma_f32_16x16x32_bf16 v[44:47], v[68:71], v[136:139], v[44:47]
ds_read_b128 v[172:175], v213 offset:2368
v_mfma_f32_16x16x32_bf16 v[44:47], v[72:75], v[132:135], v[44:47]
ds_read_b64 v[108:109], v212 offset:1856
ds_read_b64 v[110:111], v212 offset:1864
v_mfma_f32_16x16x32_bf16 v[48:51], v[72:75], v[136:139], v[48:51]
ds_read_b128 v[176:179], v213 offset:1856
s_waitcnt lgkmcnt(15)
v_mfma_f32_16x16x32_bf16 v[44:47], v[64:67], v[140:143], v[44:47]
ds_read_b64 v[112:113], v212 offset:2368
ds_read_b64 v[114:115], v212 offset:2376
v_mfma_f32_16x16x32_bf16 v[44:47], v[76:79], v[128:131], v[44:47]
ds_read_b128 v[180:183], v213 offset:1344
v_mfma_f32_16x16x32_bf16 v[48:51], v[68:71], v[140:143], v[48:51]
ds_read_b64 v[116:117], v212 offset:2880
ds_read_b64 v[118:119], v212 offset:2888
v_mfma_f32_16x16x32_bf16 v[48:51], v[76:79], v[132:135], v[48:51]
ds_read_b128 v[184:187], v213 offset:832
v_mfma_f32_16x16x32_bf16 v[52:55], v[72:75], v[140:143], v[52:55]
ds_read_b64 v[120:121], v212 offset:3392
ds_read_b64 v[122:123], v212 offset:3400
v_mfma_f32_16x16x32_bf16 v[52:55], v[76:79], v[136:139], v[52:55]
ds_read_b128 v[188:191], v213 offset:320
v_mfma_f32_16x16x32_bf16 v[56:59], v[76:79], v[140:143], v[56:59]
ds_read_b64 v[124:125], v212 offset:3904
ds_read_b64 v[126:127], v212 offset:3912
v_mfma_f32_16x16x32_bf16 v[48:51], v[64:67], v[144:147], v[48:51]
v_mfma_f32_16x16x32_bf16 v[48:51], v[80:83], v[128:131], v[48:51]
v_mfma_f32_16x16x32_bf16 v[52:55], v[68:71], v[144:147], v[52:55]
v_mfma_f32_16x16x32_bf16 v[52:55], v[80:83], v[132:135], v[52:55]
v_mfma_f32_16x16x32_bf16 v[56:59], v[72:75], v[144:147], v[56:59]
v_mfma_f32_16x16x32_bf16 v[56:59], v[80:83], v[136:139], v[56:59]
v_mfma_f32_16x16x32_bf16 v[60:63], v[76:79], v[144:147], v[60:63]
v_mfma_f32_16x16x32_bf16 v[60:63], v[80:83], v[140:143], v[60:63]
v_mfma_f32_16x16x32_bf16 v[52:55], v[64:67], v[148:151], v[52:55]
v_mfma_f32_16x16x32_bf16 v[52:55], v[84:87], v[128:131], v[52:55]
v_mfma_f32_16x16x32_bf16 v[56:59], v[68:71], v[148:151], v[56:59]
v_mfma_f32_16x16x32_bf16 v[56:59], v[84:87], v[132:135], v[56:59]
v_mfma_f32_16x16x32_bf16 v[60:63], v[72:75], v[148:151], v[60:63]
v_mfma_f32_16x16x32_bf16 v[60:63], v[84:87], v[136:139], v[60:63]
v_mfma_f32_16x16x32_bf16 v[56:59], v[64:67], v[152:155], v[56:59]
v_mfma_f32_16x16x32_bf16 v[56:59], v[88:91], v[128:131], v[56:59]
v_mfma_f32_16x16x32_bf16 v[60:63], v[68:71], v[152:155], v[60:63]
v_mfma_f32_16x16x32_bf16 v[60:63], v[88:91], v[132:135], v[60:63]
v_mfma_f32_16x16x32_bf16 v[60:63], v[64:67], v[156:159], v[60:63]
s_waitcnt lgkmcnt(15)
v_mfma_f32_16x16x32_bf16 v[60:63], v[92:95], v[128:131], v[60:63]
v_mfma_f32_16x16x32_bf16 v[32:35], v[96:99], v[160:163], v[32:35]
ds_read_b128 v[128:131], v213 offset:3968
v_mfma_f32_16x16x32_bf16 v[36:39], v[96:99], v[164:167], v[36:39]
ds_read_b64 v[64:65], v212 offset:384
ds_read_b64 v[66:67], v212 offset:392
v_mfma_f32_16x16x32_bf16 v[36:39], v[100:103], v[160:163], v[36:39]
ds_read_b128 v[132:135], v213 offset:3456
v_mfma_f32_16x16x32_bf16 v[40:43], v[100:103], v[164:167], v[40:43]
ds_read_b64 v[68:69], v212 offset:896
ds_read_b64 v[70:71], v212 offset:904
v_mfma_f32_16x16x32_bf16 v[40:43], v[96:99], v[168:171], v[40:43]
ds_read_b128 v[136:139], v213 offset:2944
v_mfma_f32_16x16x32_bf16 v[40:43], v[104:107], v[160:163], v[40:43]
ds_read_b64 v[72:73], v212 offset:1408
ds_read_b64 v[74:75], v212 offset:1416
v_mfma_f32_16x16x32_bf16 v[44:47], v[100:103], v[168:171], v[44:47]
ds_read_b128 v[140:143], v213 offset:2432
v_mfma_f32_16x16x32_bf16 v[44:47], v[104:107], v[164:167], v[44:47]
ds_read_b64 v[76:77], v212 offset:1920
ds_read_b64 v[78:79], v212 offset:1928
v_mfma_f32_16x16x32_bf16 v[48:51], v[104:107], v[168:171], v[48:51]
ds_read_b128 v[144:147], v213 offset:1920
s_waitcnt lgkmcnt(15)
v_mfma_f32_16x16x32_bf16 v[44:47], v[96:99], v[172:175], v[44:47]
ds_read_b64 v[80:81], v212 offset:2432
ds_read_b64 v[82:83], v212 offset:2440
v_mfma_f32_16x16x32_bf16 v[44:47], v[108:111], v[160:163], v[44:47]
ds_read_b128 v[148:151], v213 offset:1408
v_mfma_f32_16x16x32_bf16 v[48:51], v[100:103], v[172:175], v[48:51]
ds_read_b64 v[84:85], v212 offset:2944
ds_read_b64 v[86:87], v212 offset:2952
v_mfma_f32_16x16x32_bf16 v[48:51], v[108:111], v[164:167], v[48:51]
ds_read_b128 v[152:155], v213 offset:896
v_mfma_f32_16x16x32_bf16 v[52:55], v[104:107], v[172:175], v[52:55]
ds_read_b64 v[88:89], v212 offset:3456
ds_read_b64 v[90:91], v212 offset:3464
v_mfma_f32_16x16x32_bf16 v[52:55], v[108:111], v[168:171], v[52:55]
ds_read_b128 v[156:159], v213 offset:384
v_mfma_f32_16x16x32_bf16 v[56:59], v[108:111], v[172:175], v[56:59]
ds_read_b64 v[92:93], v212 offset:3968
ds_read_b64 v[94:95], v212 offset:3976
v_mfma_f32_16x16x32_bf16 v[48:51], v[96:99], v[176:179], v[48:51]
v_mfma_f32_16x16x32_bf16 v[48:51], v[112:115], v[160:163], v[48:51]
v_mfma_f32_16x16x32_bf16 v[52:55], v[100:103], v[176:179], v[52:55]
v_mfma_f32_16x16x32_bf16 v[52:55], v[112:115], v[164:167], v[52:55]
v_mfma_f32_16x16x32_bf16 v[56:59], v[104:107], v[176:179], v[56:59]
v_mfma_f32_16x16x32_bf16 v[56:59], v[112:115], v[168:171], v[56:59]
v_mfma_f32_16x16x32_bf16 v[60:63], v[108:111], v[176:179], v[60:63]
v_mfma_f32_16x16x32_bf16 v[60:63], v[112:115], v[172:175], v[60:63]
v_mfma_f32_16x16x32_bf16 v[52:55], v[96:99], v[180:183], v[52:55]
v_mfma_f32_16x16x32_bf16 v[52:55], v[116:119], v[160:163], v[52:55]
v_mfma_f32_16x16x32_bf16 v[56:59], v[100:103], v[180:183], v[56:59]
v_mfma_f32_16x16x32_bf16 v[56:59], v[116:119], v[164:167], v[56:59]
v_mfma_f32_16x16x32_bf16 v[60:63], v[104:107], v[180:183], v[60:63]
v_mfma_f32_16x16x32_bf16 v[60:63], v[116:119], v[168:171], v[60:63]
v_mfma_f32_16x16x32_bf16 v[56:59], v[96:99], v[184:187], v[56:59]
v_mfma_f32_16x16x32_bf16 v[56:59], v[120:123], v[160:163], v[56:59]
v_mfma_f32_16x16x32_bf16 v[60:63], v[100:103], v[184:187], v[60:63]
v_mfma_f32_16x16x32_bf16 v[60:63], v[120:123], v[164:167], v[60:63]
v_mfma_f32_16x16x32_bf16 v[60:63], v[96:99], v[188:191], v[60:63]
s_waitcnt lgkmcnt(15)
v_mfma_f32_16x16x32_bf16 v[60:63], v[124:127], v[160:163], v[60:63]
v_mfma_f32_16x16x32_bf16 v[32:35], v[64:67], v[128:131], v[32:35]
ds_read_b128 v[160:163], v213 offset:4032
v_mfma_f32_16x16x32_bf16 v[36:39], v[64:67], v[132:135], v[36:39]
ds_read_b64 v[96:97], v212 offset:448
ds_read_b64 v[98:99], v212 offset:456
v_mfma_f32_16x16x32_bf16 v[36:39], v[68:71], v[128:131], v[36:39]
ds_read_b128 v[164:167], v213 offset:3520
v_mfma_f32_16x16x32_bf16 v[40:43], v[68:71], v[132:135], v[40:43]
ds_read_b64 v[100:101], v212 offset:960
ds_read_b64 v[102:103], v212 offset:968
v_mfma_f32_16x16x32_bf16 v[40:43], v[64:67], v[136:139], v[40:43]
ds_read_b128 v[168:171], v213 offset:3008
v_mfma_f32_16x16x32_bf16 v[40:43], v[72:75], v[128:131], v[40:43]
ds_read_b64 v[104:105], v212 offset:1472
ds_read_b64 v[106:107], v212 offset:1480
v_mfma_f32_16x16x32_bf16 v[44:47], v[68:71], v[136:139], v[44:47]
ds_read_b128 v[172:175], v213 offset:2496
v_mfma_f32_16x16x32_bf16 v[44:47], v[72:75], v[132:135], v[44:47]
ds_read_b64 v[108:109], v212 offset:1984
ds_read_b64 v[110:111], v212 offset:1992
v_mfma_f32_16x16x32_bf16 v[48:51], v[72:75], v[136:139], v[48:51]
ds_read_b128 v[176:179], v213 offset:1984
s_waitcnt lgkmcnt(15)
v_mfma_f32_16x16x32_bf16 v[44:47], v[64:67], v[140:143], v[44:47]
ds_read_b64 v[112:113], v212 offset:2496
ds_read_b64 v[114:115], v212 offset:2504
v_mfma_f32_16x16x32_bf16 v[44:47], v[76:79], v[128:131], v[44:47]
ds_read_b128 v[180:183], v213 offset:1472
v_mfma_f32_16x16x32_bf16 v[48:51], v[68:71], v[140:143], v[48:51]
ds_read_b64 v[116:117], v212 offset:3008
ds_read_b64 v[118:119], v212 offset:3016
v_mfma_f32_16x16x32_bf16 v[48:51], v[76:79], v[132:135], v[48:51]
ds_read_b128 v[184:187], v213 offset:960
v_mfma_f32_16x16x32_bf16 v[52:55], v[72:75], v[140:143], v[52:55]
ds_read_b64 v[120:121], v212 offset:3520
ds_read_b64 v[122:123], v212 offset:3528
v_mfma_f32_16x16x32_bf16 v[52:55], v[76:79], v[136:139], v[52:55]
ds_read_b128 v[188:191], v213 offset:448
v_mfma_f32_16x16x32_bf16 v[56:59], v[76:79], v[140:143], v[56:59]
ds_read_b64 v[124:125], v212 offset:4032
ds_read_b64 v[126:127], v212 offset:4040
v_mfma_f32_16x16x32_bf16 v[48:51], v[64:67], v[144:147], v[48:51]
v_mfma_f32_16x16x32_bf16 v[48:51], v[80:83], v[128:131], v[48:51]
v_mfma_f32_16x16x32_bf16 v[52:55], v[68:71], v[144:147], v[52:55]
v_mfma_f32_16x16x32_bf16 v[52:55], v[80:83], v[132:135], v[52:55]
v_mfma_f32_16x16x32_bf16 v[56:59], v[72:75], v[144:147], v[56:59]
v_mfma_f32_16x16x32_bf16 v[56:59], v[80:83], v[136:139], v[56:59]
v_mfma_f32_16x16x32_bf16 v[60:63], v[76:79], v[144:147], v[60:63]
v_mfma_f32_16x16x32_bf16 v[60:63], v[80:83], v[140:143], v[60:63]
v_mfma_f32_16x16x32_bf16 v[52:55], v[64:67], v[148:151], v[52:55]
v_mfma_f32_16x16x32_bf16 v[52:55], v[84:87], v[128:131], v[52:55]
v_mfma_f32_16x16x32_bf16 v[56:59], v[68:71], v[148:151], v[56:59]
v_mfma_f32_16x16x32_bf16 v[56:59], v[84:87], v[132:135], v[56:59]
v_mfma_f32_16x16x32_bf16 v[60:63], v[72:75], v[148:151], v[60:63]
v_mfma_f32_16x16x32_bf16 v[60:63], v[84:87], v[136:139], v[60:63]
v_mfma_f32_16x16x32_bf16 v[56:59], v[64:67], v[152:155], v[56:59]
v_mfma_f32_16x16x32_bf16 v[56:59], v[88:91], v[128:131], v[56:59]
v_mfma_f32_16x16x32_bf16 v[60:63], v[68:71], v[152:155], v[60:63]
v_mfma_f32_16x16x32_bf16 v[60:63], v[88:91], v[132:135], v[60:63]
v_mfma_f32_16x16x32_bf16 v[60:63], v[64:67], v[156:159], v[60:63]
s_waitcnt lgkmcnt(15)
v_mfma_f32_16x16x32_bf16 v[60:63], v[92:95], v[128:131], v[60:63]
v_mfma_f32_16x16x32_bf16 v[32:35], v[96:99], v[160:163], v[32:35]
v_mfma_f32_16x16x32_bf16 v[36:39], v[96:99], v[164:167], v[36:39]
v_mfma_f32_16x16x32_bf16 v[36:39], v[100:103], v[160:163], v[36:39]
v_mfma_f32_16x16x32_bf16 v[40:43], v[100:103], v[164:167], v[40:43]
v_mfma_f32_16x16x32_bf16 v[40:43], v[96:99], v[168:171], v[40:43]
v_mfma_f32_16x16x32_bf16 v[40:43], v[104:107], v[160:163], v[40:43]
v_mfma_f32_16x16x32_bf16 v[44:47], v[100:103], v[168:171], v[44:47]
v_mfma_f32_16x16x32_bf16 v[44:47], v[104:107], v[164:167], v[44:47]
v_mfma_f32_16x16x32_bf16 v[48:51], v[104:107], v[168:171], v[48:51]
s_waitcnt lgkmcnt(14)
v_mfma_f32_16x16x32_bf16 v[44:47], v[96:99], v[172:175], v[44:47]
s_waitcnt lgkmcnt(12)
v_mfma_f32_16x16x32_bf16 v[44:47], v[108:111], v[160:163], v[44:47]
v_mfma_f32_16x16x32_bf16 v[48:51], v[100:103], v[172:175], v[48:51]
v_mfma_f32_16x16x32_bf16 v[48:51], v[108:111], v[164:167], v[48:51]
v_mfma_f32_16x16x32_bf16 v[52:55], v[104:107], v[172:175], v[52:55]
v_mfma_f32_16x16x32_bf16 v[52:55], v[108:111], v[168:171], v[52:55]
v_mfma_f32_16x16x32_bf16 v[56:59], v[108:111], v[172:175], v[56:59]
s_waitcnt lgkmcnt(11)
v_mfma_f32_16x16x32_bf16 v[48:51], v[96:99], v[176:179], v[48:51]
s_waitcnt lgkmcnt(9)
v_mfma_f32_16x16x32_bf16 v[48:51], v[112:115], v[160:163], v[48:51]
v_mfma_f32_16x16x32_bf16 v[52:55], v[100:103], v[176:179], v[52:55]
v_mfma_f32_16x16x32_bf16 v[52:55], v[112:115], v[164:167], v[52:55]
v_mfma_f32_16x16x32_bf16 v[56:59], v[104:107], v[176:179], v[56:59]
v_mfma_f32_16x16x32_bf16 v[56:59], v[112:115], v[168:171], v[56:59]
v_mfma_f32_16x16x32_bf16 v[60:63], v[108:111], v[176:179], v[60:63]
v_mfma_f32_16x16x32_bf16 v[60:63], v[112:115], v[172:175], v[60:63]
s_waitcnt lgkmcnt(8)
v_mfma_f32_16x16x32_bf16 v[52:55], v[96:99], v[180:183], v[52:55]
s_waitcnt lgkmcnt(6)
v_mfma_f32_16x16x32_bf16 v[52:55], v[116:119], v[160:163], v[52:55]
v_mfma_f32_16x16x32_bf16 v[56:59], v[100:103], v[180:183], v[56:59]
v_mfma_f32_16x16x32_bf16 v[56:59], v[116:119], v[164:167], v[56:59]
v_mfma_f32_16x16x32_bf16 v[60:63], v[104:107], v[180:183], v[60:63]
v_mfma_f32_16x16x32_bf16 v[60:63], v[116:119], v[168:171], v[60:63]
s_waitcnt lgkmcnt(5)
v_mfma_f32_16x16x32_bf16 v[56:59], v[96:99], v[184:187], v[56:59]
s_waitcnt lgkmcnt(3)
v_mfma_f32_16x16x32_bf16 v[56:59], v[120:123], v[160:163], v[56:59]
v_mfma_f32_16x16x32_bf16 v[60:63], v[100:103], v[184:187], v[60:63]
v_mfma_f32_16x16x32_bf16 v[60:63], v[120:123], v[164:167], v[60:63]
s_waitcnt lgkmcnt(2)
v_mfma_f32_16x16x32_bf16 v[60:63], v[96:99], v[188:191], v[60:63]
s_waitcnt lgkmcnt(0)
v_mfma_f32_16x16x32_bf16 v[60:63], v[124:127], v[160:163], v[60:63]
v_mov_b32 v26, 157704
s_mov_b32 s75, 0
lw_21:
ds_read_b32 v27, v26
s_add_u32 s75, s75, 1
s_waitcnt lgkmcnt(0)
v_readfirstlane_b32 s71, v27
s_cmp_gt_u32 s75, 4000000
s_cbranch_scc1 lwe_22
s_cmp_lt_u32 s71, 1
s_cbranch_scc1 lw_21
lwe_22:
s_lshl_b32 s67, s72, 7
s_add_u32 s67, s67, 9175040
v_cvt_pk_bf16_f32 v64, v32, v33
v_cvt_pk_bf16_f32 v65, v34, v35
v_cvt_pk_bf16_f32 v66, v36, v37
v_cvt_pk_bf16_f32 v67, v38, v39
v_cvt_pk_bf16_f32 v68, v40, v41
v_cvt_pk_bf16_f32 v69, v42, v43
v_cvt_pk_bf16_f32 v70, v44, v45
v_cvt_pk_bf16_f32 v71, v46, v47
v_cvt_pk_bf16_f32 v72, v48, v49
v_cvt_pk_bf16_f32 v73, v50, v51
v_cvt_pk_bf16_f32 v74, v52, v53
v_cvt_pk_bf16_f32 v75, v54, v55
v_cvt_pk_bf16_f32 v76, v56, v57
v_cvt_pk_bf16_f32 v77, v58, v59
v_cvt_pk_bf16_f32 v78, v60, v61
v_cvt_pk_bf16_f32 v79, v62, v63
v_permlane16_swap_b32 v64, v66
v_permlane16_swap_b32 v65, v67
buffer_store_dwordx4 v[64:67], v214, s[4:7], s67 offen sc1
s_add_u32 s67, s67, 589824
v_permlane16_swap_b32 v68, v70
v_permlane16_swap_b32 v69, v71
buffer_store_dwordx4 v[68:71], v214, s[4:7], s67 offen sc1
s_add_u32 s67, s67, 589824
v_permlane16_swap_b32 v72, v74
v_permlane16_swap_b32 v73, v75
buffer_store_dwordx4 v[72:75], v214, s[4:7], s67 offen sc1
s_add_u32 s67, s67, 589824
v_permlane16_swap_b32 v76, v78
v_permlane16_swap_b32 v77, v79
buffer_store_dwordx4 v[76:79], v214, s[4:7], s67 offen sc1
s_add_u32 s67, s67, 589824
s_add_u32 s89, s93, 0
buffer_load_dwordx4 a[0:3], v14, s[4:7], s89 offen offset:0 sc1
buffer_load_dwordx4 a[8:11], v14, s[4:7], s89 offen offset:1024 sc1
s_add_u32 s89, s93, 2048
buffer_load_dwordx4 a[16:19], v14, s[4:7], s89 offen offset:0 sc1
buffer_load_dwordx4 a[24:27], v14, s[4:7], s89 offen offset:1024 sc1
s_add_u32 s89, s93, 4096
buffer_load_dwordx4 a[32:35], v14, s[4:7], s89 offen offset:0 sc1
buffer_load_dwordx4 a[40:43], v14, s[4:7], s89 offen offset:1024 sc1
s_add_u32 s89, s93, 6144
buffer_load_dwordx4 a[48:51], v14, s[4:7], s89 offen offset:0 sc1
buffer_load_dwordx4 a[56:59], v14, s[4:7], s89 offen offset:1024 sc1
s_add_u32 s89, s93, 8192
buffer_load_dwordx4 a[64:67], v14, s[4:7], s89 offen offset:0 sc1
buffer_load_dwordx4 a[72:75], v14, s[4:7], s89 offen offset:1024 sc1
s_add_u32 s89, s93, 10240
buffer_load_dwordx4 a[80:83], v14, s[4:7], s89 offen offset:0 sc1
buffer_load_dwordx4 a[88:91], v14, s[4:7], s89 offen offset:1024 sc1
s_add_u32 s89, s93, 12288
buffer_load_dwordx4 a[96:99], v14, s[4:7], s89 offen offset:0 sc1
buffer_load_dwordx4 a[104:107], v14, s[4:7], s89 offen offset:1024 sc1
s_add_u32 s89, s93, 14336
buffer_load_dwordx4 a[112:115], v14, s[4:7], s89 offen offset:0 sc1
buffer_load_dwordx4 a[120:123], v14, s[4:7], s89 offen offset:1024 sc1
v_mov_b32 v26, 157700
s_mov_b32 s75, 0
lw_23:
ds_read_b32 v27, v26
s_add_u32 s75, s75, 1
s_waitcnt lgkmcnt(0)
v_readfirstlane_b32 s71, v27
s_cmp_gt_u32 s75, 4000000
s_cbranch_scc1 lwe_24
s_cmp_lt_u32 s71, 1
s_cbranch_scc1 lw_23
lwe_24:
s_sub_u32 s97, s71, 1
v_and_b32 v26, 15, v1
s_lshl_b32 s66, s61, 4
v_add_u32 v27, s66, v26
v_mul_u32_u24 v27, 144, v27
v_lshrrev_b32 v28, 4, v1
v_lshl_add_u32 v27, v28, 3, v27
ds_read_b64 v[2:3], v27 offset:20480
ds_read_b64 v[4:5], v27 offset:20512
ds_read_b64 v[6:7], v27 offset:20544
ds_read_b64 v[8:9], v27 offset:20576
ds_read_b64 v[10:11], v27 offset:20608
v_and_b32 v27, 1, v26
v_lshlrev_b32 v27, 7, v27
v_lshrrev_b32 v28, 3, v26
v_lshl_add_u32 v27, v28, 6, v27
v_bfe_u32 v28, v26, 1, 2
v_lshl_add_u32 v26, v28, 4, v27
s_lshl_b32 s66, s61, 8
s_add_u32 s66, s66, 156672
v_add_u32 v26, s66, v26
v_lshrrev_b32 v27, 1, v1
v_lshlrev_b32 v27, 7, v27
v_and_b32 v28, 1, v1
v_lshl_add_u32 v27, v28, 4, v27
v_mov_b32 v28, 0x40000000
v_cmp_gt_u32 vcc, 16, v1
s_nop 1
v_cndmask_b32 v29, v28, v27, vcc
s_mul_i32 s70, s61, 3072
v_lshl_add_u32 v30, v1, 3, s70
s_mul_i32 s69, s58, 73728
s_mul_i32 s67, s59, 9216
s_add_u32 s69, s69, s67
s_lshl_b32 s67, s61, 5
s_add_u32 s69, s69, s67
s_add_u32 s69, s69, 9175040
v_lshrrev_b32 v28, 4, v1
v_mul_u32_u24 v28, 504, v28
v_sub_u32 v223, v12, v28
v_and_b32 v68, 15, v1
v_lshlrev_b32 v68, 3, v68
v_lshrrev_b32 v69, 4, v1
v_lshl_add_u32 v68, v69, 10, v68
s_lshl_b32 s67, s58, 12
s_lshl_b32 s68, s61, 7
s_add_u32 s67, s67, s68
s_add_u32 s67, s67, 262144
s_mov_b32 s96, s67
s_add_u32 s91, s69, 4096
s_add_u32 s90, s69, 8192
v_bfe_u32 v176, v1, 2, 1
v_lshrrev_b32 v177, 5, v1
v_cmp_eq_u32 vcc, v176, v177
v_bfe_u32 v176, v1, 3, 2
v_and_b32 v177, 3, v1
v_lshl_add_u32 v176, v176, 2, v177
v_mov_b32 v177, -64
v_cndmask_b32 v176, v177, v176, vcc
v_add_u32 v177, -8, v176
v_and_b32 v178, 1, v176
v_cmp_eq_u32 vcc, 1, v178
v_mov_b32 v178, s82
v_mov_b32 v179, s83
v_cndmask_b32 v178, v178, v179, vcc
v_ashrrev_i32 v179, 1, v176
v_cmp_eq_u32 vcc, 0, v179
s_nop 1
v_cndmask_b32 v212, 0, v178, vcc
v_cmp_eq_u32 vcc, 1, v179
s_nop 1
v_cndmask_b32 v213, 0, v178, vcc
v_cmp_eq_u32 vcc, 2, v179
s_nop 1
v_cndmask_b32 v214, 0, v178, vcc
v_cmp_eq_u32 vcc, 3, v179
s_nop 1
v_cndmask_b32 v215, 0, v178, vcc
v_and_b32 v178, 1, v177
v_cmp_eq_u32 vcc, 1, v178
v_mov_b32 v178, s82
v_mov_b32 v179, s83
v_cndmask_b32 v178, v178, v179, vcc
v_ashrrev_i32 v179, 1, v177
v_cmp_eq_u32 vcc, 0, v179
s_nop 1
v_cndmask_b32 v216, 0, v178, vcc
v_cmp_eq_u32 vcc, 1, v179
s_nop 1
v_cndmask_b32 v217, 0, v178, vcc
v_cmp_eq_u32 vcc, 2, v179
s_nop 1
v_cndmask_b32 v218, 0, v178, vcc
v_cmp_eq_u32 vcc, 3, v179
s_nop 1
v_cndmask_b32 v219, 0, v178, vcc
s_waitcnt lgkmcnt(0)
v_lshlrev_b32 v76, 16, v2
v_and_b32 v77, s63, v2
v_lshlrev_b32 v78, 16, v3
v_and_b32 v79, s63, v3
v_lshlrev_b32 v80, 16, v4
v_and_b32 v81, s63, v4
v_lshlrev_b32 v82, 16, v5
v_and_b32 v83, s63, v5
v_lshlrev_b32 v84, 16, v6
v_and_b32 v85, s63, v6
v_lshlrev_b32 v86, 16, v7
v_and_b32 v87, s63, v7
v_lshlrev_b32 v88, 16, v8
v_and_b32 v89, s63, v8
v_lshlrev_b32 v90, 16, v9
v_and_b32 v91, s63, v9
v_lshlrev_b32 v92, 16, v10
v_and_b32 v93, s63, v10
v_lshlrev_b32 v94, 16, v11
v_and_b32 v95, s63, v11
s_add_u32 s89, s93, 16384
buffer_load_dwordx4 a[128:131], v14, s[4:7], s89 offen offset:0 sc1
buffer_load_dwordx4 a[136:139], v14, s[4:7], s89 offen offset:1024 sc1
s_add_u32 s89, s93, 18432
buffer_load_dwordx4 a[144:147], v14, s[4:7], s89 offen offset:0 sc1
buffer_load_dwordx4 a[152:155], v14, s[4:7], s89 offen offset:1024 sc1
s_add_u32 s89, s93, 20480
buffer_load_dwordx4 a[160:163], v14, s[4:7], s89 offen offset:0 sc1
buffer_load_dwordx4 a[168:171], v14, s[4:7], s89 offen offset:1024 sc1
s_add_u32 s89, s93, 22528
buffer_load_dwordx4 a[176:179], v14, s[4:7], s89 offen offset:0 sc1
buffer_load_dwordx4 a[184:187], v14, s[4:7], s89 offen offset:1024 sc1
s_add_u32 s89, s93, 24576
buffer_load_dwordx4 a[192:195], v14, s[4:7], s89 offen offset:0 sc1
buffer_load_dwordx4 a[200:203], v14, s[4:7], s89 offen offset:1024 sc1
s_add_u32 s89, s93, 26624
buffer_load_dwordx4 a[208:211], v14, s[4:7], s89 offen offset:0 sc1
buffer_load_dwordx4 a[216:219], v14, s[4:7], s89 offen offset:1024 sc1
s_branch convend_17
noconv3_16:
s_cmp_lg_u32 s61, 3
s_cbranch_scc1 w_25
v_mov_b32 v72, -1
v_mov_b32 v73, -1
v_mov_b32 v74, -1
v_mov_b32 v75, -1
s_mul_i32 s67, s58, 73728
s_mul_i32 s68, s59, 9216
s_add_u32 s67, s67, s68
s_add_u32 s67, s67, 9175040
buffer_store_dwordx4 v[72:75], v14, s[4:7], s67 offen offset:0 sc1
buffer_store_dwordx4 v[72:75], v14, s[4:7], s67 offen offset:1024 sc1
buffer_store_dwordx4 v[72:75], v14, s[4:7], s67 offen offset:2048 sc1
buffer_store_dwordx4 v[72:75], v14, s[4:7], s67 offen offset:3072 sc1
s_add_u32 s67, s67, 4096
buffer_store_dwordx4 v[72:75], v14, s[4:7], s67 offen offset:0 sc1
buffer_store_dwordx4 v[72:75], v14, s[4:7], s67 offen offset:1024 sc1
buffer_store_dwordx4 v[72:75], v14, s[4:7], s67 offen offset:2048 sc1
buffer_store_dwordx4 v[72:75], v14, s[4:7], s67 offen offset:3072 sc1
s_add_u32 s67, s67, 4096
buffer_store_dwordx4 v[72:75], v14, s[4:7], s67 offen offset:0 sc1
s_waitcnt vmcnt(0) lgkmcnt(0)
s_lshl_b32 s66, s59, 7
s_lshl_b32 s67, s58, 2
s_add_u32 s67, s67, s66
s_add_u32 s67, s67, 5120
s_mov_b64 exec, 1
v_mov_b32 v26, 157696
v_mov_b32 v27, 1
ds_add_rtn_u32 v27, v26, v27
s_mov_b64 exec, -1
s_waitcnt lgkmcnt(0)
v_readfirstlane_b32 s71, v27
s_cmp_lg_u32 s71, 3
s_cbranch_scc1 nl_26
v_lshlrev_b32 v26, 10, v1
v_mov_b32 v27, s62
s_mov_b64 exec, 3
buffer_store_dword v27, v26, s[4:7], s67 offen sc1
s_mov_b64 exec, -1
nl_26:
v_mov_b32 v26, 157716
s_mov_b32 s75, 0
lw_27:
ds_read_b32 v27, v26
s_add_u32 s75, s75, 1
s_waitcnt lgkmcnt(0)
v_readfirstlane_b32 s71, v27
s_cmp_gt_u32 s75, 4000000
s_cbranch_scc1 lwe_28
s_cmp_lt_u32 s71, 3
s_cbranch_scc1 lw_27
lwe_28:
s_waitcnt vmcnt(0)
v_and_b32 v27, 31, v1
v_lshlrev_b32 v27, 2, v27
s_lshl_b32 s66, s56, 7
s_add_u32 s67, s66, 4096
s_add_u32 s66, s66, 13312
s_mov_b32 s75, 0
pu_29:
s_cmp_gt_u32 s75, 24
s_cselect_b32 s66, s67, s66
buffer_load_dword v28, v27, s[4:7], s66 offen sc1
s_add_u32 s75, s75, 1
s_waitcnt vmcnt(0)
v_xor_b32 v28, s70, v28
v_cmp_lt_u32 vcc, 15, v28
s_cmp_gt_u32 s75, 200000
s_cbranch_scc1 pue_30
s_cbranch_vccnz pu_29
pue_30:
v_cmp_ne_u32 vcc, 0, v28
s_nop 4
s_cmp_eq_u64 vcc, 0
s_cselect_b32 s66, 2, 1
s_mov_b64 exec, 1
v_mov_b32 v27, 157700
v_mov_b32 v28, s66
ds_add_u32 v27, v28
s_mov_b64 exec, -1
s_sub_u32 s97, s66, 1
s_lshl_b32 s66, s59, 7
s_add_u32 s66, s66, 5120
s_lshl_b32 s67, s56, 7
s_add_u32 s67, s67, 6144
s_cmp_lt_u32 s57, 8
s_cselect_b32 s96, 3, 2
v_and_b32 v30, 31, v1
v_lshl_add_u32 v31, v30, 2, s67
v_lshl_add_u32 v30, v30, 2, s66
v_cmp_gt_u32 vcc, 32, v1
s_nop 1
v_cndmask_b32 v30, v31, v30, vcc
s_waitcnt lgkmcnt(0)
v_mov_b32 v26, 157708
s_mov_b32 s75, 0
lw_31:
ds_read_b32 v27, v26
s_add_u32 s75, s75, 1
s_waitcnt lgkmcnt(0)
v_readfirstlane_b32 s71, v27
s_cmp_gt_u32 s75, 4000000
s_cbranch_scc1 lwe_32
s_cmp_lt_u32 s71, s96
s_cbranch_scc1 lw_31
lwe_32:
s_mov_b32 s36, s8
s_mov_b32 s37, s9
s_mov_b32 s38, 2359296
s_mov_b32 s39, 0x20000
s_mul_i32 s67, s58, 73728
s_mul_i32 s68, s59, 144
s_add_u32 s67, s67, s68
v_add_u32 v26, 0, v1
v_mul_u32_u24 v27, 7282, v26
v_lshrrev_b32 v27, 16, v27
v_mul_u32_u24 v27, 1008, v27
v_lshl_add_u32 v26, v26, 4, v27
s_mov_b32 m0, 20480
s_nop 0
buffer_load_dwordx4 v26, s[36:39], s67 offen lds
v_add_u32 v26, 64, v1
v_mul_u32_u24 v27, 7282, v26
v_lshrrev_b32 v27, 16, v27
v_mul_u32_u24 v27, 1008, v27
v_lshl_add_u32 v26, v26, 4, v27
s_mov_b32 m0, 21504
s_nop 0
buffer_load_dwordx4 v26, s[36:39], s67 offen lds
v_add_u32 v26, 128, v1
v_mul_u32_u24 v27, 7282, v26
v_lshrrev_b32 v27, 16, v27
v_mul_u32_u24 v27, 1008, v27
v_lshl_add_u32 v26, v26, 4, v27
s_mov_b32 m0, 22528
s_nop 0
buffer_load_dwordx4 v26, s[36:39], s67 offen lds
v_add_u32 v26, 192, v1
v_mul_u32_u24 v27, 7282, v26
v_lshrrev_b32 v27, 16, v27
v_mul_u32_u24 v27, 1008, v27
v_lshl_add_u32 v26, v26, 4, v27
s_mov_b32 m0, 23552
s_nop 0
buffer_load_dwordx4 v26, s[36:39], s67 offen lds
v_add_u32 v26, 256, v1
v_mul_u32_u24 v27, 7282, v26
v_lshrrev_b32 v27, 16, v27
v_mul_u32_u24 v27, 1008, v27
v_lshl_add_u32 v26, v26, 4, v27
s_mov_b32 m0, 24576
s_nop 0
buffer_load_dwordx4 v26, s[36:39], s67 offen lds
v_add_u32 v26, 320, v1
v_mul_u32_u24 v27, 7282, v26
v_lshrrev_b32 v27, 16, v27
v_mul_u32_u24 v27, 1008, v27
v_lshl_add_u32 v26, v26, 4, v27
s_mov_b32 m0, 25600
s_nop 0
buffer_load_dwordx4 v26, s[36:39], s67 offen lds
v_add_u32 v26, 384, v1
v_mul_u32_u24 v27, 7282, v26
v_lshrrev_b32 v27, 16, v27
v_mul_u32_u24 v27, 1008, v27
v_lshl_add_u32 v26, v26, 4, v27
s_mov_b32 m0, 26624
s_nop 0
buffer_load_dwordx4 v26, s[36:39], s67 offen lds
v_add_u32 v26, 448, v1
v_mul_u32_u24 v27, 7282, v26
v_lshrrev_b32 v27, 16, v27
v_mul_u32_u24 v27, 1008, v27
v_lshl_add_u32 v26, v26, 4, v27
s_mov_b32 m0, 27648
s_nop 0
buffer_load_dwordx4 v26, s[36:39], s67 offen lds
v_add_u32 v26, 512, v1
v_mul_u32_u24 v27, 7282, v26
v_lshrrev_b32 v27, 16, v27
v_mul_u32_u24 v27, 1008, v27
v_lshl_add_u32 v26, v26, 4, v27
s_mov_b32 m0, 28672
s_nop 0
buffer_load_dwordx4 v26, s[36:39], s67 offen lds
v_lshlrev_b32 v26, 7, v1
s_lshl_b32 s69, s58, 3
s_add_u32 s69, s69, s59
s_lshl_b32 s69, s69, 9
s_add_u32 s69, s69, 393216
v_and_b32 v27, 0x180, v26
v_bfe_u32 v28, v1, 2, 1
v_mul_u32_u24 v28, 131072, v28
v_add3_u32 v27, v27, v28, s69
v_and_b32 v28, 0x380, v26
v_add_u32 v28, s98, v28
v_cmp_gt_u32 vcc, 8, v1
s_nop 1
v_cndmask_b32 v27, v28, v27, vcc
s_lshl_b32 s68, s99, 5
s_add_u32 s68, s68, 32768
v_mov_b32 v28, s68
v_cmp_gt_u32 vcc, 13, v1
s_nop 1
v_cndmask_b32 v27, v28, v27, vcc
s_lshl_b32 s68, s56, 7
s_add_u32 s68, s68, 7168
v_writelane_b32 v27, s68, 14
s_lshl_b32 s68, s58, 7
s_add_u32 s68, s68, 8192
v_writelane_b32 v27, s68, 15
s_mov_b64 exec, 0xffff
buffer_load_dword v220, v27, s[4:7], 0 offen
s_mov_b64 exec, -1
s_mov_b32 s52, s26
s_mov_b32 s53, s27
s_mov_b32 s54, 663552
s_mov_b32 s55, 0x20000
s_mul_i32 s67, s59, 144
s_mov_b32 m0, 36864
s_nop 0
buffer_load_dwordx4 v216, s[52:55], s67 offen lds
s_mov_b32 m0, 37888
s_nop 0
buffer_load_dwordx4 v217, s[52:55], s67 offen lds
s_mov_b32 m0, 38912
s_nop 0
buffer_load_dwordx4 v218, s[52:55], s67 offen lds
s_mov_b32 m0, 39936
s_nop 0
buffer_load_dwordx4 v219, s[52:55], s67 offen lds
v_mov_b32 v72, -1
v_mov_b32 v73, -1
v_mov_b32 v74, -1
v_mov_b32 v75, -1
s_lshl_b32 s69, s59, 2
s_add_u32 s69, s69, s60
s_lshl_b32 s69, s69, 3
s_add_u32 s69, s69, s56
s_lshl_b32 s69, s69, 11
s_add_u32 s69, s69, 655360
s_add_u32 s68, s69, 524288
buffer_store_dwordx4 v[72:75], v14, s[4:7], s69 offen offset:0 sc1
buffer_store_dwordx4 v[72:75], v14, s[4:7], s69 offen offset:1024 sc1
buffer_store_dwordx4 v[72:75], v14, s[4:7], s68 offen offset:0 sc1
buffer_store_dwordx4 v[72:75], v14, s[4:7], s68 offen offset:1024 sc1
s_getpc_b64 s[86:87]
pc_33:
s_add_u32 s86, s86, L_layer0-pc_33
s_addc_u32 s87, s87, 0
s_mul_i32 s71, s57, 640
v_lshl_add_u32 v222, v1, 7, s71
v_min_u32 v222, L_code_end-L_layer0-4, v222
s_mov_b64 exec, 31
global_load_dword v222, v222, s[86:87]
s_mov_b64 exec, -1
s_waitcnt vmcnt(0)
s_mov_b32 s75, 0
poll_34:
buffer_load_dword v27, v30, s[4:7], 0 offen offset:0 sc1
s_add_u32 s75, s75, 1
s_waitcnt vmcnt(0)
v_cmp_ne_u32 vcc, s62, v27
s_cmp_gt_u32 s75, 200000
s_cbranch_scc1 polle_35
s_cbranch_vccnz poll_34
polle_35:
s_mov_b64 exec, 1
v_mov_b32 v76, 157704
v_mov_b32 v77, 1
ds_add_u32 v76, v77
s_mov_b64 exec, -1
v_mul_u32_u24 v26, 144, v1
v_mov_b32 v28, 0
v_mov_b32 v29, 0
ds_read_b128 v[32:35], v26 offset:20480
ds_read_b128 v[36:39], v26 offset:20496
ds_read_b128 v[40:43], v26 offset:20512
ds_read_b128 v[44:47], v26 offset:20528
ds_read_b128 v[48:51], v26 offset:20544
ds_read_b128 v[52:55], v26 offset:20560
ds_read_b128 v[56:59], v26 offset:20576
ds_read_b128 v[60:63], v26 offset:20592
ds_read_b128 v[64:67], v26 offset:20608
s_waitcnt lgkmcnt(8)
v_dot2c_f32_bf16 v28, s84, v32
v_dot2c_f32_bf16 v29, v32, v32
v_dot2c_f32_bf16 v28, s84, v33
v_dot2c_f32_bf16 v29, v33, v33
v_dot2c_f32_bf16 v28, s84, v34
v_dot2c_f32_bf16 v29, v34, v34
v_dot2c_f32_bf16 v28, s84, v35
v_dot2c_f32_bf16 v29, v35, v35
s_waitcnt lgkmcnt(7)
v_dot2c_f32_bf16 v28, s84, v36
v_dot2c_f32_bf16 v29, v36, v36
v_dot2c_f32_bf16 v28, s84, v37
v_dot2c_f32_bf16 v29, v37, v37
v_dot2c_f32_bf16 v28, s84, v38
v_dot2c_f32_bf16 v29, v38, v38
v_dot2c_f32_bf16 v28, s84, v39
v_dot2c_f32_bf16 v29, v39, v39
s_waitcnt lgkmcnt(6)
v_dot2c_f32_bf16 v28, s84, v40
v_dot2c_f32_bf16 v29, v40, v40
v_dot2c_f32_bf16 v28, s84, v41
v_dot2c_f32_bf16 v29, v41, v41
v_dot2c_f32_bf16 v28, s84, v42
v_dot2c_f32_bf16 v29, v42, v42
v_dot2c_f32_bf16 v28, s84, v43
v_dot2c_f32_bf16 v29, v43, v43
s_waitcnt lgkmcnt(5)
v_dot2c_f32_bf16 v28, s84, v44
v_dot2c_f32_bf16 v29, v44, v44
v_dot2c_f32_bf16 v28, s84, v45
v_dot2c_f32_bf16 v29, v45, v45
v_dot2c_f32_bf16 v28, s84, v46
v_dot2c_f32_bf16 v29, v46, v46
v_dot2c_f32_bf16 v28, s84, v47
v_dot2c_f32_bf16 v29, v47, v47
s_waitcnt lgkmcnt(4)
v_dot2c_f32_bf16 v28, s84, v48
v_dot2c_f32_bf16 v29, v48, v48
v_dot2c_f32_bf16 v28, s84, v49
v_dot2c_f32_bf16 v29, v49, v49
v_dot2c_f32_bf16 v28, s84, v50
v_dot2c_f32_bf16 v29, v50, v50
v_dot2c_f32_bf16 v28, s84, v51
v_dot2c_f32_bf16 v29, v51, v51
s_waitcnt lgkmcnt(3)
v_dot2c_f32_bf16 v28, s84, v52
v_dot2c_f32_bf16 v29, v52, v52
v_dot2c_f32_bf16 v28, s84, v53
v_dot2c_f32_bf16 v29, v53, v53
v_dot2c_f32_bf16 v28, s84, v54
v_dot2c_f32_bf16 v29, v54, v54
v_dot2c_f32_bf16 v28, s84, v55
v_dot2c_f32_bf16 v29, v55, v55
s_waitcnt lgkmcnt(2)
v_dot2c_f32_bf16 v28, s84, v56
v_dot2c_f32_bf16 v29, v56, v56
v_dot2c_f32_bf16 v28, s84, v57
v_dot2c_f32_bf16 v29, v57, v57
v_dot2c_f32_bf16 v28, s84, v58
v_dot2c_f32_bf16 v29, v58, v58
v_dot2c_f32_bf16 v28, s84, v59
v_dot2c_f32_bf16 v29, v59, v59
s_waitcnt lgkmcnt(1)
v_dot2c_f32_bf16 v28, s84, v60
v_dot2c_f32_bf16 v29, v60, v60
v_dot2c_f32_bf16 v28, s84, v61
v_dot2c_f32_bf16 v29, v61, v61
v_dot2c_f32_bf16 v28, s84, v62
v_dot2c_f32_bf16 v29, v62, v62
v_dot2c_f32_bf16 v28, s84, v63
v_dot2c_f32_bf16 v29, v63, v63
s_waitcnt lgkmcnt(0)
v_dot2c_f32_bf16 v28, s84, v64
v_dot2c_f32_bf16 v29, v64, v64
v_dot2c_f32_bf16 v28, s84, v65
v_dot2c_f32_bf16 v29, v65, v65
v_dot2c_f32_bf16 v28, s84, v66
v_dot2c_f32_bf16 v29, v66, v66
v_dot2c_f32_bf16 v28, s84, v67
v_dot2c_f32_bf16 v29, v67, v67
s_lshl_b32 s67, s58, 3
s_add_u32 s67, s67, s59
s_lshl_b32 s67, s67, 9
s_add_u32 s67, s67, 262144
v_lshlrev_b32 v26, 3, v1
buffer_store_dwordx2 v[28:29], v26, s[4:7], s67 offen sc1
s_add_u32 s67, s67, 262144
s_cmp_eq_u32 s97, 0
s_cbranch_scc1 slow_36
buffer_store_dwordx2 v[72:73], v26, s[4:7], s67 offen
back_37:
v_bfe_u32 v76, v1, 2, 2
v_mul_u32_u24 v76, 144, v76
v_and_b32 v77, 1, v1
v_lshl_add_u32 v78, v77, 3, v76
v_and_b32 v77, 3, v1
v_lshl_add_u32 v76, v77, 3, v76
v_lshrrev_b32 v77, 4, v1
v_lshl_add_u32 v76, v77, 5, v76
v_and_b32 v79, 15, v1
v_lshlrev_b32 v79, 4, v79
v_lshl_add_u32 v79, v77, 10, v79
s_lshr_b32 s67, s58, 2
s_mul_i32 s67, s67, 4608
s_mul_i32 s68, s59, 82944
s_add_u32 s67, s67, s68
s_add_u32 s67, s67, 2097152
s_and_b32 s68, s58, 3
s_lshl_b32 s68, s68, 7
s_add_u32 s67, s67, s68
s_add_u32 s69, s67, 4096
s_add_u32 s67, s67, s68
ds_read_b64_tr_b16 v[80:81], v76 offset:36864
ds_read_b64_tr_b16 v[82:83], v76 offset:37440
ds_read_b64_tr_b16 v[84:85], v78 offset:36992
ds_read_b64_tr_b16 v[86:87], v78 offset:37568
ds_read_b64_tr_b16 v[88:89], v76 offset:38016
ds_read_b64_tr_b16 v[90:91], v76 offset:38592
ds_read_b64_tr_b16 v[92:93], v78 offset:38144
ds_read_b64_tr_b16 v[94:95], v78 offset:38720
ds_read_b64_tr_b16 v[96:97], v76 offset:39168
ds_read_b64_tr_b16 v[98:99], v76 offset:39744
ds_read_b64_tr_b16 v[100:101], v78 offset:39296
ds_read_b64_tr_b16 v[102:103], v78 offset:39872
s_waitcnt lgkmcnt(0)
s_cmp_ge_u32 s58, 8
s_cbranch_scc1 c3_38
s_add_u32 s68, s67, 73728
buffer_store_dwordx4 v[96:99], v79, s[4:7], s68 offen sc1
s_add_u32 s68, s69, 73728
s_mov_b64 exec, 0xff
buffer_store_dwordx4 v[100:103], v79, s[4:7], s68 offen sc1
s_mov_b64 exec, -1
c3_38:
s_add_u32 s68, s67, 0
buffer_store_dwordx4 v[80:83], v79, s[4:7], s68 offen sc1
s_add_u32 s68, s69, 0
s_mov_b64 exec, 0xff
buffer_store_dwordx4 v[84:87], v79, s[4:7], s68 offen sc1
s_mov_b64 exec, -1
s_add_u32 s68, s67, 36864
buffer_store_dwordx4 v[88:91], v79, s[4:7], s68 offen sc1
s_add_u32 s68, s69, 36864
s_mov_b64 exec, 0xff
buffer_store_dwordx4 v[92:95], v79, s[4:7], s68 offen sc1
s_mov_b64 exec, -1
s_add_u32 s89, s93, 0
buffer_load_dwordx4 a[0:3], v14, s[4:7], s89 offen offset:0 sc1
buffer_load_dwordx4 a[8:11], v14, s[4:7], s89 offen offset:1024 sc1
s_waitcnt vmcnt(2)
s_lshl_b32 s67, s58, 7
s_lshl_b32 s68, s59, 2
s_add_u32 s67, s67, s68
s_add_u32 s67, s67, 8192
s_lshl_b32 s68, s56, 7
s_lshl_b32 s69, s57, 2
s_add_u32 s68, s68, s69
s_add_u32 s68, s68, 7168
s_lshl_b32 s69, s59, 7
s_lshl_b32 s70, s58, 2
s_add_u32 s69, s69, s70
s_add_u32 s69, s69, 12288
s_cmp_eq_u32 s97, 0
s_cbranch_scc1 slow_39
s_mov_b64 exec, 1
v_mov_b32 v26, s62
buffer_store_dword v26, off, s[4:7], s67 offset:0
s_mov_b64 exec, -1
back_40:
s_cmp_eq_u32 s97, 0
s_cbranch_scc1 slow_41
s_mov_b64 exec, 1
v_mov_b32 v26, s62
buffer_store_dword v26, off, s[4:7], s68 offset:0
s_mov_b64 exec, -1
back_42:
s_mov_b64 exec, 1
v_mov_b32 v26, s62
buffer_store_dword v26, off, s[4:7], s69 offset:0 sc1
s_mov_b64 exec, -1
s_add_u32 s89, s93, 2048
buffer_load_dwordx4 a[16:19], v14, s[4:7], s89 offen offset:0 sc1
buffer_load_dwordx4 a[24:27], v14, s[4:7], s89 offen offset:1024 sc1
s_add_u32 s89, s93, 4096
buffer_load_dwordx4 a[32:35], v14, s[4:7], s89 offen offset:0 sc1
buffer_load_dwordx4 a[40:43], v14, s[4:7], s89 offen offset:1024 sc1
s_add_u32 s89, s93, 6144
buffer_load_dwordx4 a[48:51], v14, s[4:7], s89 offen offset:0 sc1
buffer_load_dwordx4 a[56:59], v14, s[4:7], s89 offen offset:1024 sc1
s_add_u32 s89, s93, 8192
buffer_load_dwordx4 a[64:67], v14, s[4:7], s89 offen offset:0 sc1
buffer_load_dwordx4 a[72:75], v14, s[4:7], s89 offen offset:1024 sc1
s_add_u32 s89, s93, 10240
buffer_load_dwordx4 a[80:83], v14, s[4:7], s89 offen offset:0 sc1
buffer_load_dwordx4 a[88:91], v14, s[4:7], s89 offen offset:1024 sc1
s_add_u32 s89, s93, 12288
buffer_load_dwordx4 a[96:99], v14, s[4:7], s89 offen offset:0 sc1
buffer_load_dwordx4 a[104:107], v14, s[4:7], s89 offen offset:1024 sc1
s_add_u32 s89, s93, 14336
buffer_load_dwordx4 a[112:115], v14, s[4:7], s89 offen offset:0 sc1
buffer_load_dwordx4 a[120:123], v14, s[4:7], s89 offen offset:1024 sc1
s_add_u32 s89, s93, 16384
buffer_load_dwordx4 a[128:131], v14, s[4:7], s89 offen offset:0 sc1
buffer_load_dwordx4 a[136:139], v14, s[4:7], s89 offen offset:1024 sc1
s_add_u32 s89, s93, 18432
buffer_load_dwordx4 a[144:147], v14, s[4:7], s89 offen offset:0 sc1
buffer_load_dwordx4 a[152:155], v14, s[4:7], s89 offen offset:1024 sc1
s_add_u32 s89, s93, 20480
buffer_load_dwordx4 a[160:163], v14, s[4:7], s89 offen offset:0 sc1
buffer_load_dwordx4 a[168:171], v14, s[4:7], s89 offen offset:1024 sc1
s_add_u32 s89, s93, 22528
buffer_load_dwordx4 a[176:179], v14, s[4:7], s89 offen offset:0 sc1
buffer_load_dwordx4 a[184:187], v14, s[4:7], s89 offen offset:1024 sc1
s_add_u32 s89, s93, 24576
buffer_load_dwordx4 a[192:195], v14, s[4:7], s89 offen offset:0 sc1
buffer_load_dwordx4 a[200:203], v14, s[4:7], s89 offen offset:1024 sc1
s_add_u32 s89, s93, 26624
buffer_load_dwordx4 a[208:211], v14, s[4:7], s89 offen offset:0 sc1
buffer_load_dwordx4 a[216:219], v14, s[4:7], s89 offen offset:1024 sc1
s_add_u32 s89, s93, 28672
buffer_load_dwordx4 a[224:227], v14, s[4:7], s89 offen offset:0 sc1
buffer_load_dwordx4 a[232:235], v14, s[4:7], s89 offen offset:1024 sc1
s_add_u32 s89, s93, 30720
buffer_load_dwordx4 a[240:243], v14, s[4:7], s89 offen offset:0 sc1
buffer_load_dwordx4 a[248:251], v14, s[4:7], s89 offen offset:1024 sc1
s_add_u32 s89, s93, 32768
buffer_load_dwordx4 v[224:227], v14, s[4:7], s89 offen offset:0 sc1
buffer_load_dwordx4 v[232:235], v14, s[4:7], s89 offen offset:1024 sc1
s_add_u32 s89, s93, 34816
buffer_load_dwordx4 v[240:243], v14, s[4:7], s89 offen offset:0 sc1
buffer_load_dwordx4 v[248:251], v14, s[4:7], s89 offen offset:1024 sc1
v_and_b32 v26, 31, v1
s_lshl_b32 s66, s56, 7
s_add_u32 s66, s66, 7168
v_lshl_add_u32 v26, v26, 2, s66
v_and_b32 v27, 7, v1
s_lshl_b32 s67, s58, 7
s_add_u32 s67, s67, 8192
v_lshl_add_u32 v27, v27, 2, s67
v_cmp_gt_u32 vcc, 32, v1
s_nop 1
v_cndmask_b32 v26, v27, v26, vcc
s_waitcnt vmcnt(0)
s_mov_b32 s75, 0
poll_43:
buffer_load_dword v27, v26, s[4:7], 0 offen offset:0 sc1
s_add_u32 s75, s75, 1
s_waitcnt vmcnt(0)
v_cmp_ne_u32 vcc, s62, v27
s_cmp_gt_u32 s75, 200000
s_cbranch_scc1 polle_44
s_cbranch_vccnz poll_43
polle_44:
s_mov_b64 exec, 1
v_mov_b32 v26, 157724
v_mov_b32 v27, 1
ds_add_u32 v26, v27
s_mov_b64 exec, -1
s_branch w2_45
w_25:
s_waitcnt vmcnt(0) lgkmcnt(0)
s_lshl_b32 s66, s59, 7
s_lshl_b32 s67, s58, 2
s_add_u32 s67, s67, s66
s_add_u32 s67, s67, 5120
s_mov_b64 exec, 1
v_mov_b32 v26, 157696
v_mov_b32 v27, 1
ds_add_rtn_u32 v27, v26, v27
s_mov_b64 exec, -1
s_waitcnt lgkmcnt(0)
v_readfirstlane_b32 s71, v27
s_cmp_lg_u32 s71, 3
s_cbranch_scc1 nl_46
v_lshlrev_b32 v26, 10, v1
v_mov_b32 v27, s62
s_mov_b64 exec, 3
buffer_store_dword v27, v26, s[4:7], s67 offen sc1
s_mov_b64 exec, -1
nl_46:
v_mov_b32 v26, 157704
s_mov_b32 s75, 0
lw_47:
ds_read_b32 v27, v26
s_add_u32 s75, s75, 1
s_waitcnt lgkmcnt(0)
v_readfirstlane_b32 s71, v27
s_cmp_gt_u32 s75, 4000000
s_cbranch_scc1 lwe_48
s_cmp_lt_u32 s71, 1
s_cbranch_scc1 lw_47
lwe_48:
s_add_u32 s89, s93, 0
buffer_load_dwordx4 a[0:3], v14, s[4:7], s89 offen offset:0 sc1
buffer_load_dwordx4 a[8:11], v14, s[4:7], s89 offen offset:1024 sc1
s_add_u32 s89, s93, 2048
buffer_load_dwordx4 a[16:19], v14, s[4:7], s89 offen offset:0 sc1
buffer_load_dwordx4 a[24:27], v14, s[4:7], s89 offen offset:1024 sc1
s_add_u32 s89, s93, 4096
buffer_load_dwordx4 a[32:35], v14, s[4:7], s89 offen offset:0 sc1
buffer_load_dwordx4 a[40:43], v14, s[4:7], s89 offen offset:1024 sc1
s_add_u32 s89, s93, 6144
buffer_load_dwordx4 a[48:51], v14, s[4:7], s89 offen offset:0 sc1
buffer_load_dwordx4 a[56:59], v14, s[4:7], s89 offen offset:1024 sc1
s_add_u32 s89, s93, 8192
buffer_load_dwordx4 a[64:67], v14, s[4:7], s89 offen offset:0 sc1
buffer_load_dwordx4 a[72:75], v14, s[4:7], s89 offen offset:1024 sc1
s_add_u32 s89, s93, 10240
buffer_load_dwordx4 a[80:83], v14, s[4:7], s89 offen offset:0 sc1
buffer_load_dwordx4 a[88:91], v14, s[4:7], s89 offen offset:1024 sc1
s_add_u32 s89, s93, 12288
buffer_load_dwordx4 a[96:99], v14, s[4:7], s89 offen offset:0 sc1
buffer_load_dwordx4 a[104:107], v14, s[4:7], s89 offen offset:1024 sc1
s_add_u32 s89, s93, 14336
buffer_load_dwordx4 a[112:115], v14, s[4:7], s89 offen offset:0 sc1
buffer_load_dwordx4 a[120:123], v14, s[4:7], s89 offen offset:1024 sc1
s_add_u32 s89, s93, 16384
buffer_load_dwordx4 a[128:131], v14, s[4:7], s89 offen offset:0 sc1
buffer_load_dwordx4 a[136:139], v14, s[4:7], s89 offen offset:1024 sc1
s_add_u32 s89, s93, 18432
buffer_load_dwordx4 a[144:147], v14, s[4:7], s89 offen offset:0 sc1
buffer_load_dwordx4 a[152:155], v14, s[4:7], s89 offen offset:1024 sc1
s_add_u32 s89, s93, 20480
buffer_load_dwordx4 a[160:163], v14, s[4:7], s89 offen offset:0 sc1
buffer_load_dwordx4 a[168:171], v14, s[4:7], s89 offen offset:1024 sc1
s_add_u32 s89, s93, 22528
buffer_load_dwordx4 a[176:179], v14, s[4:7], s89 offen offset:0 sc1
buffer_load_dwordx4 a[184:187], v14, s[4:7], s89 offen offset:1024 sc1
s_add_u32 s89, s93, 24576
buffer_load_dwordx4 a[192:195], v14, s[4:7], s89 offen offset:0 sc1
buffer_load_dwordx4 a[200:203], v14, s[4:7], s89 offen offset:1024 sc1
s_add_u32 s89, s93, 26624
buffer_load_dwordx4 a[208:211], v14, s[4:7], s89 offen offset:0 sc1
buffer_load_dwordx4 a[216:219], v14, s[4:7], s89 offen offset:1024 sc1
s_add_u32 s89, s93, 28672
buffer_load_dwordx4 a[224:227], v14, s[4:7], s89 offen offset:0 sc1
buffer_load_dwordx4 a[232:235], v14, s[4:7], s89 offen offset:1024 sc1
s_add_u32 s89, s93, 30720
buffer_load_dwordx4 a[240:243], v14, s[4:7], s89 offen offset:0 sc1
buffer_load_dwordx4 a[248:251], v14, s[4:7], s89 offen offset:1024 sc1
s_add_u32 s89, s93, 32768
buffer_load_dwordx4 v[224:227], v14, s[4:7], s89 offen offset:0 sc1
buffer_load_dwordx4 v[232:235], v14, s[4:7], s89 offen offset:1024 sc1
s_add_u32 s89, s93, 34816
buffer_load_dwordx4 v[240:243], v14, s[4:7], s89 offen offset:0 sc1
buffer_load_dwordx4 v[248:251], v14, s[4:7], s89 offen offset:1024 sc1
w2_45:
s_waitcnt lgkmcnt(0)
v_mov_b32 v26, 157700
s_mov_b32 s75, 0
lw_49:
ds_read_b32 v27, v26
s_add_u32 s75, s75, 1
s_waitcnt lgkmcnt(0)
v_readfirstlane_b32 s71, v27
s_cmp_gt_u32 s75, 4000000
s_cbranch_scc1 lwe_50
s_cmp_lt_u32 s71, 1
s_cbranch_scc1 lw_49
lwe_50:
s_sub_u32 s97, s71, 1
v_and_b32 v26, 15, v1
s_lshl_b32 s66, s61, 4
v_add_u32 v27, s66, v26
v_mul_u32_u24 v27, 144, v27
v_lshrrev_b32 v28, 4, v1
v_lshl_add_u32 v27, v28, 3, v27
ds_read_b64 v[2:3], v27 offset:20480
ds_read_b64 v[4:5], v27 offset:20512
ds_read_b64 v[6:7], v27 offset:20544
ds_read_b64 v[8:9], v27 offset:20576
ds_read_b64 v[10:11], v27 offset:20608
v_and_b32 v27, 1, v26
v_lshlrev_b32 v27, 7, v27
v_lshrrev_b32 v28, 3, v26
v_lshl_add_u32 v27, v28, 6, v27
v_bfe_u32 v28, v26, 1, 2
v_lshl_add_u32 v26, v28, 4, v27
s_lshl_b32 s66, s61, 8
s_add_u32 s66, s66, 156672
v_add_u32 v26, s66, v26
v_lshrrev_b32 v27, 1, v1
v_lshlrev_b32 v27, 7, v27
v_and_b32 v28, 1, v1
v_lshl_add_u32 v27, v28, 4, v27
v_mov_b32 v28, 0x40000000
v_cmp_gt_u32 vcc, 16, v1
s_nop 1
v_cndmask_b32 v29, v28, v27, vcc
s_mul_i32 s70, s61, 3072
v_lshl_add_u32 v30, v1, 3, s70
s_mul_i32 s69, s58, 73728
s_mul_i32 s67, s59, 9216
s_add_u32 s69, s69, s67
s_lshl_b32 s67, s61, 5
s_add_u32 s69, s69, s67
s_add_u32 s69, s69, 9175040
v_lshrrev_b32 v28, 4, v1
v_mul_u32_u24 v28, 504, v28
v_sub_u32 v223, v12, v28
v_and_b32 v68, 15, v1
v_lshlrev_b32 v68, 3, v68
v_lshrrev_b32 v69, 4, v1
v_lshl_add_u32 v68, v69, 10, v68
s_lshl_b32 s67, s58, 12
s_lshl_b32 s68, s61, 7
s_add_u32 s67, s67, s68
s_add_u32 s67, s67, 262144
s_mov_b32 s96, s67
s_add_u32 s91, s69, 4096
s_add_u32 s90, s69, 8192
v_bfe_u32 v176, v1, 2, 1
v_lshrrev_b32 v177, 5, v1
v_cmp_eq_u32 vcc, v176, v177
v_bfe_u32 v176, v1, 3, 2
v_and_b32 v177, 3, v1
v_lshl_add_u32 v176, v176, 2, v177
v_mov_b32 v177, -64
v_cndmask_b32 v176, v177, v176, vcc
v_add_u32 v177, -8, v176
v_and_b32 v178, 1, v176
v_cmp_eq_u32 vcc, 1, v178
v_mov_b32 v178, s82
v_mov_b32 v179, s83
v_cndmask_b32 v178, v178, v179, vcc
v_ashrrev_i32 v179, 1, v176
v_cmp_eq_u32 vcc, 0, v179
s_nop 1
v_cndmask_b32 v212, 0, v178, vcc
v_cmp_eq_u32 vcc, 1, v179
s_nop 1
v_cndmask_b32 v213, 0, v178, vcc
v_cmp_eq_u32 vcc, 2, v179
s_nop 1
v_cndmask_b32 v214, 0, v178, vcc
v_cmp_eq_u32 vcc, 3, v179
s_nop 1
v_cndmask_b32 v215, 0, v178, vcc
v_and_b32 v178, 1, v177
v_cmp_eq_u32 vcc, 1, v178
v_mov_b32 v178, s82
v_mov_b32 v179, s83
v_cndmask_b32 v178, v178, v179, vcc
v_ashrrev_i32 v179, 1, v177
v_cmp_eq_u32 vcc, 0, v179
s_nop 1
v_cndmask_b32 v216, 0, v178, vcc
v_cmp_eq_u32 vcc, 1, v179
s_nop 1
v_cndmask_b32 v217, 0, v178, vcc
v_cmp_eq_u32 vcc, 2, v179
s_nop 1
v_cndmask_b32 v218, 0, v178, vcc
v_cmp_eq_u32 vcc, 3, v179
s_nop 1
v_cndmask_b32 v219, 0, v178, vcc
s_waitcnt lgkmcnt(0)
v_lshlrev_b32 v76, 16, v2
v_and_b32 v77, s63, v2
v_lshlrev_b32 v78, 16, v3
v_and_b32 v79, s63, v3
v_lshlrev_b32 v80, 16, v4
v_and_b32 v81, s63, v4
v_lshlrev_b32 v82, 16, v5
v_and_b32 v83, s63, v5
v_lshlrev_b32 v84, 16, v6
v_and_b32 v85, s63, v6
v_lshlrev_b32 v86, 16, v7
v_and_b32 v87, s63, v7
v_lshlrev_b32 v88, 16, v8
v_and_b32 v89, s63, v8
v_lshlrev_b32 v90, 16, v9
v_and_b32 v91, s63, v9
v_lshlrev_b32 v92, 16, v10
v_and_b32 v93, s63, v10
v_lshlrev_b32 v94, 16, v11
v_and_b32 v95, s63, v11
convend_17:
v_mov_b32 v70, 157724
s_mov_b32 s75, 0
lw_51:
ds_read_b32 v71, v70
s_add_u32 s75, s75, 1
s_waitcnt lgkmcnt(0)
v_readfirstlane_b32 s71, v71
s_cmp_gt_u32 s75, 4000000
s_cbranch_scc1 lwe_52
s_cmp_lt_u32 s71, 1
s_cbranch_scc1 lw_51
lwe_52:
s_mov_b32 s67, s96
buffer_load_dwordx2 v[64:65], v68, s[4:7], s67 offen sc1
buffer_load_dwordx2 v[66:67], v68, s[4:7], s67 offen offset:512 sc1
s_add_u32 m0, s70, 0
s_nop 0
buffer_load_dwordx4 v27, s[4:7], s69 offen sc1 lds
s_add_u32 m0, s70, 1024
s_nop 0
buffer_load_dwordx4 v27, s[4:7], s91 offen sc1 lds
s_add_u32 m0, s70, 2048
s_nop 0
buffer_load_dwordx4 v29, s[4:7], s90 offen sc1 lds
s_cmp_eq_u32 s85, 0
s_cbranch_scc1 pf_53
s_add_u32 s89, s93, 28672
buffer_load_dwordx4 a[224:227], v14, s[4:7], s89 offen offset:0 sc1
buffer_load_dwordx4 a[232:235], v14, s[4:7], s89 offen offset:1024 sc1
s_add_u32 s89, s93, 30720
buffer_load_dwordx4 a[240:243], v14, s[4:7], s89 offen offset:0 sc1
buffer_load_dwordx4 a[248:251], v14, s[4:7], s89 offen offset:1024 sc1
s_add_u32 s89, s93, 32768
buffer_load_dwordx4 v[224:227], v14, s[4:7], s89 offen offset:0 sc1
buffer_load_dwordx4 v[232:235], v14, s[4:7], s89 offen offset:1024 sc1
s_add_u32 s89, s93, 34816
buffer_load_dwordx4 v[240:243], v14, s[4:7], s89 offen offset:0 sc1
buffer_load_dwordx4 v[248:251], v14, s[4:7], s89 offen offset:1024 sc1
pfe_54:
s_waitcnt vmcnt(8)
s_mov_b32 s75, 0
py_55:
ds_read_b64_tr_b16 v[16:17], v30 offset:0
ds_read_b64_tr_b16 v[18:19], v30 offset:512
ds_read_b64_tr_b16 v[20:21], v30 offset:1024
ds_read_b64_tr_b16 v[22:23], v30 offset:1536
ds_read_b64_tr_b16 v[24:25], v30 offset:2048
s_waitcnt lgkmcnt(4)
v_lshlrev_b32 v116, 16, v16
v_and_b32 v117, s63, v16
v_lshlrev_b32 v118, 16, v17
v_and_b32 v119, s63, v17
v_max3_u32 v28, v116, v117, v118
v_max_u32 v28, v28, v119
s_waitcnt lgkmcnt(3)
v_lshlrev_b32 v120, 16, v18
v_and_b32 v121, s63, v18
v_lshlrev_b32 v122, 16, v19
v_and_b32 v123, s63, v19
v_max3_u32 v28, v28, v120, v121
v_max3_u32 v28, v28, v122, v123
s_waitcnt lgkmcnt(2)
v_lshlrev_b32 v124, 16, v20
v_and_b32 v125, s63, v20
v_lshlrev_b32 v126, 16, v21
v_and_b32 v127, s63, v21
v_max3_u32 v28, v28, v124, v125
v_max3_u32 v28, v28, v126, v127
s_waitcnt lgkmcnt(1)
v_lshlrev_b32 v128, 16, v22
v_and_b32 v129, s63, v22
v_lshlrev_b32 v130, 16, v23
v_and_b32 v131, s63, v23
v_max3_u32 v28, v28, v128, v129
v_max3_u32 v28, v28, v130, v131
s_waitcnt lgkmcnt(0)
v_lshlrev_b32 v132, 16, v24
v_and_b32 v133, s63, v24
v_lshlrev_b32 v134, 16, v25
v_and_b32 v135, s63, v25
v_max3_u32 v28, v28, v132, v133
v_max3_u32 v28, v28, v134, v135
v_cmp_eq_u32 vcc, s63, v28
s_cbranch_vccnz po_56
pk_57:
s_lshl_b32 s66, s74, 13
s_add_u32 s66, s66, 1835008
s_add_u32 s67, s66, 4096
buffer_load_dwordx4 v[144:147], v14, s[4:7], s66 offen offset:0 sc1
buffer_load_dwordx4 v[148:151], v14, s[4:7], s66 offen offset:1024 sc1
buffer_load_dwordx4 v[152:155], v14, s[4:7], s66 offen offset:2048 sc1
buffer_load_dwordx4 v[156:159], v14, s[4:7], s66 offen offset:3072 sc1
buffer_load_dwordx4 v[160:163], v14, s[4:7], s67 offen offset:0 sc1
buffer_load_dwordx4 v[164:167], v14, s[4:7], s67 offen offset:1024 sc1
buffer_load_dwordx4 v[168:171], v14, s[4:7], s67 offen offset:2048 sc1
buffer_load_dwordx4 v[172:175], v14, s[4:7], s67 offen offset:3072 sc1
s_mov_b32 s92, s91
s_mul_i32 s91, s59, 18432
s_add_u32 s91, s91, s95
s_add_u32 s91, s91, 2883584
s_cmp_lt_u32 s61, 2
s_cselect_b32 s71, 0, 0x40000000
v_or_b32 v180, s71, v14
buffer_load_dwordx4 v[192:195], v14, s[4:7], s91 offen sc1
s_add_u32 s91, s91, 4096
buffer_load_dwordx4 v[196:199], v14, s[4:7], s91 offen sc1
s_add_u32 s91, s91, 4096
buffer_load_dwordx4 v[200:203], v14, s[4:7], s91 offen sc1
s_add_u32 s91, s91, 4096
buffer_load_dwordx4 v[204:207], v14, s[4:7], s91 offen sc1
s_add_u32 s91, s91, 4096
buffer_load_dwordx4 v[208:211], v180, s[4:7], s91 offen sc1
s_mov_b32 s91, s92
v_pk_add_f32 v[64:65], v[64:65], v[66:67]
s_mov_b32 s68, 987991609
s_nop 0
v_permlane16_swap_b32 v64, v65
v_add_f32 v64, v64, v65
v_mov_b32 v65, v64
s_nop 1
v_permlane32_swap_b32 v64, v65
v_add_f32 v64, v64, v65
v_mul_f32 v64, 987991609, v64
v_mov_b32 v65, v64
s_nop 1
v_permlane16_swap_b32 v64, v65
v_fma_f32 v65, -v64, v64, v65
v_max_f32 v65, 0, v65
v_add_f32 v65, 925353388, v65
v_rsq_f32 v136, v65
s_nop 0
v_mul_f32 v137, -v64, v136
v_pk_fma_f32 v[96:97], v[76:77], v[136:137], v[136:137] op_sel:[0,0,1] op_sel_hi:[1,0,1]
v_pk_fma_f32 v[98:99], v[78:79], v[136:137], v[136:137] op_sel:[0,0,1] op_sel_hi:[1,0,1]
v_pk_fma_f32 v[100:101], v[80:81], v[136:137], v[136:137] op_sel:[0,0,1] op_sel_hi:[1,0,1]
v_pk_fma_f32 v[102:103], v[82:83], v[136:137], v[136:137] op_sel:[0,0,1] op_sel_hi:[1,0,1]
v_pk_fma_f32 v[104:105], v[84:85], v[136:137], v[136:137] op_sel:[0,0,1] op_sel_hi:[1,0,1]
v_pk_fma_f32 v[106:107], v[86:87], v[136:137], v[136:137] op_sel:[0,0,1] op_sel_hi:[1,0,1]
v_pk_fma_f32 v[108:109], v[88:89], v[136:137], v[136:137] op_sel:[0,0,1] op_sel_hi:[1,0,1]
v_pk_fma_f32 v[110:111], v[90:91], v[136:137], v[136:137] op_sel:[0,0,1] op_sel_hi:[1,0,1]
v_pk_fma_f32 v[112:113], v[92:93], v[136:137], v[136:137] op_sel:[0,0,1] op_sel_hi:[1,0,1]
v_pk_fma_f32 v[114:115], v[94:95], v[136:137], v[136:137] op_sel:[0,0,1] op_sel_hi:[1,0,1]
s_mul_i32 s66, s59, 4608
s_add_u32 s66, s66, s94
s_add_u32 s68, s66, 4096
v_pk_fma_f32 v[76:77], v[96:97], v[116:117], v[76:77]
v_pk_fma_f32 v[78:79], v[98:99], v[118:119], v[78:79]
v_pk_fma_f32 v[80:81], v[100:101], v[120:121], v[80:81]
v_pk_fma_f32 v[82:83], v[102:103], v[122:123], v[82:83]
v_pk_fma_f32 v[84:85], v[104:105], v[124:125], v[84:85]
v_pk_fma_f32 v[86:87], v[106:107], v[126:127], v[86:87]
v_pk_fma_f32 v[88:89], v[108:109], v[128:129], v[88:89]
v_pk_fma_f32 v[90:91], v[110:111], v[130:131], v[90:91]
v_pk_fma_f32 v[92:93], v[112:113], v[132:133], v[92:93]
v_pk_fma_f32 v[94:95], v[114:115], v[134:135], v[94:95]
v_cvt_pk_bf16_f32 v2, v76, v77
v_cvt_pk_bf16_f32 v3, v78, v79
v_cvt_pk_bf16_f32 v4, v80, v81
v_cvt_pk_bf16_f32 v5, v82, v83
v_cvt_pk_bf16_f32 v6, v84, v85
v_cvt_pk_bf16_f32 v7, v86, v87
v_cvt_pk_bf16_f32 v8, v88, v89
v_cvt_pk_bf16_f32 v9, v90, v91
v_cvt_pk_bf16_f32 v10, v92, v93
v_cvt_pk_bf16_f32 v11, v94, v95
s_cmp_eq_u32 s97, 0
s_cbranch_scc1 slow_58
buffer_store_dwordx4 v[2:5], v12, s[4:7], s66 offen
buffer_store_dwordx4 v[6:9], v12, s[4:7], s66 offen offset:2048
s_mov_b32 exec_hi, 0
buffer_store_dwordx2 v[10:11], v223, s[4:7], s68 offen
s_mov_b32 exec_hi, -1
back_59:
s_mov_b32 exec_lo, 0
v_mov_b32 v92, 0
v_mov_b32 v93, 0
v_mov_b32 v94, 0
v_mov_b32 v95, 0
s_mov_b32 exec_lo, -1
v_pk_add_f32 v[140:141], v[76:77], v[78:79]
v_pk_mul_f32 v[142:143], v[76:77], v[76:77]
v_pk_fma_f32 v[142:143], v[78:79], v[78:79], v[142:143]
v_pk_add_f32 v[140:141], v[140:141], v[80:81]
v_pk_fma_f32 v[142:143], v[80:81], v[80:81], v[142:143]
v_pk_add_f32 v[140:141], v[140:141], v[82:83]
v_pk_fma_f32 v[142:143], v[82:83], v[82:83], v[142:143]
v_pk_add_f32 v[140:141], v[140:141], v[84:85]
v_pk_fma_f32 v[142:143], v[84:85], v[84:85], v[142:143]
v_pk_add_f32 v[140:141], v[140:141], v[86:87]
v_pk_fma_f32 v[142:143], v[86:87], v[86:87], v[142:143]
v_pk_add_f32 v[140:141], v[140:141], v[88:89]
v_pk_fma_f32 v[142:143], v[88:89], v[88:89], v[142:143]
v_pk_add_f32 v[140:141], v[140:141], v[90:91]
v_pk_fma_f32 v[142:143], v[90:91], v[90:91], v[142:143]
v_pk_add_f32 v[140:141], v[140:141], v[92:93]
v_pk_fma_f32 v[142:143], v[92:93], v[92:93], v[142:143]
v_pk_add_f32 v[140:141], v[140:141], v[94:95]
v_pk_fma_f32 v[142:143], v[94:95], v[94:95], v[142:143]
v_add_f32 v140, v140, v141
v_add_f32 v142, v142, v143
s_lshl_b32 s67, s58, 3
s_add_u32 s67, s67, s59
v_permlane16_swap_b32 v140, v142
v_add_f32 v140, v140, v142
v_mov_b32 v142, v140
s_lshl_b32 s67, s67, 9
s_add_u32 s67, s67, 393216
v_permlane32_swap_b32 v140, v142
v_add_f32 v140, v140, v142
v_min_u32 v140, -2, v140
s_mov_b32 exec_hi, 0
s_cmp_eq_u32 s97, 0
s_cbranch_scc1 slow_60
buffer_store_dword v140, v13, s[4:7], s67 offen
back_61:
s_mov_b32 exec_hi, -1
s_lshl_b32 s71, s59, 2
s_add_u32 s71, s71, s98
v_and_b32 v142, 7, v1
v_lshlrev_b32 v142, 2, v142
s_waitcnt vmcnt(0)
s_barrier
s_cmp_lg_u32 s61, 0
s_cbranch_scc1 w_62
s_cmp_eq_u32 s97, 0
s_cbranch_scc1 slow_63
s_mov_b64 exec, 1
v_mov_b32 v140, s62
buffer_store_dword v140, off, s[4:7], s71 offset:0
s_mov_b64 exec, -1
back_64:
w_62:
v_pk_add_f32 v[144:145], v[144:145], v[148:149]
v_pk_add_f32 v[146:147], v[146:147], v[150:151]
v_pk_add_f32 v[144:145], v[144:145], v[152:153]
v_pk_add_f32 v[146:147], v[146:147], v[154:155]
v_pk_add_f32 v[144:145], v[144:145], v[156:157]
v_pk_add_f32 v[146:147], v[146:147], v[158:159]
v_pk_add_f32 v[144:145], v[144:145], v[160:161]
v_pk_add_f32 v[146:147], v[146:147], v[162:163]
v_pk_add_f32 v[144:145], v[144:145], v[164:165]
v_pk_add_f32 v[146:147], v[146:147], v[166:167]
v_pk_add_f32 v[144:145], v[144:145], v[168:169]
v_pk_add_f32 v[146:147], v[146:147], v[170:171]
v_pk_add_f32 v[144:145], v[144:145], v[172:173]
v_pk_add_f32 v[146:147], v[146:147], v[174:175]
v_mov_b32 v148, v144
v_mov_b32 v149, v145
v_mov_b32 v150, v146
v_mov_b32 v151, v147
v_permlane16_swap_b32 v144, v148
v_permlane16_swap_b32 v145, v149
v_permlane16_swap_b32 v146, v150
v_permlane16_swap_b32 v147, v151
v_pk_add_f32 v[144:145], v[144:145], v[148:149]
v_pk_add_f32 v[146:147], v[146:147], v[150:151]
v_mov_b32 v148, v144
v_mov_b32 v149, v145
v_mov_b32 v150, v146
v_mov_b32 v151, v147
v_permlane32_swap_b32 v144, v148
v_permlane32_swap_b32 v145, v149
v_permlane32_swap_b32 v146, v150
v_permlane32_swap_b32 v147, v151
v_pk_add_f32 v[144:145], v[144:145], v[148:149]
v_pk_add_f32 v[146:147], v[146:147], v[150:151]
s_mov_b64 exec, 0xffff
ds_write_b128 v26, v[144:147]
s_mov_b64 exec, -1
s_cmp_lg_u32 s61, 0
s_cbranch_scc1 w_65
s_waitcnt vmcnt(0)
s_mov_b32 s75, 0
poll_66:
buffer_load_dword v141, v142, s[4:7], s98 offen offset:0 sc1
s_add_u32 s75, s75, 1
s_waitcnt vmcnt(0)
v_cmp_ne_u32 vcc, s62, v141
s_cmp_gt_u32 s75, 200000
s_cbranch_scc1 polle_67
s_cbranch_vccnz poll_66
polle_67:
w_65:
s_barrier
L_layer0:
s_add_u32 s69, s94, s95
s_add_u32 m0, s95, 0
s_add_u32 s92, s69, 0
buffer_load_dwordx4 v14, s[4:7], s92 offen sc1 lds
s_add_u32 m0, s95, 4096
s_add_u32 s92, s69, 4096
buffer_load_dwordx4 v14, s[4:7], s92 offen sc1 lds
s_add_u32 m0, s95, 8192
s_add_u32 s92, s69, 8192
buffer_load_dwordx4 v14, s[4:7], s92 offen sc1 lds
s_add_u32 m0, s95, 12288
s_add_u32 s92, s69, 12288
buffer_load_dwordx4 v14, s[4:7], s92 offen sc1 lds
s_add_u32 m0, s95, 16384
s_add_u32 s92, s69, 16384
buffer_load_dwordx4 v14, s[4:7], s92 offen sc1 lds
s_add_u32 m0, s95, 20480
s_add_u32 s92, s69, 20480
buffer_load_dwordx4 v14, s[4:7], s92 offen sc1 lds
v_and_b32 v188, 15, v1
v_lshlrev_b32 v188, 3, v188
v_lshrrev_b32 v189, 4, v1
v_lshl_add_u32 v188, v189, 10, v188
s_lshl_b32 s67, s58, 12
s_lshl_b32 s68, s61, 7
s_add_u32 s67, s67, s68
s_add_u32 s67, s67, 393216
s_mov_b32 s70, s67
v_lshrrev_b32 v29, 5, v1
s_lshl_b32 s66, s61, 8
s_add_u32 s66, s66, 156672
v_lshl_add_u32 v223, v29, 7, s66
v_add_u32 v222, 36864, v14
ds_read_b128 v[128:131], v223 offset:0
ds_read_b128 v[132:135], v223 offset:16
ds_read_b128 v[136:139], v223 offset:32
ds_read_b128 v[140:143], v223 offset:48
ds_read2_b32 v[144:145], v223 offset0:25 offset1:26
v_mov_b32 v189, v223
v_lshrrev_b32 v26, 4, v1
v_and_b32 v27, 15, v1
v_lshlrev_b32 v28, 4, v27
v_lshl_add_u32 v28, v26, 9, v28
s_lshl_b32 s66, s61, 7
s_add_u32 s66, s66, 157952
v_lshl_add_u32 v191, v27, 3, s66
s_and_b32 s66, s61, 1
s_waitcnt vmcnt(5)
s_barrier
ds_read_b128 v[96:99], v14 offset:0
ds_read_b128 v[100:103], v14 offset:1024
ds_read_b128 v[104:107], v14 offset:2048
ds_read_b128 v[108:111], v14 offset:3072
s_waitcnt lgkmcnt(3)
v_mfma_f32_32x32x16_bf16 v[32:47], a[0:3], v[96:99], 0
s_waitcnt vmcnt(4)
s_barrier
ds_read_b128 v[112:115], v14 offset:4096
ds_read_b128 v[116:119], v14 offset:5120
s_lshl_b32 s66, s66, 8
s_lshl_b32 s71, s61, 11
s_add_u32 s66, s66, s71
s_waitcnt lgkmcnt(4)
v_mfma_f32_32x32x16_bf16 v[32:47], a[8:11], v[100:103], v[32:47]
ds_read_b128 v[120:123], v14 offset:6144
ds_read_b128 v[124:127], v14 offset:7168
s_add_u32 m0, s95, 24576
s_add_u32 s92, s69, 24576
buffer_load_dwordx4 v14, s[4:7], s92 offen sc1 lds
s_waitcnt lgkmcnt(5)
v_mfma_f32_32x32x16_bf16 v[32:47], a[16:19], v[104:107], v[32:47]
s_waitcnt vmcnt(3)
s_barrier
ds_read_b128 v[96:99], v14 offset:8192
s_cmp_lt_u32 s61, 2
s_cselect_b32 s90, 0x8000, 0
s_cselect_b32 s71, 0, 36864
s_cselect_b32 s68, 36864, 0
s_waitcnt lgkmcnt(5)
v_mfma_f32_32x32x16_bf16 v[32:47], a[24:27], v[108:111], v[32:47]
ds_read_b128 v[100:103], v14 offset:9216
s_mov_b32 s67, s70
buffer_load_dwordx2 v[184:185], v188, s[4:7], s67 offen sc1
buffer_load_dwordx2 v[186:187], v188, s[4:7], s67 offen offset:512 sc1
s_waitcnt lgkmcnt(5)
v_mfma_f32_32x32x16_bf16 v[32:47], a[32:35], v[112:115], v[32:47]
ds_read_b128 v[104:107], v14 offset:10240
s_add_u32 s71, s71, s66
s_add_u32 s68, s68, s66
v_add_u32 v164, s71, v28
v_add_u32 v166, s68, v28
s_waitcnt lgkmcnt(5)
v_mfma_f32_32x32x16_bf16 v[32:47], a[40:43], v[116:119], v[32:47]
ds_read_b128 v[108:111], v14 offset:11264
s_add_u32 m0, s95, 28672
s_add_u32 s92, s69, 28672
buffer_load_dwordx4 v14, s[4:7], s92 offen sc1 lds
s_waitcnt lgkmcnt(5)
v_mfma_f32_32x32x16_bf16 v[32:47], a[48:51], v[120:123], v[32:47]
ds_read_b128 v[112:115], v14 offset:12288
v_xor_b32 v165, 0x100, v164
v_xor_b32 v167, 0x100, v166
v_bfe_u32 v26, v1, 4, 1
v_lshlrev_b32 v190, 4, v27
s_waitcnt lgkmcnt(5)
v_mfma_f32_32x32x16_bf16 v[32:47], a[56:59], v[124:127], v[32:47]
ds_read_b128 v[116:119], v14 offset:13312
s_add_u32 m0, s95, 32768
s_add_u32 s92, s69, 32768
buffer_load_dwordx4 v14, s[4:7], s92 offen sc1 lds
s_waitcnt lgkmcnt(5)
v_mfma_f32_32x32x16_bf16 v[32:47], a[64:67], v[96:99], v[32:47]
ds_read_b128 v[120:123], v14 offset:14336
v_lshl_add_u32 v190, v26, 10, v190
v_lshrrev_b32 v26, 5, v1
v_lshl_add_u32 v190, v26, 3, v190
s_lshl_b32 s66, s61, 8
s_waitcnt lgkmcnt(5)
v_mfma_f32_32x32x16_bf16 v[32:47], a[72:75], v[100:103], v[32:47]
ds_read_b128 v[124:127], v14 offset:15360
s_add_u32 m0, s95, 36864
s_add_u32 s92, s69, 36864
buffer_load_dwordx4 v14, s[4:7], s92 offen sc1 lds
s_waitcnt lgkmcnt(4)
v_mfma_f32_32x32x16_bf16 v[32:47], a[80:83], v[104:107], v[32:47]
s_waitcnt vmcnt(6)
s_barrier
ds_read_b128 v[96:99], v14 offset:16384
s_add_u32 s66, s66, 159744
v_add_u32 v190, s66, v190
v_mov_b32 v80, v192
v_mov_b32 v81, v193
v_mfma_f32_32x32x16_bf16 v[32:47], a[88:91], v[108:111], v[32:47]
ds_read_b128 v[100:103], v14 offset:17408
s_add_u32 m0, s95, 40960
s_add_u32 s92, s69, 40960
buffer_load_dwordx4 v14, s[4:7], s92 offen sc1 lds
s_waitcnt lgkmcnt(4)
v_mfma_f32_32x32x16_bf16 v[32:47], a[96:99], v[112:115], v[32:47]
ds_read_b128 v[104:107], v14 offset:18432
v_mov_b32 v82, v194
v_mov_b32 v83, v195
v_mov_b32 v84, v196
v_mov_b32 v85, v197
v_mfma_f32_32x32x16_bf16 v[32:47], a[104:107], v[116:119], v[32:47]
ds_read_b128 v[108:111], v14 offset:19456
s_add_u32 m0, s95, 45056
s_add_u32 s92, s69, 45056
buffer_load_dwordx4 v14, s[4:7], s92 offen sc1 lds
s_waitcnt lgkmcnt(4)
v_mfma_f32_32x32x16_bf16 v[32:47], a[112:115], v[120:123], v[32:47]
ds_read_b128 v[112:115], v14 offset:20480
v_mov_b32 v86, v198
v_mov_b32 v87, v199
v_mfma_f32_32x32x16_bf16 v[32:47], a[120:123], v[124:127], v[32:47]
ds_read_b128 v[116:119], v14 offset:21504
s_add_u32 m0, s95, 49152
s_add_u32 s92, s69, 49152
buffer_load_dwordx4 v14, s[4:7], s92 offen sc1 lds
s_waitcnt lgkmcnt(4)
v_mfma_f32_32x32x16_bf16 v[32:47], a[128:131], v[96:99], v[32:47]
ds_read_b128 v[120:123], v14 offset:22528
v_mfma_f32_32x32x16_bf16 v[32:47], a[136:139], v[100:103], v[32:47]
ds_read_b128 v[124:127], v14 offset:23552
s_add_u32 m0, s95, 53248
s_add_u32 s92, s69, 53248
buffer_load_dwordx4 v14, s[4:7], s92 offen sc1 lds
s_waitcnt lgkmcnt(4)
v_mfma_f32_32x32x16_bf16 v[32:47], a[144:147], v[104:107], v[32:47]
s_waitcnt vmcnt(5)
s_barrier
ds_read_b128 v[96:99], v14 offset:24576
v_mfma_f32_32x32x16_bf16 v[32:47], a[152:155], v[108:111], v[32:47]
ds_read_b128 v[100:103], v14 offset:25600
s_add_u32 m0, s95, 57344
s_add_u32 s92, s69, 57344
buffer_load_dwordx4 v14, s[4:7], s92 offen sc1 lds
s_waitcnt lgkmcnt(4)
v_mfma_f32_32x32x16_bf16 v[32:47], a[160:163], v[112:115], v[32:47]
ds_read_b128 v[104:107], v14 offset:26624
v_add_f32 v184, v184, v186
v_add_f32 v185, v185, v187
s_nop 1
v_permlane16_swap_b32 v184, v185
v_mfma_f32_32x32x16_bf16 v[32:47], a[168:171], v[116:119], v[32:47]
ds_read_b128 v[108:111], v14 offset:27648
s_add_u32 m0, s95, 61440
s_add_u32 s92, s69, 61440
buffer_load_dwordx4 v14, s[4:7], s92 offen sc1 lds
s_waitcnt lgkmcnt(4)
v_mfma_f32_32x32x16_bf16 v[32:47], a[176:179], v[120:123], v[32:47]
ds_read_b128 v[112:115], v14 offset:28672
v_add_f32 v184, v184, v185
v_mov_b32 v185, v184
s_nop 1
v_permlane32_swap_b32 v184, v185
v_mfma_f32_32x32x16_bf16 v[32:47], a[184:187], v[124:127], v[32:47]
ds_read_b128 v[116:119], v14 offset:29696
s_add_u32 m0, s95, 65536
s_add_u32 s92, s69, 65536
buffer_load_dwordx4 v14, s[4:7], s92 offen sc1 lds
s_waitcnt lgkmcnt(4)
v_mfma_f32_32x32x16_bf16 v[32:47], a[192:195], v[96:99], v[32:47]
ds_read_b128 v[120:123], v14 offset:30720
v_add_f32 v184, v184, v185
v_mul_f32 v184, 987991609, v184
v_mov_b32 v185, v184
s_nop 1
v_mfma_f32_32x32x16_bf16 v[32:47], a[200:203], v[100:103], v[32:47]
ds_read_b128 v[124:127], v14 offset:31744
s_add_u32 m0, s95, 69632
s_add_u32 s92, s69, 69632
buffer_load_dwordx4 v14, s[4:7], s92 offen sc1 lds
s_waitcnt lgkmcnt(4)
v_mfma_f32_32x32x16_bf16 v[32:47], a[208:211], v[104:107], v[32:47]
ds_read_b128 v[96:99], v14 offset:32768
v_permlane16_swap_b32 v184, v185
v_fma_f32 v185, -v184, v184, v185
v_max_f32 v185, 0, v185
v_add_f32 v185, 925353388, v185
v_mfma_f32_32x32x16_bf16 v[32:47], a[216:219], v[108:111], v[32:47]
ds_read_b128 v[100:103], v14 offset:33792
v_and_b32 v223, 31, v1
v_lshlrev_b32 v223, 2, v223
s_lshl_b32 s72, s59, 7
s_add_u32 s72, s72, 12288
buffer_load_dword v188, v223, s[4:7], s72 offen sc1
s_waitcnt lgkmcnt(4)
v_mfma_f32_32x32x16_bf16 v[32:47], a[224:227], v[112:115], v[32:47]
ds_read_b128 v[104:107], v14 offset:34816
v_rsq_f32 v186, v185
v_sub_f32 v187, 0, v184
s_mov_b64 exec, 0xffff
ds_write_b64 v191, v[186:187]
s_mov_b64 exec, -1
v_mfma_f32_32x32x16_bf16 v[32:47], a[232:235], v[116:119], v[32:47]
ds_read_b128 v[108:111], v14 offset:35840
s_add_u32 s89, s93, 36864
buffer_load_dwordx4 a[4:7], v15, s[4:7], s89 offen offset:0 sc1
s_waitcnt lgkmcnt(5)
v_mfma_f32_32x32x16_bf16 v[32:47], a[240:243], v[120:123], v[32:47]
s_waitcnt vmcnt(7) lgkmcnt(1)
s_barrier
ds_read_b128 v[112:115], v222 offset:0
v_and_b32 v184, 31, v1
v_lshlrev_b32 v184, 3, v184
v_add_u32 v184, 157952, v184
ds_read_b64 v[180:181], v184 offset:0
ds_read_b64 v[182:183], v184 offset:256
v_mov_b32 v88, v200
v_mov_b32 v89, v201
v_mov_b32 v90, v202
v_mov_b32 v91, v203
v_mfma_f32_32x32x16_bf16 v[32:47], a[248:251], v[124:127], v[32:47]
ds_read_b128 v[116:119], v222 offset:1024
buffer_load_dwordx4 a[12:15], v15, s[4:7], s89 offen offset:1024 sc1
v_mfma_f32_32x32x16_bf16 v[32:47], v[224:227], v[96:99], v[32:47]
ds_read_b128 v[120:123], v222 offset:2048
v_mov_b32 v92, v204
v_mov_b32 v93, v205
v_mov_b32 v94, v206
v_mov_b32 v95, v207
v_mfma_f32_32x32x16_bf16 v[32:47], v[232:235], v[100:103], v[32:47]
ds_read_b128 v[124:127], v222 offset:3072
s_add_u32 s89, s93, 38912
buffer_load_dwordx4 a[20:23], v15, s[4:7], s89 offen offset:0 sc1
s_waitcnt lgkmcnt(6)
s_waitcnt lgkmcnt(3)
v_mfma_f32_32x32x16_bf16 v[32:47], v[240:243], v[104:107], v[32:47]
ds_read_b128 v[96:99], v222 offset:4096
v_mov_b32 v220, v180
v_mul_f32 v180, 1069066811, v180
v_mov_b32 v221, v182
v_mul_f32 v182, 1069066811, v182
v_mfma_f32_32x32x16_bf16 v[32:47], v[248:251], v[108:111], v[32:47]
ds_read_b128 v[100:103], v222 offset:5120
buffer_load_dwordx4 a[28:31], v15, s[4:7], s89 offen offset:1024 sc1
s_waitcnt lgkmcnt(4)
v_mul_f32 v48, v128, v183
v_mul_f32 v49, v129, v183
v_mul_f32 v50, v130, v183
v_mul_f32 v51, v131, v183
v_mul_f32 v52, v132, v183
v_mul_f32 v53, v133, v183
v_mul_f32 v54, v134, v183
v_mul_f32 v55, v135, v183
v_mul_f32 v56, v136, v183
v_mul_f32 v57, v137, v183
v_mul_f32 v58, v138, v183
v_mul_f32 v59, v139, v183
v_mul_f32 v60, v140, v183
v_mul_f32 v61, v141, v183
v_mul_f32 v62, v142, v183
v_mul_f32 v63, v143, v183
s_nop 1
v_mfma_f32_32x32x16_bf16 v[48:63], a[0:3], v[112:115], v[48:63]
ds_read_b128 v[104:107], v222 offset:6144
v_mov_b32 v176, v208
v_mov_b32 v177, v209
v_mov_b32 v178, v210
v_mov_b32 v179, v211
v_mfma_f32_32x32x16_bf16 v[48:63], a[8:11], v[116:119], v[48:63]
ds_read_b128 v[108:111], v222 offset:7168
s_add_u32 s89, s93, 40960
buffer_load_dwordx4 a[36:39], v15, s[4:7], s89 offen offset:0 sc1
s_waitcnt lgkmcnt(4)
s_add_u32 s66, s95, 159744
v_add_u32 v184, s66, v14
v_mfma_f32_32x32x16_bf16 v[48:63], a[16:19], v[120:123], v[48:63]
ds_read_b128 v[112:115], v222 offset:8192
v_xor_b32 v185, 0x400, v184
v_xor_b32 v186, 0x800, v184
v_xor_b32 v187, 0xc00, v184
v_fmac_f32 v32, v128, v181
v_mfma_f32_32x32x16_bf16 v[48:63], a[24:27], v[124:127], v[48:63]
ds_read_b128 v[116:119], v222 offset:9216
buffer_load_dwordx4 a[44:47], v15, s[4:7], s89 offen offset:1024 sc1
s_waitcnt lgkmcnt(4)
v_fmac_f32 v33, v129, v181
v_fmac_f32 v34, v130, v181
v_mfma_f32_32x32x16_bf16 v[48:63], a[32:35], v[96:99], v[48:63]
ds_read_b128 v[120:123], v222 offset:10240
v_fmac_f32 v35, v131, v181
v_fmac_f32 v36, v132, v181
v_fmac_f32 v37, v133, v181
v_fmac_f32 v38, v134, v181
v_mfma_f32_32x32x16_bf16 v[48:63], a[40:43], v[100:103], v[48:63]
ds_read_b128 v[124:127], v222 offset:11264
s_add_u32 s89, s93, 43008
buffer_load_dwordx4 a[52:55], v15, s[4:7], s89 offen offset:0 sc1
s_waitcnt lgkmcnt(4)
v_fmac_f32 v39, v135, v181
v_fmac_f32 v40, v136, v181
v_mfma_f32_32x32x16_bf16 v[48:63], a[48:51], v[104:107], v[48:63]
ds_read_b128 v[96:99], v222 offset:12288
s_waitcnt vmcnt(8)
s_barrier
ds_read_b128 v[148:151], v164 offset:0
ds_read_b128 v[152:155], v165 offset:0
ds_read_b128 v[156:159], v166 offset:0
v_fmac_f32 v41, v137, v181
v_fmac_f32 v42, v138, v181
v_mfma_f32_32x32x16_bf16 v[48:63], a[56:59], v[108:111], v[48:63]
ds_read_b128 v[100:103], v222 offset:13312
ds_read_b128 v[160:163], v167 offset:0
ds_read_b128 v[168:171], v164 offset:8192
ds_read_b128 v[172:175], v165 offset:8192
buffer_load_dwordx4 a[60:63], v15, s[4:7], s89 offen offset:1024 sc1
s_waitcnt lgkmcnt(10)
v_fmac_f32 v43, v139, v181
v_fmac_f32 v44, v140, v181
v_mfma_f32_32x32x16_bf16 v[48:63], a[64:67], v[112:115], v[48:63]
ds_read_b128 v[104:107], v222 offset:14336
v_fmac_f32 v45, v141, v181
v_fmac_f32 v46, v142, v181
v_fmac_f32 v47, v143, v181
v_max3_f32 v26, v32, v33, v34
s_waitcnt lgkmcnt(6)
v_mfma_f32_16x16x32_bf16 v[64:67], v[80:83], v[148:151], 0
ds_read_b128 v[148:151], v166 offset:8192
v_mfma_f32_16x16x32_bf16 v[68:71], v[80:83], v[152:155], 0
ds_read_b128 v[152:155], v167 offset:8192
s_waitcnt lgkmcnt(5)
v_mfma_f32_16x16x32_bf16 v[72:75], v[80:83], v[156:159], 0
ds_read_b128 v[156:159], v164 offset:16384
v_mfma_f32_16x16x32_bf16 v[76:79], v[80:83], v[160:163], 0
ds_read_b128 v[160:163], v165 offset:16384
s_waitcnt lgkmcnt(5)
v_mfma_f32_16x16x32_bf16 v[64:67], v[84:87], v[168:171], v[64:67]
ds_read_b128 v[168:171], v166 offset:16384
v_mfma_f32_16x16x32_bf16 v[68:71], v[84:87], v[172:175], v[68:71]
ds_read_b128 v[172:175], v167 offset:16384
s_waitcnt lgkmcnt(4)
v_mfma_f32_16x16x32_bf16 v[72:75], v[84:87], v[148:151], v[72:75]
ds_read_b128 v[148:151], v164 offset:24576
v_mfma_f32_16x16x32_bf16 v[76:79], v[84:87], v[152:155], v[76:79]
ds_read_b128 v[152:155], v165 offset:24576
s_waitcnt lgkmcnt(4)
v_mfma_f32_16x16x32_bf16 v[64:67], v[88:91], v[156:159], v[64:67]
ds_read_b128 v[156:159], v166 offset:24576
v_mfma_f32_16x16x32_bf16 v[68:71], v[88:91], v[160:163], v[68:71]
ds_read_b128 v[160:163], v167 offset:24576
s_waitcnt lgkmcnt(4)
v_mfma_f32_16x16x32_bf16 v[72:75], v[88:91], v[168:171], v[72:75]
v_add_u32 v164, s90, v164
ds_read_b128 v[168:171], v164 offset:0
v_mfma_f32_16x16x32_bf16 v[76:79], v[88:91], v[172:175], v[76:79]
v_add_u32 v165, s90, v165
ds_read_b128 v[172:175], v165 offset:0
s_waitcnt lgkmcnt(4)
v_mfma_f32_16x16x32_bf16 v[64:67], v[92:95], v[148:151], v[64:67]
v_add_u32 v166, s90, v166
ds_read_b128 v[148:151], v166 offset:0
v_mfma_f32_16x16x32_bf16 v[68:71], v[92:95], v[152:155], v[68:71]
v_add_u32 v167, s90, v167
ds_read_b128 v[152:155], v167 offset:0
s_waitcnt lgkmcnt(4)
v_mfma_f32_16x16x32_bf16 v[72:75], v[92:95], v[156:159], v[72:75]
v_mfma_f32_16x16x32_bf16 v[76:79], v[92:95], v[160:163], v[76:79]
s_waitcnt lgkmcnt(2)
v_mfma_f32_16x16x32_bf16 v[64:67], v[176:179], v[168:171], v[64:67]
v_mfma_f32_16x16x32_bf16 v[68:71], v[176:179], v[172:175], v[68:71]
s_waitcnt lgkmcnt(0)
v_mfma_f32_16x16x32_bf16 v[72:75], v[176:179], v[148:151], v[72:75]
v_mfma_f32_16x16x32_bf16 v[76:79], v[176:179], v[152:155], v[76:79]
v_mfma_f32_32x32x16_bf16 v[48:63], a[72:75], v[116:119], v[48:63]
ds_read_b128 v[108:111], v222 offset:15360
s_add_u32 s89, s93, 45056
buffer_load_dwordx4 a[68:71], v15, s[4:7], s89 offen offset:0 sc1
v_max3_f32 v27, -v32, -v33, -v34
v_max3_f32 v26, v26, v35, v36
v_mfma_f32_32x32x16_bf16 v[48:63], a[80:83], v[120:123], v[48:63]
ds_read_b128 v[112:115], v222 offset:16384
ds_write_b128 v184, v[64:67]
v_max3_f32 v27, v27, -v35, -v36
v_max3_f32 v26, v26, v37, v38
v_mfma_f32_32x32x16_bf16 v[48:63], a[88:91], v[124:127], v[48:63]
ds_read_b128 v[116:119], v222 offset:17408
buffer_load_dwordx4 a[76:79], v15, s[4:7], s89 offen offset:1024 sc1
v_max3_f32 v27, v27, -v37, -v38
v_max3_f32 v26, v26, v39, v40
v_mfma_f32_32x32x16_bf16 v[48:63], a[96:99], v[96:99], v[48:63]
ds_read_b128 v[120:123], v222 offset:18432
v_max3_f32 v27, v27, -v39, -v40
s_nop 1
v_permlane32_swap_b32 v26, v27
v_mfma_f32_32x32x16_bf16 v[48:63], a[104:107], v[100:103], v[48:63]
ds_read_b128 v[124:127], v222 offset:19456
s_add_u32 s89, s93, 47104
buffer_load_dwordx4 a[84:87], v15, s[4:7], s89 offen offset:0 sc1
s_waitcnt lgkmcnt(5)
v_max_f32 v26, v26, v27
v_mul_f32 v28, -v26, v180
v_mfma_f32_32x32x16_bf16 v[48:63], a[112:115], v[104:107], v[48:63]
ds_read_b128 v[96:99], v222 offset:20480
s_waitcnt lgkmcnt(4)
s_barrier
ds_read_b128 v[168:171], v185
v_mul_f32 v29, -v26, v180
v_mfma_f32_32x32x16_bf16 v[48:63], a[120:123], v[108:111], v[48:63]
ds_read_b128 v[100:103], v222 offset:21504
buffer_load_dwordx4 a[92:95], v15, s[4:7], s89 offen offset:1024 sc1
s_waitcnt lgkmcnt(5)
v_permlane32_swap_b32 v28, v29
v_mfma_f32_32x32x16_bf16 v[48:63], a[128:131], v[112:115], v[48:63]
ds_read_b128 v[104:107], v222 offset:22528
v_fma_f32 v192, v32, v180, v28
v_fma_f32 v202, -v32, v180, v29
v_fma_f32 v193, v33, v180, v28
v_mfma_f32_32x32x16_bf16 v[48:63], a[136:139], v[116:119], v[48:63]
ds_read_b128 v[108:111], v222 offset:23552
s_waitcnt lgkmcnt(3)
v_add_f32 v68, v68, v168
v_add_f32 v69, v69, v169
v_add_f32 v70, v70, v170
v_add_f32 v71, v71, v171
ds_write_b128 v185, v[68:71]
s_add_u32 s89, s93, 49152
buffer_load_dwordx4 a[100:103], v15, s[4:7], s89 offen offset:0 sc1
v_fma_f32 v203, -v33, v180, v29
v_fma_f32 v194, v34, v180, v28
v_mfma_f32_32x32x16_bf16 v[48:63], a[144:147], v[120:123], v[48:63]
ds_read_b128 v[112:115], v222 offset:24576
v_fma_f32 v204, -v34, v180, v29
v_fma_f32 v195, v35, v180, v28
v_fma_f32 v205, -v35, v180, v29
v_fma_f32 v196, v36, v180, v28
v_mfma_f32_32x32x16_bf16 v[48:63], a[152:155], v[124:127], v[48:63]
ds_read_b128 v[116:119], v222 offset:25600
buffer_load_dwordx4 a[108:111], v15, s[4:7], s89 offen offset:1024 sc1
s_waitcnt lgkmcnt(5)
v_fma_f32 v206, -v36, v180, v29
v_fma_f32 v197, v37, v180, v28
v_mfma_f32_32x32x16_bf16 v[48:63], a[160:163], v[96:99], v[48:63]
ds_read_b128 v[120:123], v222 offset:26624
v_fma_f32 v207, -v37, v180, v29
v_fma_f32 v198, v38, v180, v28
v_fma_f32 v208, -v38, v180, v29
v_fma_f32 v199, v39, v180, v28
v_mfma_f32_32x32x16_bf16 v[48:63], a[168:171], v[100:103], v[48:63]
ds_read_b128 v[124:127], v222 offset:27648
s_waitcnt lgkmcnt(4)
s_barrier
ds_read_b128 v[168:171], v186
s_add_u32 s89, s93, 51200
buffer_load_dwordx4 a[116:119], v15, s[4:7], s89 offen offset:0 sc1
v_fma_f32 v209, -v39, v180, v29
v_fma_f32 v200, v40, v180, v28
v_mfma_f32_32x32x16_bf16 v[48:63], a[176:179], v[104:107], v[48:63]
ds_read_b128 v[96:99], v222 offset:28672
v_fma_f32 v210, -v40, v180, v29
v_exp_f32 v192, v192
v_mfma_f32_32x32x16_bf16 v[48:63], a[184:187], v[108:111], v[48:63]
ds_read_b128 v[100:103], v222 offset:29696
buffer_load_dwordx4 a[124:127], v15, s[4:7], s89 offen offset:1024 sc1
s_waitcnt lgkmcnt(5)
v_exp_f32 v202, v202
v_mfma_f32_32x32x16_bf16 v[48:63], a[192:195], v[112:115], v[48:63]
ds_read_b128 v[104:107], v222 offset:30720
s_waitcnt lgkmcnt(3)
v_add_f32 v72, v72, v168
v_add_f32 v73, v73, v169
v_add_f32 v74, v74, v170
v_add_f32 v75, v75, v171
ds_write_b128 v186, v[72:75]
v_exp_f32 v193, v193
v_mfma_f32_32x32x16_bf16 v[48:63], a[200:203], v[116:119], v[48:63]
ds_read_b128 v[108:111], v222 offset:31744
s_add_u32 s89, s93, 53248
buffer_load_dwordx4 a[132:135], v15, s[4:7], s89 offen offset:0 sc1
v_exp_f32 v203, v203
v_mfma_f32_32x32x16_bf16 v[48:63], a[208:211], v[120:123], v[48:63]
ds_read_b128 v[112:115], v222 offset:32768
s_mov_b32 s75, 0
s_waitcnt vmcnt(17)
fr_68:
v_cmp_ne_u32 vcc, s62, v188
s_cbranch_vccnz fo_69
fk_70:
v_exp_f32 v194, v194
v_mfma_f32_32x32x16_bf16 v[48:63], a[216:219], v[124:127], v[48:63]
ds_read_b128 v[116:119], v222 offset:33792
buffer_load_dwordx4 a[140:143], v15, s[4:7], s89 offen offset:1024 sc1
s_waitcnt lgkmcnt(5)
v_exp_f32 v204, v204
v_mfma_f32_32x32x16_bf16 v[48:63], a[224:227], v[96:99], v[48:63]
ds_read_b128 v[120:123], v222 offset:34816
s_waitcnt lgkmcnt(4)
s_barrier
ds_read_b128 v[168:171], v187
v_exp_f32 v195, v195
v_mfma_f32_32x32x16_bf16 v[48:63], a[232:235], v[100:103], v[48:63]
ds_read_b128 v[124:127], v222 offset:35840
s_add_u32 s89, s93, 55296
buffer_load_dwordx4 a[148:151], v15, s[4:7], s89 offen offset:0 sc1
s_waitcnt lgkmcnt(5)
v_exp_f32 v205, v205
v_mfma_f32_32x32x16_bf16 v[48:63], a[240:243], v[104:107], v[48:63]
v_exp_f32 v196, v196
v_exp_f32 v206, v206
v_mfma_f32_32x32x16_bf16 v[48:63], a[248:251], v[108:111], v[48:63]
s_waitcnt lgkmcnt(1)
v_add_f32 v76, v76, v168
v_add_f32 v77, v77, v169
v_add_f32 v78, v78, v170
v_add_f32 v79, v79, v171
ds_write_b128 v187, v[76:79]
buffer_load_dwordx4 a[156:159], v15, s[4:7], s89 offen offset:1024 sc1
v_exp_f32 v197, v197
v_mfma_f32_32x32x16_bf16 v[48:63], v[224:227], v[112:115], v[48:63]
v_exp_f32 v207, v207
v_exp_f32 v198, v198
v_mfma_f32_32x32x16_bf16 v[48:63], v[232:235], v[116:119], v[48:63]
s_add_u32 s89, s93, 57344
buffer_load_dwordx4 a[164:167], v15, s[4:7], s89 offen offset:0 sc1
s_waitcnt lgkmcnt(1)
v_exp_f32 v208, v208
v_mfma_f32_32x32x16_bf16 v[48:63], v[240:243], v[120:123], v[48:63]
v_exp_f32 v199, v199
v_exp_f32 v209, v209
v_mfma_f32_32x32x16_bf16 v[48:63], v[248:251], v[124:127], v[48:63]
s_waitcnt lgkmcnt(0)
s_barrier
ds_read_b64 v[184:185], v190 offset:0
ds_read_b64 v[186:187], v190 offset:2048
buffer_load_dwordx4 a[172:175], v15, s[4:7], s89 offen offset:1024 sc1
v_exp_f32 v200, v200
v_exp_f32 v210, v210
v_add_f32 v26, v192, v194
v_add_f32 v28, v202, v204
v_add_f32 v27, v193, v195
v_add_f32 v29, v203, v205
v_add_f32 v26, v26, v196
v_add_f32 v28, v28, v206
v_add_f32 v27, v27, v197
v_add_f32 v29, v29, v207
v_add_f32 v26, v26, v198
v_add_f32 v28, v28, v208
v_add_f32 v27, v27, v199
v_add_f32 v29, v29, v209
v_add_f32 v26, v26, v27
v_add_f32 v28, v28, v29
v_add_f32 v26, v26, v200
v_add_f32 v28, v28, v210
s_nop 1
v_permlane32_swap_b32 v26, v28
v_add_f32 v26, v26, v28
v_rcp_f32 v26, v26
s_nop 0
v_mov_b32 v27, v26
s_nop 1
v_permlane32_swap_b32 v26, v27
v_mul_f32 v192, v192, v26
v_mul_f32 v202, v202, v27
v_mul_f32 v193, v193, v26
v_mul_f32 v203, v203, v27
v_mul_f32 v194, v194, v26
v_mul_f32 v204, v204, v27
v_mul_f32 v195, v195, v26
v_mul_f32 v205, v205, v27
v_mul_f32 v196, v196, v26
v_mul_f32 v206, v206, v27
v_mul_f32 v197, v197, v26
v_mul_f32 v207, v207, v27
v_mul_f32 v198, v198, v26
v_mul_f32 v208, v208, v27
v_mul_f32 v199, v199, v26
v_mul_f32 v209, v209, v27
v_mul_f32 v200, v200, v26
v_mul_f32 v210, v210, v27
v_cvt_pk_bf16_f32 v148, v192, v193
v_cvt_pk_bf16_f32 v149, v194, v195
v_cvt_pk_bf16_f32 v150, v196, v197
v_cvt_pk_bf16_f32 v151, v198, v199
v_cvt_pk_bf16_f32 v152, v202, v203
v_cvt_pk_bf16_f32 v153, v204, v205
v_cvt_pk_bf16_f32 v154, v206, v207
v_cvt_pk_bf16_f32 v155, v208, v209
v_cvt_pk_bf16_f32 v161, v200, v210
v_mul_f32 v41, v41, v220
v_mul_f32 v42, v42, v220
v_mul_f32 v43, v43, v220
v_mul_f32 v44, v44, v220
v_mul_f32 v45, v45, v220
v_mul_f32 v46, v46, v220
v_mul_f32 v47, v47, v220
v_cvt_pk_bf16_f32 v156, v41, v42
v_cvt_pk_bf16_f32 v157, v43, v44
v_cvt_pk_bf16_f32 v158, v45, v46
v_mov_b32 v162, 0
v_mov_b32 v163, 0
s_waitcnt lgkmcnt(0)
v_fmac_f32 v184, v144, v181
v_fmac_f32 v185, v145, v181
v_mul_f32 v184, v184, v220
v_mul_f32 v185, v185, v220
v_cvt_pk_bf16_f32 v159, v47, v184
v_cvt_pk_bf16_f32 v160, v185, 1.0
v_mfma_f32_32x32x16_bf16 v[32:47], v[148:151], v[212:215], 0
v_max3_f32 v26, v48, v49, v50
s_add_u32 s89, s93, 59392
buffer_load_dwordx4 a[180:183], v15, s[4:7], s89 offen offset:0 sc1
v_max3_f32 v27, -v48, -v49, -v50
v_max3_f32 v26, v26, v51, v52
v_mfma_f32_32x32x16_bf16 v[96:111], v[156:159], v[212:215], 0
v_max3_f32 v27, v27, -v51, -v52
v_max3_f32 v26, v26, v53, v54
v_max3_f32 v27, v27, -v53, -v54
v_max3_f32 v26, v26, v55, v56
v_mfma_f32_32x32x16_bf16 v[32:47], v[152:155], v[216:219], v[32:47]
buffer_load_dwordx4 a[188:191], v15, s[4:7], s89 offen offset:1024 sc1
v_max3_f32 v27, v27, -v55, -v56
s_nop 1
v_permlane32_swap_b32 v26, v27
v_max_f32 v26, v26, v27
v_mfma_f32_32x32x16_bf16 v[96:111], v[160:163], v[216:219], v[96:111]
v_mul_f32 v28, -v26, v182
v_mul_f32 v29, -v26, v182
s_nop 1
v_permlane32_swap_b32 v28, v29
s_add_u32 s89, s93, 61440
buffer_load_dwordx4 a[196:199], v15, s[4:7], s89 offen offset:0 sc1
v_fma_f32 v192, v48, v182, v28
v_fma_f32 v202, -v48, v182, v29
v_fma_f32 v193, v49, v182, v28
v_fma_f32 v203, -v49, v182, v29
v_fma_f32 v194, v50, v182, v28
v_fma_f32 v204, -v50, v182, v29
buffer_load_dwordx4 a[204:207], v15, s[4:7], s89 offen offset:1024 sc1
v_fma_f32 v195, v51, v182, v28
v_fma_f32 v205, -v51, v182, v29
v_fma_f32 v196, v52, v182, v28
v_fma_f32 v206, -v52, v182, v29
v_cvt_pk_bf16_f32 v112, v32, v33
v_cvt_pk_bf16_f32 v113, v34, v35
v_cvt_pk_bf16_f32 v114, v36, v37
v_cvt_pk_bf16_f32 v115, v38, v39
v_cvt_pk_bf16_f32 v116, v40, v41
v_cvt_pk_bf16_f32 v117, v42, v43
v_cvt_pk_bf16_f32 v118, v44, v45
v_cvt_pk_bf16_f32 v119, v46, v47
v_cvt_pk_bf16_f32 v120, v96, v97
v_cvt_pk_bf16_f32 v121, v98, v99
v_cvt_pk_bf16_f32 v122, v100, v101
v_cvt_pk_bf16_f32 v123, v102, v103
v_cvt_pk_bf16_f32 v124, v104, v105
v_cvt_pk_bf16_f32 v125, v106, v107
v_cvt_pk_bf16_f32 v126, v108, v109
v_cvt_pk_bf16_f32 v127, v110, v111
v_mfma_f32_32x32x16_bf16 v[64:79], v[112:115], v[120:123], 0
v_fma_f32 v197, v53, v182, v28
v_fma_f32 v207, -v53, v182, v29
s_add_u32 s89, s93, 63488
buffer_load_dwordx4 a[212:215], v15, s[4:7], s89 offen offset:0 sc1
v_fma_f32 v198, v54, v182, v28
v_mfma_f32_32x32x16_bf16 v[80:95], v[120:123], v[120:123], 0
v_fma_f32 v208, -v54, v182, v29
v_fma_f32 v199, v55, v182, v28
v_fma_f32 v209, -v55, v182, v29
v_fma_f32 v200, v56, v182, v28
v_fma_f32 v210, -v56, v182, v29
v_mfma_f32_32x32x16_bf16 v[64:79], v[116:119], v[124:127], v[64:79]
buffer_load_dwordx4 a[220:223], v15, s[4:7], s89 offen offset:1024 sc1
v_exp_f32 v192, v192
v_exp_f32 v202, v202
v_mfma_f32_32x32x16_bf16 v[80:95], v[124:127], v[124:127], v[80:95]
v_exp_f32 v193, v193
v_exp_f32 v203, v203
v_exp_f32 v194, v194
v_exp_f32 v204, v204
s_add_u32 s89, s93, 65536
buffer_load_dwordx4 a[228:231], v15, s[4:7], s89 offen offset:0 sc1
v_exp_f32 v195, v195
v_exp_f32 v205, v205
v_exp_f32 v196, v196
v_exp_f32 v206, v206
v_exp_f32 v197, v197
v_exp_f32 v207, v207
buffer_load_dwordx4 a[236:239], v15, s[4:7], s89 offen offset:1024 sc1
v_exp_f32 v198, v198
v_exp_f32 v208, v208
v_exp_f32 v199, v199
v_exp_f32 v209, v209
v_exp_f32 v200, v200
v_exp_f32 v210, v210
s_add_u32 s89, s93, 67584
buffer_load_dwordx4 a[244:247], v15, s[4:7], s89 offen offset:0 sc1
v_pk_add_f32 v[26:27], v[192:193], v[194:195]
v_pk_add_f32 v[28:29], v[202:203], v[204:205]
v_pk_add_f32 v[26:27], v[26:27], v[196:197]
v_pk_add_f32 v[28:29], v[28:29], v[206:207]
v_pk_add_f32 v[26:27], v[26:27], v[198:199]
v_pk_add_f32 v[28:29], v[28:29], v[208:209]
buffer_load_dwordx4 a[252:255], v15, s[4:7], s89 offen offset:1024 sc1
v_add_f32 v26, v26, v27
v_add_f32 v28, v28, v29
v_add_f32 v26, v26, v200
v_add_f32 v28, v28, v210
s_nop 1
v_permlane32_swap_b32 v26, v28
v_add_f32 v26, v26, v28
s_add_u32 s89, s93, 69632
buffer_load_dwordx4 v[228:231], v15, s[4:7], s89 offen offset:0 sc1
v_rcp_f32 v26, v26
s_nop 0
v_mov_b32 v27, v26
s_nop 1
v_permlane32_swap_b32 v26, v27
v_pk_mul_f32 v[192:193], v[192:193], v[26:27] op_sel_hi:[1,0]
v_pk_mul_f32 v[202:203], v[202:203], v[26:27] op_sel:[0,1]
v_pk_mul_f32 v[194:195], v[194:195], v[26:27] op_sel_hi:[1,0]
buffer_load_dwordx4 v[236:239], v15, s[4:7], s89 offen offset:1024 sc1
v_pk_mul_f32 v[204:205], v[204:205], v[26:27] op_sel:[0,1]
v_pk_mul_f32 v[196:197], v[196:197], v[26:27] op_sel_hi:[1,0]
v_pk_mul_f32 v[206:207], v[206:207], v[26:27] op_sel:[0,1]
v_pk_mul_f32 v[198:199], v[198:199], v[26:27] op_sel_hi:[1,0]
v_pk_mul_f32 v[208:209], v[208:209], v[26:27] op_sel:[0,1]
v_mul_f32 v200, v200, v26
s_add_u32 s89, s93, 71680
buffer_load_dwordx4 v[244:247], v15, s[4:7], s89 offen offset:0 sc1
v_mul_f32 v210, v210, v27
v_cvt_pk_bf16_f32 v164, v192, v193
v_cvt_pk_bf16_f32 v165, v194, v195
v_cvt_pk_bf16_f32 v166, v196, v197
v_cvt_pk_bf16_f32 v167, v198, v199
v_cvt_pk_bf16_f32 v168, v202, v203
buffer_load_dwordx4 v[252:255], v15, s[4:7], s89 offen offset:1024 sc1
v_cvt_pk_bf16_f32 v169, v204, v205
v_cvt_pk_bf16_f32 v170, v206, v207
v_cvt_pk_bf16_f32 v171, v208, v209
v_cvt_pk_bf16_f32 v177, v200, v210
v_mul_f32 v57, v57, v221
v_pk_mul_f32 v[58:59], v[58:59], v[220:221] op_sel:[0,1]
s_lshl_b32 s67, s58, 3
s_add_u32 s67, s67, s59
s_lshl_b32 s67, s67, 9
s_add_u32 s67, s67, 524288
s_lshl_b32 s68, s99, 5
s_add_u32 s68, s68, 32768
v_lshl_add_u32 v223, v1, 7, s67
v_writelane_b32 v223, s68, 4
s_add_u32 s68, s98, 128
v_writelane_b32 v223, s68, 5
s_add_u32 s68, s98, 256
v_writelane_b32 v223, s68, 6
s_mov_b64 exec, 127
buffer_load_dword v223, v223, s[4:7], 0 offen
s_mov_b64 exec, -1
v_pk_mul_f32 v[60:61], v[60:61], v[220:221] op_sel:[0,1]
v_pk_mul_f32 v[62:63], v[62:63], v[220:221] op_sel:[0,1]
v_cvt_pk_bf16_f32 v172, v57, v58
v_cvt_pk_bf16_f32 v173, v59, v60
v_cvt_pk_bf16_f32 v174, v61, v62
v_mov_b32 v178, 0
s_mul_i32 s96, s59, 82944
s_add_u32 s96, s96, 2097152
s_add_u32 s96, s96, s95
v_mov_b32 v179, 0
s_add_u32 m0, s95, 73728
s_add_u32 s92, s96, 0
buffer_load_dwordx4 v14, s[4:7], s92 offen sc1 lds
s_add_u32 m0, s95, 77824
s_add_u32 s92, s96, 4096
buffer_load_dwordx4 v14, s[4:7], s92 offen sc1 lds
s_add_u32 m0, s95, 81920
s_add_u32 s92, s96, 8192
buffer_load_dwordx4 v14, s[4:7], s92 offen sc1 lds
s_add_u32 m0, s95, 86016
s_add_u32 s92, s96, 12288
buffer_load_dwordx4 v14, s[4:7], s92 offen sc1 lds
s_add_u32 m0, s95, 90112
s_add_u32 s92, s96, 16384
buffer_load_dwordx4 v14, s[4:7], s92 offen sc1 lds
s_add_u32 m0, s95, 94208
s_add_u32 s92, s96, 20480
buffer_load_dwordx4 v14, s[4:7], s92 offen sc1 lds
s_add_u32 m0, s95, 98304
s_add_u32 s92, s96, 24576
buffer_load_dwordx4 v14, s[4:7], s92 offen sc1 lds
s_add_u32 m0, s95, 102400
s_add_u32 s92, s96, 28672
buffer_load_dwordx4 v14, s[4:7], s92 offen sc1 lds
s_add_u32 m0, s95, 106496
s_add_u32 s92, s96, 32768
buffer_load_dwordx4 v14, s[4:7], s92 offen sc1 lds
v_fmac_f32 v186, v144, v183
v_fmac_f32 v187, v145, v183
v_mul_f32 v186, v186, v221
v_mul_f32 v187, v187, v221
v_cvt_pk_bf16_f32 v175, v63, v186
v_cvt_pk_bf16_f32 v176, v187, 1.0
ds_read_b128 v[128:131], v189 offset:64
ds_read_b128 v[132:135], v189 offset:80
ds_read_b128 v[136:139], v189 offset:96
v_mfma_f32_32x32x16_bf16 v[32:47], v[164:167], v[212:215], 0
v_lshrrev_b32 v30, 5, v1
v_mul_u32_u24 v30, 20, v30
v_and_b32 v31, 31, v1
v_add_u32 v30, v30, v31
v_mfma_f32_32x32x16_bf16 v[96:111], v[172:175], v[212:215], 0
v_cmp_lt_u32 vcc, 19, v31
v_add_u32 v31, -2, v30
s_nop 0
v_cndmask_b32 v31, v30, v31, vcc
v_lshlrev_b32 v30, 4, v31
v_lshlrev_b32 v31, 2, v31
v_lshrrev_b32 v186, 9, v30
v_mul_u32_u24 v186, 17920, v186
v_mfma_f32_32x32x16_bf16 v[32:47], v[168:171], v[216:219], v[32:47]
v_add_u32 v184, v30, v186
v_add_u32 v187, 640, v30
v_lshrrev_b32 v186, 9, v187
v_mul_u32_u24 v186, 17920, v186
v_add_u32 v185, v187, v186
s_lshl_b32 s67, s61, 9
v_mfma_f32_32x32x16_bf16 v[96:111], v[176:179], v[216:219], v[96:111]
s_mul_i32 s68, s59, 2304
s_add_u32 s67, s67, s68
s_add_u32 s67, s67, s94
s_add_u32 s67, s67, 2359296
s_add_u32 s68, s67, 37120
v_cvt_pk_bf16_f32 v112, v32, v33
v_cvt_pk_bf16_f32 v113, v34, v35
v_cvt_pk_bf16_f32 v114, v36, v37
v_cvt_pk_bf16_f32 v115, v38, v39
v_cvt_pk_bf16_f32 v116, v40, v41
v_cvt_pk_bf16_f32 v117, v42, v43
v_cvt_pk_bf16_f32 v118, v44, v45
v_cvt_pk_bf16_f32 v119, v46, v47
v_cvt_pk_bf16_f32 v120, v96, v97
v_cvt_pk_bf16_f32 v121, v98, v99
v_cvt_pk_bf16_f32 v122, v100, v101
v_cvt_pk_bf16_f32 v123, v102, v103
v_cvt_pk_bf16_f32 v124, v104, v105
v_cvt_pk_bf16_f32 v125, v106, v107
v_cvt_pk_bf16_f32 v126, v108, v109
v_cvt_pk_bf16_f32 v127, v110, v111
v_mfma_f32_32x32x16_bf16 v[64:79], v[112:115], v[120:123], v[64:79]
v_mfma_f32_32x32x16_bf16 v[80:95], v[120:123], v[120:123], v[80:95]
v_mfma_f32_32x32x16_bf16 v[64:79], v[116:119], v[124:127], v[64:79]
v_mfma_f32_32x32x16_bf16 v[80:95], v[124:127], v[124:127], v[80:95]
ds_read_b128 v[96:99], v14 offset:0
ds_read_b128 v[100:103], v14 offset:1024
ds_read_b128 v[104:107], v14 offset:2048
ds_read_b128 v[108:111], v14 offset:3072
s_nop 6
v_cvt_pk_bf16_f32 v148, v64, v65
v_cvt_pk_bf16_f32 v149, v66, v67
v_cvt_pk_bf16_f32 v150, v68, v69
v_cvt_pk_bf16_f32 v151, v70, v71
v_cvt_pk_bf16_f32 v152, v72, v73
v_cvt_pk_bf16_f32 v153, v74, v75
v_cvt_pk_bf16_f32 v154, v76, v77
v_cvt_pk_bf16_f32 v155, v78, v79
v_cvt_pk_bf16_f32 v156, v90, v91
s_mov_b64 exec, s[76:77]
s_cmp_eq_u32 s97, 0
s_cbranch_scc1 slow_71
buffer_store_dwordx4 v[148:151], v184, s[4:7], s67 offen
buffer_store_dwordx4 v[152:155], v185, s[4:7], s67 offen
buffer_store_dword v156, v31, s[4:7], s68 offen
back_72:
s_mov_b64 exec, -1
s_waitcnt lgkmcnt(4)
v_mul_f32 v64, v128, v181
v_mul_f32 v65, v129, v181
v_mul_f32 v66, v130, v181
v_mul_f32 v67, v131, v181
v_mul_f32 v68, v132, v181
v_mul_f32 v69, v133, v181
v_mul_f32 v70, v134, v181
v_mul_f32 v71, v135, v181
v_mul_f32 v72, v136, v181
s_waitcnt vmcnt(48) lgkmcnt(3)
s_nop 0
v_mfma_f32_32x32x16_bf16 v[64:79], a[4:7], v[96:99], v[64:79]
ds_read_b128 v[112:115], v14 offset:4096
ds_read_b128 v[116:119], v14 offset:5120
s_lshl_b32 s66, s99, 5
s_add_u32 s66, s66, 32768
s_lshl_b32 s67, s60, 2
s_lshl_b32 s68, s61, 4
s_add_u32 s67, s67, s68
s_waitcnt vmcnt(47) lgkmcnt(4)
v_mfma_f32_32x32x16_bf16 v[64:79], a[12:15], v[100:103], v[64:79]
ds_read_b128 v[120:123], v14 offset:6144
ds_read_b128 v[124:127], v14 offset:7168
s_waitcnt lgkmcnt(4)
s_add_u32 s67, s67, s66
s_lshl_b32 s68, s60, 4
s_add_u32 s66, s66, s68
v_and_b32 v176, 3, v1
v_lshlrev_b32 v176, 2, v176
s_waitcnt vmcnt(46)
v_mfma_f32_32x32x16_bf16 v[64:79], a[20:23], v[104:107], v[64:79]
ds_read_b128 v[96:99], v14 offset:8192
v_lshlrev_b32 v178, 3, v0
v_mov_b32 v177, 0x40000000
v_cmp_gt_u32 vcc, 180, v0
s_mul_i32 s68, s56, 294912
s_lshl_b32 s69, s60, 9
v_cndmask_b32 v178, v177, v178, vcc
s_waitcnt vmcnt(45)
v_mfma_f32_32x32x16_bf16 v[64:79], a[28:31], v[108:111], v[64:79]
ds_read_b128 v[100:103], v14 offset:9216
s_waitcnt lgkmcnt(4)
s_mul_i32 s70, s61, 17920
v_add_u32 v179, s70, v178
s_add_u32 s68, s68, s69
s_mul_i32 s69, s59, 2304
s_add_u32 s68, s68, s69
s_add_u32 s68, s68, 9175040
s_waitcnt vmcnt(44)
v_mfma_f32_32x32x16_bf16 v[64:79], a[36:39], v[112:115], v[64:79]
ds_read_b128 v[104:107], v14 offset:10240
s_lshl_b32 s69, s59, 2
s_add_u32 s69, s69, s60
s_lshl_b32 s69, s69, 3
s_add_u32 s69, s69, s56
s_lshl_b32 s69, s69, 11
s_add_u32 s69, s69, 655360
s_waitcnt vmcnt(43)
v_mfma_f32_32x32x16_bf16 v[64:79], a[44:47], v[116:119], v[64:79]
ds_read_b128 v[108:111], v14 offset:11264
s_waitcnt lgkmcnt(4)
v_mul_f32 v80, v128, v183
v_mul_f32 v81, v129, v183
v_mul_f32 v82, v130, v183
v_mul_f32 v83, v131, v183
s_waitcnt vmcnt(42)
v_mfma_f32_32x32x16_bf16 v[64:79], a[52:55], v[120:123], v[64:79]
ds_read_b128 v[112:115], v14 offset:12288
v_mul_f32 v84, v132, v183
v_mul_f32 v85, v133, v183
v_mul_f32 v86, v134, v183
v_mul_f32 v87, v135, v183
s_waitcnt vmcnt(41)
v_mfma_f32_32x32x16_bf16 v[64:79], a[60:63], v[124:127], v[64:79]
ds_read_b128 v[116:119], v14 offset:13312
s_waitcnt lgkmcnt(4)
v_mul_f32 v88, v136, v183
s_mul_i32 s90, s59, 2304
s_add_u32 s90, s90, s94
s_add_u32 s90, s90, 2359296
s_waitcnt vmcnt(40)
v_mfma_f32_32x32x16_bf16 v[64:79], a[68:71], v[96:99], v[64:79]
ds_read_b128 v[120:123], v14 offset:14336
s_add_u32 s72, s90, 36864
v_bfe_u32 v188, v1, 4, 1
v_mul_u32_u24 v188, 18432, v188
v_and_b32 v189, 15, v1
s_waitcnt vmcnt(39)
v_mfma_f32_32x32x16_bf16 v[64:79], a[76:79], v[100:103], v[64:79]
ds_read_b128 v[124:127], v14 offset:15360
s_waitcnt lgkmcnt(4)
v_lshl_add_u32 v188, v189, 4, v188
v_lshrrev_b32 v189, 5, v1
s_lshl_b32 s71, s61, 1
v_add_u32 v189, s71, v189
s_waitcnt vmcnt(38)
v_mfma_f32_32x32x16_bf16 v[64:79], a[84:87], v[104:107], v[64:79]
ds_read_b128 v[96:99], v14 offset:16384
s_waitcnt vmcnt(0)
s_cmp_eq_u32 s97, 0
s_cbranch_scc1 slow_73
s_mov_b64 exec, 1
v_mov_b32 v164, s62
buffer_store_dword v164, off, s[4:7], s67 offset:0
s_mov_b64 exec, -1
back_74:
v_lshrrev_b32 v190, 4, v1
v_mul_u32_u24 v190, 18176, v190
v_mfma_f32_32x32x16_bf16 v[64:79], a[92:95], v[108:111], v[64:79]
ds_read_b128 v[100:103], v14 offset:17408
s_waitcnt lgkmcnt(4)
s_lshl_b32 s71, s61, 2
v_add3_u32 v190, v190, v14, s71
v_lshl_add_u32 v188, v189, 8, v188
v_mfma_f32_32x32x16_bf16 v[64:79], a[100:103], v[112:115], v[64:79]
ds_read_b128 v[104:107], v14 offset:18432
v_mfma_f32_32x32x16_bf16 v[64:79], a[108:111], v[116:119], v[64:79]
ds_read_b128 v[108:111], v14 offset:19456
s_waitcnt lgkmcnt(4)
v_mfma_f32_32x32x16_bf16 v[64:79], a[116:119], v[120:123], v[64:79]
ds_read_b128 v[112:115], v14 offset:20480
v_mfma_f32_32x32x16_bf16 v[64:79], a[124:127], v[124:127], v[64:79]
ds_read_b128 v[116:119], v14 offset:21504
buffer_load_dword v165, v176, s[4:7], s66 offen sc1
s_waitcnt lgkmcnt(4)
v_mfma_f32_32x32x16_bf16 v[64:79], a[132:135], v[96:99], v[64:79]
ds_read_b128 v[120:123], v14 offset:22528
v_mfma_f32_32x32x16_bf16 v[64:79], a[140:143], v[100:103], v[64:79]
ds_read_b128 v[124:127], v14 offset:23552
s_waitcnt lgkmcnt(4)
v_mfma_f32_32x32x16_bf16 v[64:79], a[148:151], v[104:107], v[64:79]
ds_read_b128 v[96:99], v14 offset:24576
v_mfma_f32_32x32x16_bf16 v[64:79], a[156:159], v[108:111], v[64:79]
ds_read_b128 v[100:103], v14 offset:25600
s_waitcnt lgkmcnt(4)
v_mfma_f32_32x32x16_bf16 v[64:79], a[164:167], v[112:115], v[64:79]
ds_read_b128 v[104:107], v14 offset:26624
v_mfma_f32_32x32x16_bf16 v[64:79], a[172:175], v[116:119], v[64:79]
ds_read_b128 v[108:111], v14 offset:27648
s_waitcnt lgkmcnt(4)
v_mfma_f32_32x32x16_bf16 v[64:79], a[180:183], v[120:123], v[64:79]
ds_read_b128 v[112:115], v14 offset:28672
v_mfma_f32_32x32x16_bf16 v[64:79], a[188:191], v[124:127], v[64:79]
ds_read_b128 v[116:119], v14 offset:29696
s_waitcnt lgkmcnt(4)
v_mfma_f32_32x32x16_bf16 v[64:79], a[196:199], v[96:99], v[64:79]
ds_read_b128 v[120:123], v14 offset:30720
s_mov_b32 s75, 0
s_waitcnt vmcnt(0)
pr_75:
v_cmp_ne_u32 vcc, s62, v165
s_cbranch_vccnz po_76
pk_77:
buffer_load_dwordx2 v[164:165], v179, s[4:7], s68 offen sc1
s_add_u32 s68, s68, 73728
buffer_load_dwordx2 v[166:167], v179, s[4:7], s68 offen sc1
s_add_u32 s68, s68, 73728
buffer_load_dwordx2 v[168:169], v179, s[4:7], s68 offen sc1
s_add_u32 s68, s68, 73728
buffer_load_dwordx2 v[170:171], v179, s[4:7], s68 offen sc1
v_mfma_f32_32x32x16_bf16 v[64:79], a[204:207], v[100:103], v[64:79]
ds_read_b128 v[124:127], v14 offset:31744
s_waitcnt lgkmcnt(4)
v_mfma_f32_32x32x16_bf16 v[64:79], a[212:215], v[104:107], v[64:79]
ds_read_b128 v[96:99], v14 offset:32768
v_mfma_f32_32x32x16_bf16 v[64:79], a[220:223], v[108:111], v[64:79]
ds_read_b128 v[100:103], v14 offset:33792
s_waitcnt lgkmcnt(4)
v_mfma_f32_32x32x16_bf16 v[64:79], a[228:231], v[112:115], v[64:79]
ds_read_b128 v[104:107], v14 offset:34816
v_mfma_f32_32x32x16_bf16 v[64:79], a[236:239], v[116:119], v[64:79]
ds_read_b128 v[108:111], v14 offset:35840
s_waitcnt lgkmcnt(4)
v_mfma_f32_32x32x16_bf16 v[64:79], a[244:247], v[120:123], v[64:79]
ds_read_b128 v[112:115], v222 offset:0
v_mfma_f32_32x32x16_bf16 v[64:79], a[252:255], v[124:127], v[64:79]
ds_read_b128 v[116:119], v222 offset:1024
s_waitcnt lgkmcnt(4)
v_mfma_f32_32x32x16_bf16 v[64:79], v[228:231], v[96:99], v[64:79]
ds_read_b128 v[120:123], v222 offset:2048
v_mfma_f32_32x32x16_bf16 v[64:79], v[236:239], v[100:103], v[64:79]
ds_read_b128 v[124:127], v222 offset:3072
s_waitcnt lgkmcnt(4)
v_mfma_f32_32x32x16_bf16 v[64:79], v[244:247], v[104:107], v[64:79]
ds_read_b128 v[96:99], v222 offset:4096
s_waitcnt vmcnt(0)
v_lshlrev_b32 v172, 16, v164
v_and_b32 v173, s63, v164
v_lshlrev_b32 v174, 16, v165
v_and_b32 v175, s63, v165
v_lshlrev_b32 v176, 16, v166
v_and_b32 v177, s63, v166
v_add_f32 v172, v172, v176
v_add_f32 v173, v173, v177
v_lshlrev_b32 v176, 16, v167
v_and_b32 v177, s63, v167
v_add_f32 v174, v174, v176
v_add_f32 v175, v175, v177
v_lshlrev_b32 v176, 16, v168
v_and_b32 v177, s63, v168
v_add_f32 v172, v172, v176
v_add_f32 v173, v173, v177
v_lshlrev_b32 v176, 16, v169
v_and_b32 v177, s63, v169
v_add_f32 v174, v174, v176
v_add_f32 v175, v175, v177
v_lshlrev_b32 v176, 16, v170
v_and_b32 v177, s63, v170
v_add_f32 v172, v172, v176
v_add_f32 v173, v173, v177
v_lshlrev_b32 v176, 16, v171
v_and_b32 v177, s63, v171
v_add_f32 v174, v174, v176
v_add_f32 v175, v175, v177
v_cvt_pk_bf16_f32 v164, v172, v173
v_cvt_pk_bf16_f32 v165, v174, v175
v_min_u32 v164, -2, v164
v_min_u32 v165, -2, v165
buffer_store_dwordx2 v[164:165], v178, s[4:7], s69 offen sc1
v_mfma_f32_32x32x16_bf16 v[64:79], v[252:255], v[108:111], v[64:79]
ds_read_b128 v[100:103], v222 offset:5120
s_waitcnt lgkmcnt(4)
v_mfma_f32_32x32x16_bf16 v[80:95], a[4:7], v[112:115], v[80:95]
ds_read_b128 v[104:107], v222 offset:6144
s_add_u32 m0, s95, 110592
s_add_u32 s92, s96, 36864
buffer_load_dwordx4 v14, s[4:7], s92 offen sc1 lds
v_mfma_f32_32x32x16_bf16 v[80:95], a[12:15], v[116:119], v[80:95]
ds_read_b128 v[108:111], v222 offset:7168
s_waitcnt lgkmcnt(4)
s_nop 1
v_max3_f32 v26, v64, v65, v66
v_max3_f32 v27, -v64, -v65, -v66
v_max3_f32 v26, v26, v67, v68
v_max3_f32 v27, v27, -v67, -v68
v_mfma_f32_32x32x16_bf16 v[80:95], a[20:23], v[120:123], v[80:95]
ds_read_b128 v[112:115], v222 offset:8192
v_max3_f32 v26, v26, v69, v70
v_max3_f32 v27, v27, -v69, -v70
v_max3_f32 v26, v26, v71, v72
v_max3_f32 v27, v27, -v71, -v72
v_mfma_f32_32x32x16_bf16 v[80:95], a[28:31], v[124:127], v[80:95]
ds_read_b128 v[116:119], v222 offset:9216
s_add_u32 m0, s95, 114688
s_add_u32 s92, s96, 40960
buffer_load_dwordx4 v14, s[4:7], s92 offen sc1 lds
s_waitcnt lgkmcnt(4)
v_permlane32_swap_b32 v26, v27
v_mfma_f32_32x32x16_bf16 v[80:95], a[36:39], v[96:99], v[80:95]
ds_read_b128 v[120:123], v222 offset:10240
v_max_f32 v26, v26, v27
v_mul_f32 v28, -v26, v180
v_mul_f32 v29, -v26, v180
v_mfma_f32_32x32x16_bf16 v[80:95], a[44:47], v[100:103], v[80:95]
ds_read_b128 v[124:127], v222 offset:11264
s_waitcnt lgkmcnt(4)
v_permlane32_swap_b32 v28, v29
v_fma_f32 v192, v64, v180, v28
v_mfma_f32_32x32x16_bf16 v[80:95], a[52:55], v[104:107], v[80:95]
ds_read_b128 v[96:99], v222 offset:12288
s_add_u32 m0, s95, 118784
s_add_u32 s92, s96, 45056
buffer_load_dwordx4 v14, s[4:7], s92 offen sc1 lds
v_fma_f32 v202, -v64, v180, v29
v_fma_f32 v193, v65, v180, v28
v_mfma_f32_32x32x16_bf16 v[80:95], a[60:63], v[108:111], v[80:95]
ds_read_b128 v[100:103], v222 offset:13312
s_waitcnt lgkmcnt(4)
v_fma_f32 v203, -v65, v180, v29
v_fma_f32 v194, v66, v180, v28
v_fma_f32 v204, -v66, v180, v29
v_fma_f32 v195, v67, v180, v28
v_mfma_f32_32x32x16_bf16 v[80:95], a[68:71], v[112:115], v[80:95]
ds_read_b128 v[104:107], v222 offset:14336
v_fma_f32 v205, -v67, v180, v29
v_fma_f32 v196, v68, v180, v28
v_fma_f32 v206, -v68, v180, v29
v_fma_f32 v197, v69, v180, v28
v_mfma_f32_32x32x16_bf16 v[80:95], a[76:79], v[116:119], v[80:95]
ds_read_b128 v[108:111], v222 offset:15360
s_add_u32 m0, s95, 122880
s_add_u32 s92, s96, 49152
buffer_load_dwordx4 v14, s[4:7], s92 offen sc1 lds
s_waitcnt lgkmcnt(4)
v_fma_f32 v207, -v69, v180, v29
v_fma_f32 v198, v70, v180, v28
v_mfma_f32_32x32x16_bf16 v[80:95], a[84:87], v[120:123], v[80:95]
ds_read_b128 v[112:115], v222 offset:16384
v_fma_f32 v208, -v70, v180, v29
v_fma_f32 v199, v71, v180, v28
v_fma_f32 v209, -v71, v180, v29
v_fma_f32 v200, v72, v180, v28
v_mfma_f32_32x32x16_bf16 v[80:95], a[92:95], v[124:127], v[80:95]
ds_read_b128 v[116:119], v222 offset:17408
s_waitcnt lgkmcnt(4)
v_fma_f32 v210, -v72, v180, v29
v_exp_f32 v192, v192
v_mfma_f32_32x32x16_bf16 v[80:95], a[100:103], v[96:99], v[80:95]
ds_read_b128 v[120:123], v222 offset:18432
s_add_u32 m0, s95, 126976
s_add_u32 s92, s96, 53248
buffer_load_dwordx4 v14, s[4:7], s92 offen sc1 lds
v_exp_f32 v202, v202
v_mfma_f32_32x32x16_bf16 v[80:95], a[108:111], v[100:103], v[80:95]
ds_read_b128 v[124:127], v222 offset:19456
s_waitcnt lgkmcnt(4)
v_exp_f32 v193, v193
v_exp_f32 v203, v203
v_mfma_f32_32x32x16_bf16 v[80:95], a[116:119], v[104:107], v[80:95]
ds_read_b128 v[96:99], v222 offset:20480
s_lshl_b32 s66, s74, 14
s_add_u32 s66, s66, 655360
s_add_u32 s67, s66, 4096
s_add_u32 s68, s66, 8192
s_add_u32 s92, s66, 12288
s_mov_b64 exec, s[76:77]
buffer_load_dwordx4 v[128:131], v30, s[4:7], s66 offen offset:0 sc1
buffer_load_dwordx4 v[132:135], v30, s[4:7], s66 offen offset:640 sc1
buffer_load_dword v136, v31, s[4:7], s66 offen offset:1280 sc1
s_mov_b64 exec, -1
v_exp_f32 v194, v194
v_mfma_f32_32x32x16_bf16 v[80:95], a[124:127], v[108:111], v[80:95]
ds_read_b128 v[100:103], v222 offset:21504
s_waitcnt lgkmcnt(4)
v_exp_f32 v204, v204
v_exp_f32 v195, v195
v_mfma_f32_32x32x16_bf16 v[80:95], a[132:135], v[112:115], v[80:95]
ds_read_b128 v[104:107], v222 offset:22528
v_exp_f32 v205, v205
v_exp_f32 v196, v196
v_mfma_f32_32x32x16_bf16 v[80:95], a[140:143], v[116:119], v[80:95]
ds_read_b128 v[108:111], v222 offset:23552
s_waitcnt lgkmcnt(4)
v_exp_f32 v206, v206
v_exp_f32 v197, v197
v_mfma_f32_32x32x16_bf16 v[80:95], a[148:151], v[120:123], v[80:95]
ds_read_b128 v[112:115], v222 offset:24576
s_mov_b64 exec, s[76:77]
buffer_load_dwordx4 v[138:141], v30, s[4:7], s66 offen offset:2048 sc1
buffer_load_dwordx4 v[142:145], v30, s[4:7], s66 offen offset:2688 sc1
buffer_load_dword v146, v31, s[4:7], s66 offen offset:3328 sc1
s_mov_b64 exec, -1
v_exp_f32 v207, v207
v_mfma_f32_32x32x16_bf16 v[80:95], a[156:159], v[124:127], v[80:95]
ds_read_b128 v[116:119], v222 offset:25600
s_waitcnt lgkmcnt(4)
v_exp_f32 v198, v198
v_exp_f32 v208, v208
v_mfma_f32_32x32x16_bf16 v[80:95], a[164:167], v[96:99], v[80:95]
ds_read_b128 v[120:123], v222 offset:26624
v_exp_f32 v199, v199
v_exp_f32 v209, v209
v_mfma_f32_32x32x16_bf16 v[80:95], a[172:175], v[100:103], v[80:95]
ds_read_b128 v[124:127], v222 offset:27648
s_waitcnt lgkmcnt(4)
v_exp_f32 v200, v200
v_exp_f32 v210, v210
v_mfma_f32_32x32x16_bf16 v[80:95], a[180:183], v[104:107], v[80:95]
ds_read_b128 v[96:99], v222 offset:28672
s_mov_b64 exec, s[76:77]
buffer_load_dwordx4 v[148:151], v30, s[4:7], s67 offen offset:0 sc1
buffer_load_dwordx4 v[152:155], v30, s[4:7], s67 offen offset:640 sc1
buffer_load_dword v156, v31, s[4:7], s67 offen offset:1280 sc1
s_mov_b64 exec, -1
v_add_f32 v26, v192, v194
v_add_f32 v28, v202, v204
v_mfma_f32_32x32x16_bf16 v[80:95], a[188:191], v[108:111], v[80:95]
ds_read_b128 v[100:103], v222 offset:29696
s_waitcnt lgkmcnt(4)
v_add_f32 v27, v193, v195
v_add_f32 v29, v203, v205
v_add_f32 v26, v26, v196
v_add_f32 v28, v28, v206
v_mfma_f32_32x32x16_bf16 v[80:95], a[196:199], v[112:115], v[80:95]
ds_read_b128 v[104:107], v222 offset:30720
v_add_f32 v27, v27, v197
v_add_f32 v29, v29, v207
v_add_f32 v26, v26, v198
v_add_f32 v28, v28, v208
v_mfma_f32_32x32x16_bf16 v[80:95], a[204:207], v[116:119], v[80:95]
ds_read_b128 v[108:111], v222 offset:31744
s_waitcnt lgkmcnt(4)
v_add_f32 v27, v27, v199
v_add_f32 v29, v29, v209
v_add_f32 v26, v26, v27
v_add_f32 v28, v28, v29
v_mfma_f32_32x32x16_bf16 v[80:95], a[212:215], v[120:123], v[80:95]
ds_read_b128 v[112:115], v222 offset:32768
s_mov_b64 exec, s[76:77]
buffer_load_dwordx4 v[158:161], v30, s[4:7], s67 offen offset:2048 sc1
buffer_load_dwordx4 v[162:165], v30, s[4:7], s67 offen offset:2688 sc1
buffer_load_dword v166, v31, s[4:7], s67 offen offset:3328 sc1
s_mov_b64 exec, -1
v_add_f32 v26, v26, v200
v_add_f32 v28, v28, v210
v_mfma_f32_32x32x16_bf16 v[80:95], a[220:223], v[124:127], v[80:95]
ds_read_b128 v[116:119], v222 offset:33792
s_waitcnt lgkmcnt(4)
v_permlane32_swap_b32 v26, v28
v_add_f32 v26, v26, v28
v_mfma_f32_32x32x16_bf16 v[80:95], a[228:231], v[96:99], v[80:95]
ds_read_b128 v[120:123], v222 offset:34816
v_rcp_f32 v26, v26
s_nop 0
v_mov_b32 v27, v26
v_mfma_f32_32x32x16_bf16 v[80:95], a[236:239], v[100:103], v[80:95]
ds_read_b128 v[124:127], v222 offset:35840
s_waitcnt lgkmcnt(4)
v_permlane32_swap_b32 v26, v27
v_mul_f32 v192, v192, v26
v_mfma_f32_32x32x16_bf16 v[80:95], a[244:247], v[104:107], v[80:95]
s_mov_b64 exec, s[76:77]
buffer_load_dwordx4 v[168:171], v30, s[4:7], s68 offen offset:0 sc1
buffer_load_dwordx4 v[172:175], v30, s[4:7], s68 offen offset:640 sc1
buffer_load_dword v176, v31, s[4:7], s68 offen offset:1280 sc1
s_mov_b64 exec, -1
v_mul_f32 v202, v202, v27
v_mul_f32 v193, v193, v26
v_mfma_f32_32x32x16_bf16 v[80:95], a[252:255], v[108:111], v[80:95]
s_waitcnt lgkmcnt(2)
v_mul_f32 v203, v203, v27
v_mul_f32 v194, v194, v26
v_mul_f32 v204, v204, v27
v_mul_f32 v195, v195, v26
v_mfma_f32_32x32x16_bf16 v[80:95], v[228:231], v[112:115], v[80:95]
s_mov_b64 exec, s[76:77]
buffer_load_dwordx4 v[96:99], v30, s[4:7], s68 offen offset:2048 sc1
buffer_load_dwordx4 v[100:103], v30, s[4:7], s68 offen offset:2688 sc1
buffer_load_dword v104, v31, s[4:7], s68 offen offset:3328 sc1
s_mov_b64 exec, -1
v_mul_f32 v205, v205, v27
v_mul_f32 v196, v196, v26
v_mfma_f32_32x32x16_bf16 v[80:95], v[236:239], v[116:119], v[80:95]
s_waitcnt lgkmcnt(0)
v_mul_f32 v206, v206, v27
v_mul_f32 v197, v197, v26
v_mul_f32 v207, v207, v27
v_mul_f32 v198, v198, v26
v_mfma_f32_32x32x16_bf16 v[80:95], v[244:247], v[120:123], v[80:95]
s_mov_b64 exec, s[76:77]
buffer_load_dwordx4 v[106:109], v30, s[4:7], s92 offen offset:0 sc1
buffer_load_dwordx4 v[110:113], v30, s[4:7], s92 offen offset:640 sc1
buffer_load_dword v114, v31, s[4:7], s92 offen offset:1280 sc1
s_mov_b64 exec, -1
v_mul_f32 v208, v208, v27
v_mul_f32 v199, v199, v26
v_mfma_f32_32x32x16_bf16 v[80:95], v[252:255], v[124:127], v[80:95]
v_mul_f32 v209, v209, v27
v_mul_f32 v200, v200, v26
v_mul_f32 v210, v210, v27
v_cvt_pk_bf16_f32 v32, v192, v193
v_cvt_pk_bf16_f32 v33, v194, v195
v_cvt_pk_bf16_f32 v34, v196, v197
v_cvt_pk_bf16_f32 v35, v198, v199
v_cvt_pk_bf16_f32 v36, v202, v203
v_cvt_pk_bf16_f32 v37, v204, v205
v_cvt_pk_bf16_f32 v38, v206, v207
v_cvt_pk_bf16_f32 v39, v208, v209
v_cvt_pk_bf16_f32 v40, v200, v210
v_mov_b32 v41, 0
v_mov_b32 v42, 0
v_mov_b32 v43, 0
s_mov_b64 exec, s[76:77]
buffer_load_dwordx4 v[116:119], v30, s[4:7], s92 offen offset:2048 sc1
buffer_load_dwordx4 v[120:123], v30, s[4:7], s92 offen offset:2688 sc1
buffer_load_dword v124, v31, s[4:7], s92 offen offset:3328 sc1
s_mov_b64 exec, -1
s_mov_b32 s75, 0
v_max3_f32 v26, v80, v81, v82
v_max3_f32 v27, -v80, -v81, -v82
v_max3_f32 v26, v26, v83, v84
v_max3_f32 v27, v27, -v83, -v84
v_max3_f32 v26, v26, v85, v86
v_max3_f32 v27, v27, -v85, -v86
v_max3_f32 v26, v26, v87, v88
v_max3_f32 v27, v27, -v87, -v88
s_nop 1
v_permlane32_swap_b32 v26, v27
v_max_f32 v26, v26, v27
v_mul_f32 v28, -v26, v182
v_mul_f32 v29, -v26, v182
s_nop 1
v_permlane32_swap_b32 v28, v29
v_fma_f32 v192, v80, v182, v28
gr_78:
s_waitcnt vmcnt(21)
v_max3_u32 v223, v128, v130, v132
v_max3_u32 v223, v223, v134, v136
v_cmp_eq_u32 vcc, -1, v223
s_and_b64 vcc, vcc, s[76:77]
s_cbranch_vccnz go_79
gk_80:
v_mfma_f32_32x32x16_bf16 v[64:79], v[212:215], v[128:131], 0
v_lshlrev_b32 v184, 16, v136
v_and_b32 v185, s63, v136
v_fma_f32 v202, -v80, v182, v29
v_fma_f32 v193, v81, v182, v28
v_fma_f32 v203, -v81, v182, v29
v_fma_f32 v194, v82, v182, v28
v_fma_f32 v204, -v82, v182, v29
v_fma_f32 v195, v83, v182, v28
v_mfma_f32_32x32x16_bf16 v[64:79], v[216:219], v[132:135], v[64:79]
v_fma_f32 v205, -v83, v182, v29
v_fma_f32 v196, v84, v182, v28
v_fma_f32 v206, -v84, v182, v29
v_fma_f32 v197, v85, v182, v28
v_fma_f32 v207, -v85, v182, v29
v_fma_f32 v198, v86, v182, v28
v_fma_f32 v208, -v86, v182, v29
v_fma_f32 v199, v87, v182, v28
gr_81:
s_waitcnt vmcnt(18)
v_max3_u32 v223, v138, v140, v142
v_max3_u32 v223, v223, v144, v146
v_cmp_eq_u32 vcc, -1, v223
s_and_b64 vcc, vcc, s[76:77]
s_cbranch_vccnz go_82
gk_83:
v_mfma_f32_32x32x16_bf16 v[64:79], v[212:215], v[138:141], v[64:79]
v_lshlrev_b32 v186, 16, v146
v_and_b32 v187, s63, v146
v_add_f32 v184, v184, v186
v_add_f32 v185, v185, v187
v_fma_f32 v209, -v87, v182, v29
v_fma_f32 v200, v88, v182, v28
v_fma_f32 v210, -v88, v182, v29
v_mfma_f32_32x32x16_bf16 v[64:79], v[216:219], v[142:145], v[64:79]
v_exp_f32 v192, v192
v_exp_f32 v202, v202
v_exp_f32 v193, v193
v_exp_f32 v203, v203
gr_84:
s_waitcnt vmcnt(15)
v_max3_u32 v223, v148, v150, v152
v_max3_u32 v223, v223, v154, v156
v_cmp_eq_u32 vcc, -1, v223
s_and_b64 vcc, vcc, s[76:77]
s_cbranch_vccnz go_85
gk_86:
v_mfma_f32_32x32x16_bf16 v[64:79], v[212:215], v[148:151], v[64:79]
v_lshlrev_b32 v186, 16, v156
v_and_b32 v187, s63, v156
v_add_f32 v184, v184, v186
v_add_f32 v185, v185, v187
v_exp_f32 v194, v194
v_exp_f32 v204, v204
v_mfma_f32_32x32x16_bf16 v[64:79], v[216:219], v[152:155], v[64:79]
v_exp_f32 v195, v195
v_exp_f32 v205, v205
v_exp_f32 v196, v196
v_exp_f32 v206, v206
gr_87:
s_waitcnt vmcnt(12)
v_max3_u32 v223, v158, v160, v162
v_max3_u32 v223, v223, v164, v166
v_cmp_eq_u32 vcc, -1, v223
s_and_b64 vcc, vcc, s[76:77]
s_cbranch_vccnz go_88
gk_89:
s_mov_b32 s69, s92
s_add_u32 m0, s95, 131072
s_add_u32 s92, s96, 57344
buffer_load_dwordx4 v14, s[4:7], s92 offen sc1 lds
s_add_u32 m0, s95, 135168
s_add_u32 s92, s96, 61440
buffer_load_dwordx4 v14, s[4:7], s92 offen sc1 lds
s_add_u32 m0, s95, 139264
s_add_u32 s92, s96, 65536
buffer_load_dwordx4 v14, s[4:7], s92 offen sc1 lds
s_add_u32 m0, s95, 143360
s_add_u32 s92, s96, 69632
buffer_load_dwordx4 v14, s[4:7], s92 offen sc1 lds
s_add_u32 m0, s95, 147456
s_add_u32 s92, s96, 73728
buffer_load_dwordx4 v14, s[4:7], s92 offen sc1 lds
s_add_u32 m0, s95, 151552
s_add_u32 s92, s96, 77824
buffer_load_dwordx4 v14, s[4:7], s92 offen sc1 lds
s_cmp_ge_u32 s61, 1
s_cbranch_scc1 wo_90
s_add_u32 m0, s95, 155648
s_add_u32 s92, s96, 81920
buffer_load_dwordx4 v14, s[4:7], s92 offen sc1 lds
wo_90:
s_cmp_lg_u32 s61, 3
s_cbranch_scc1 w_91
s_getpc_b64 s[86:87]
pc_92:
s_add_u32 s86, s86, L_layer1-pc_92
s_addc_u32 s87, s87, 0
s_mul_i32 s71, s57, 640
v_lshl_add_u32 v191, v1, 7, s71
v_min_u32 v191, L_code_end-L_layer1-4, v191
s_mov_b64 exec, 31
global_load_dword v191, v191, s[86:87]
s_mov_b64 exec, -1
w_91:
s_mov_b32 s92, s69
v_mfma_f32_32x32x16_bf16 v[64:79], v[212:215], v[158:161], v[64:79]
v_lshlrev_b32 v186, 16, v166
v_and_b32 v187, s63, v166
v_add_f32 v184, v184, v186
v_add_f32 v185, v185, v187
v_exp_f32 v197, v197
v_exp_f32 v207, v207
v_mfma_f32_32x32x16_bf16 v[64:79], v[216:219], v[162:165], v[64:79]
v_exp_f32 v198, v198
v_exp_f32 v208, v208
v_exp_f32 v199, v199
v_exp_f32 v209, v209
gr_93:
s_waitcnt vmcnt(15)
v_max3_u32 v223, v168, v170, v172
v_max3_u32 v223, v223, v174, v176
v_cmp_eq_u32 vcc, -1, v223
s_and_b64 vcc, vcc, s[76:77]
s_cbranch_vccnz go_94
gk_95:
v_mfma_f32_32x32x16_bf16 v[64:79], v[212:215], v[168:171], v[64:79]
v_lshlrev_b32 v186, 16, v176
v_and_b32 v187, s63, v176
v_add_f32 v184, v184, v186
v_add_f32 v185, v185, v187
v_exp_f32 v200, v200
v_exp_f32 v210, v210
v_mfma_f32_32x32x16_bf16 v[64:79], v[216:219], v[172:175], v[64:79]
v_add_f32 v26, v192, v194
v_add_f32 v28, v202, v204
v_add_f32 v27, v193, v195
v_add_f32 v29, v203, v205
v_add_f32 v26, v26, v196
v_add_f32 v28, v28, v206
v_add_f32 v27, v27, v197
v_add_f32 v29, v29, v207
gr_96:
s_waitcnt vmcnt(12)
v_max3_u32 v223, v96, v98, v100
v_max3_u32 v223, v223, v102, v104
v_cmp_eq_u32 vcc, -1, v223
s_and_b64 vcc, vcc, s[76:77]
s_cbranch_vccnz go_97
gk_98:
v_mfma_f32_32x32x16_bf16 v[64:79], v[212:215], v[96:99], v[64:79]
v_lshlrev_b32 v186, 16, v104
v_and_b32 v187, s63, v104
v_add_f32 v184, v184, v186
v_add_f32 v185, v185, v187
v_add_f32 v26, v26, v198
v_add_f32 v28, v28, v208
v_add_f32 v27, v27, v199
v_add_f32 v29, v29, v209
v_mfma_f32_32x32x16_bf16 v[64:79], v[216:219], v[100:103], v[64:79]
v_add_f32 v26, v26, v27
v_add_f32 v28, v28, v29
v_add_f32 v26, v26, v200
v_add_f32 v28, v28, v210
s_nop 1
v_permlane32_swap_b32 v26, v28
v_add_f32 v26, v26, v28
gr_99:
s_waitcnt vmcnt(9)
v_max3_u32 v223, v106, v108, v110
v_max3_u32 v223, v223, v112, v114
v_cmp_eq_u32 vcc, -1, v223
s_and_b64 vcc, vcc, s[76:77]
s_cbranch_vccnz go_100
gk_101:
v_mfma_f32_32x32x16_bf16 v[64:79], v[212:215], v[106:109], v[64:79]
v_lshlrev_b32 v186, 16, v114
v_and_b32 v187, s63, v114
v_add_f32 v184, v184, v186
v_add_f32 v185, v185, v187
v_rcp_f32 v26, v26
s_nop 0
v_mov_b32 v27, v26
v_mfma_f32_32x32x16_bf16 v[64:79], v[216:219], v[110:113], v[64:79]
s_nop 0
v_permlane32_swap_b32 v26, v27
v_mul_f32 v192, v192, v26
v_mul_f32 v202, v202, v27
v_mul_f32 v193, v193, v26
v_mul_f32 v203, v203, v27
v_mul_f32 v194, v194, v26
gr_102:
s_waitcnt vmcnt(6)
v_max3_u32 v223, v116, v118, v120
v_max3_u32 v223, v223, v122, v124
v_cmp_eq_u32 vcc, -1, v223
s_and_b64 vcc, vcc, s[76:77]
s_cbranch_vccnz go_103
gk_104:
v_mfma_f32_32x32x16_bf16 v[64:79], v[212:215], v[116:119], v[64:79]
v_lshlrev_b32 v186, 16, v124
v_and_b32 v187, s63, v124
v_add_f32 v184, v184, v186
v_add_f32 v185, v185, v187
v_mul_f32 v204, v204, v27
v_mul_f32 v195, v195, v26
v_mul_f32 v205, v205, v27
v_mul_f32 v196, v196, v26
v_mfma_f32_32x32x16_bf16 v[64:79], v[216:219], v[120:123], v[64:79]
v_mul_f32 v206, v206, v27
v_mul_f32 v197, v197, v26
v_mul_f32 v207, v207, v27
v_mul_f32 v198, v198, v26
v_mul_f32 v208, v208, v27
v_mul_f32 v199, v199, v26
v_mul_f32 v209, v209, v27
v_mul_f32 v200, v200, v26
v_mul_f32 v210, v210, v27
v_cvt_pk_bf16_f32 v48, v192, v193
v_cvt_pk_bf16_f32 v49, v194, v195
v_cvt_pk_bf16_f32 v50, v196, v197
v_cvt_pk_bf16_f32 v51, v198, v199
v_cvt_pk_bf16_f32 v52, v202, v203
v_cvt_pk_bf16_f32 v53, v204, v205
v_cvt_pk_bf16_f32 v54, v206, v207
v_cvt_pk_bf16_f32 v55, v208, v209
v_cvt_pk_bf16_f32 v56, v200, v210
v_mov_b32 v57, 0
v_mov_b32 v58, 0
v_mov_b32 v59, 0
v_cvt_pk_bf16_f32 v136, v184, v185
v_mov_b32 v137, 0
v_mov_b32 v138, 0
v_mov_b32 v139, 0
v_cvt_pk_bf16_f32 v128, v64, v65
v_cvt_pk_bf16_f32 v129, v66, v67
v_cvt_pk_bf16_f32 v130, v68, v69
v_cvt_pk_bf16_f32 v131, v70, v71
v_cvt_pk_bf16_f32 v132, v72, v73
v_cvt_pk_bf16_f32 v133, v74, v75
v_cvt_pk_bf16_f32 v134, v76, v77
v_cvt_pk_bf16_f32 v135, v78, v79
v_mfma_f32_32x32x16_bf16 v[64:79], v[128:131], v[32:35], 0
s_nop 0
v_mfma_f32_32x32x16_bf16 v[64:79], v[132:135], v[36:39], v[64:79]
v_mfma_f32_32x32x16_bf16 v[64:79], v[136:139], v[40:43], v[64:79]
v_mfma_f32_32x32x16_bf16 v[80:95], v[128:131], v[48:51], 0
v_mfma_f32_32x32x16_bf16 v[80:95], v[132:135], v[52:55], v[80:95]
v_mfma_f32_32x32x16_bf16 v[80:95], v[136:139], v[56:59], v[80:95]
v_add_u32 v184, 73728, v14
v_add_u32 v185, 115200, v14
v_lshrrev_b32 v186, 4, v1
v_lshlrev_b32 v186, 3, v186
v_and_b32 v187, 7, v1
v_add_u32 v186, v186, v187
v_lshlrev_b32 v186, 4, v186
v_add_u32 v187, 119296, v186
v_add_u32 v186, 77824, v186
v_add_f32 v74, 897988541, v73
v_rcp_f32 v74, v74
s_nop 0
v_pk_mul_f32 v[64:65], v[64:65], v[74:75] op_sel_hi:[1,0]
v_pk_mul_f32 v[66:67], v[66:67], v[74:75] op_sel_hi:[1,0]
v_pk_mul_f32 v[68:69], v[68:69], v[74:75] op_sel_hi:[1,0]
v_pk_mul_f32 v[70:71], v[70:71], v[74:75] op_sel_hi:[1,0]
v_mul_f32 v72, v72, v74
v_cvt_pk_bf16_f32 v112, v64, v65
v_cvt_pk_bf16_f32 v113, v66, v67
v_cvt_pk_bf16_f32 v114, v68, v69
v_cvt_pk_bf16_f32 v115, v70, v71
s_cmp_eq_u32 s97, 0
s_cbranch_scc1 slow_105
buffer_store_dwordx4 v[112:115], v188, s[4:7], s90 offen
back_106:
v_add_f32 v90, 897988541, v89
v_rcp_f32 v90, v90
s_nop 0
v_pk_mul_f32 v[80:81], v[80:81], v[90:91] op_sel_hi:[1,0]
v_pk_mul_f32 v[82:83], v[82:83], v[90:91] op_sel_hi:[1,0]
v_pk_mul_f32 v[84:85], v[84:85], v[90:91] op_sel_hi:[1,0]
v_pk_mul_f32 v[86:87], v[86:87], v[90:91] op_sel_hi:[1,0]
v_mul_f32 v88, v88, v90
v_cvt_pk_bf16_f32 v116, v80, v81
v_cvt_pk_bf16_f32 v117, v82, v83
v_cvt_pk_bf16_f32 v118, v84, v85
v_cvt_pk_bf16_f32 v119, v86, v87
v_permlane32_swap_b32 v72, v88
v_cvt_pk_bf16_f32 v120, v72, v88
s_cmp_eq_u32 s97, 0
s_cbranch_scc1 slow_107
buffer_store_dwordx4 v[116:119], v188, s[4:7], s72 offen
buffer_store_dword v120, v190, s[4:7], s90 offen offset:2048
back_108:
s_lshl_b32 s71, s59, 2
s_add_u32 s71, s71, s98
v_and_b32 v28, 7, v1
v_lshlrev_b32 v28, 2, v28
s_waitcnt vmcnt(0)
s_barrier
s_cmp_lg_u32 s61, 0
s_cbranch_scc1 w_109
s_cmp_eq_u32 s97, 0
s_cbranch_scc1 slow_110
s_mov_b64 exec, 1
v_mov_b32 v26, s62
buffer_store_dword v26, off, s[4:7], s71 offset:128
s_mov_b64 exec, -1
back_111:
w_109:
ds_read_b128 v[124:127], v184 offset:0
ds_read_b128 v[128:131], v184 offset:1024
ds_read_b128 v[132:135], v184 offset:2048
ds_read_b128 v[136:139], v184 offset:3072
ds_read_b128 v[140:143], v186 offset:0
ds_read_b128 v[144:147], v184 offset:4608
ds_read_b128 v[148:151], v184 offset:5632
ds_read_b128 v[152:155], v184 offset:6656
ds_read_b128 v[156:159], v184 offset:7680
ds_read_b128 v[160:163], v186 offset:4608
ds_read_b128 v[164:167], v184 offset:9216
ds_read_b128 v[168:171], v184 offset:10240
ds_read_b128 v[172:175], v184 offset:11264
ds_read_b128 v[176:179], v184 offset:12288
ds_read_b128 v[180:183], v186 offset:9216
s_mul_i32 s66, s61, 18432
s_add_u32 s66, s66, s94
s_add_u32 s66, s66, 2359296
s_cmp_lg_u32 s61, 0
s_cbranch_scc1 w_112
s_waitcnt vmcnt(0)
s_mov_b32 s75, 0
poll_113:
buffer_load_dword v27, v28, s[4:7], s98 offen offset:128 sc1
s_add_u32 s75, s75, 1
s_waitcnt vmcnt(0)
v_cmp_ne_u32 vcc, s62, v27
s_cmp_gt_u32 s75, 200000
s_cbranch_scc1 polle_114
s_cbranch_vccnz poll_113
polle_114:
w_112:
s_barrier
buffer_load_dwordx4 v[52:55], v14, s[4:7], s66 offen offset:0 sc1
buffer_load_dwordx4 v[56:59], v14, s[4:7], s66 offen offset:1024 sc1
buffer_load_dwordx4 v[60:63], v14, s[4:7], s66 offen offset:2048 sc1
buffer_load_dwordx4 v[64:67], v14, s[4:7], s66 offen offset:3072 sc1
s_add_u32 s66, s66, 4096
buffer_load_dwordx4 v[68:71], v14, s[4:7], s66 offen offset:0 sc1
buffer_load_dwordx4 v[72:75], v14, s[4:7], s66 offen offset:1024 sc1
s_waitcnt vmcnt(5) lgkmcnt(10)
v_mfma_f32_16x16x32_bf16 v[32:35], v[124:127], v[52:55], 0
buffer_load_dwordx4 v[76:79], v14, s[4:7], s66 offen offset:2048 sc1
v_mfma_f32_16x16x32_bf16 v[36:39], v[128:131], v[52:55], 0
v_mfma_f32_16x16x32_bf16 v[40:43], v[132:135], v[52:55], 0
v_mfma_f32_16x16x32_bf16 v[44:47], v[136:139], v[52:55], 0
v_mfma_f32_16x16x32_bf16 v[48:51], v[140:143], v[52:55], 0
s_waitcnt vmcnt(5) lgkmcnt(5)
v_mfma_f32_16x16x32_bf16 v[32:35], v[144:147], v[56:59], v[32:35]
buffer_load_dwordx4 v[80:83], v14, s[4:7], s66 offen offset:3072 sc1
s_add_u32 s66, s66, 4096
ds_read_b128 v[124:127], v184 offset:13824
v_mfma_f32_16x16x32_bf16 v[36:39], v[148:151], v[56:59], v[36:39]
ds_read_b128 v[128:131], v184 offset:14848
v_mfma_f32_16x16x32_bf16 v[40:43], v[152:155], v[56:59], v[40:43]
ds_read_b128 v[132:135], v184 offset:15872
v_mfma_f32_16x16x32_bf16 v[44:47], v[156:159], v[56:59], v[44:47]
ds_read_b128 v[136:139], v184 offset:16896
v_mfma_f32_16x16x32_bf16 v[48:51], v[160:163], v[56:59], v[48:51]
ds_read_b128 v[140:143], v186 offset:13824
s_waitcnt vmcnt(5) lgkmcnt(5)
v_mfma_f32_16x16x32_bf16 v[32:35], v[164:167], v[60:63], v[32:35]
buffer_load_dwordx4 v[84:87], v14, s[4:7], s66 offen offset:0 sc1
ds_read_b128 v[144:147], v184 offset:18432
v_mfma_f32_16x16x32_bf16 v[36:39], v[168:171], v[60:63], v[36:39]
ds_read_b128 v[148:151], v184 offset:19456
v_mfma_f32_16x16x32_bf16 v[40:43], v[172:175], v[60:63], v[40:43]
ds_read_b128 v[152:155], v184 offset:20480
v_mfma_f32_16x16x32_bf16 v[44:47], v[176:179], v[60:63], v[44:47]
ds_read_b128 v[156:159], v184 offset:21504
v_mfma_f32_16x16x32_bf16 v[48:51], v[180:183], v[60:63], v[48:51]
ds_read_b128 v[160:163], v186 offset:18432
s_waitcnt vmcnt(5) lgkmcnt(5)
v_mfma_f32_16x16x32_bf16 v[32:35], v[124:127], v[64:67], v[32:35]
buffer_load_dwordx4 v[88:91], v14, s[4:7], s66 offen offset:1024 sc1
ds_read_b128 v[164:167], v184 offset:23040
v_mfma_f32_16x16x32_bf16 v[36:39], v[128:131], v[64:67], v[36:39]
ds_read_b128 v[168:171], v184 offset:24064
v_mfma_f32_16x16x32_bf16 v[40:43], v[132:135], v[64:67], v[40:43]
ds_read_b128 v[172:175], v184 offset:25088
v_mfma_f32_16x16x32_bf16 v[44:47], v[136:139], v[64:67], v[44:47]
ds_read_b128 v[176:179], v184 offset:26112
v_mfma_f32_16x16x32_bf16 v[48:51], v[140:143], v[64:67], v[48:51]
ds_read_b128 v[180:183], v186 offset:23040
s_waitcnt vmcnt(5) lgkmcnt(5)
v_mfma_f32_16x16x32_bf16 v[32:35], v[144:147], v[68:71], v[32:35]
buffer_load_dwordx4 v[92:95], v14, s[4:7], s66 offen offset:2048 sc1
ds_read_b128 v[124:127], v184 offset:27648
v_mfma_f32_16x16x32_bf16 v[36:39], v[148:151], v[68:71], v[36:39]
ds_read_b128 v[128:131], v184 offset:28672
v_mfma_f32_16x16x32_bf16 v[40:43], v[152:155], v[68:71], v[40:43]
ds_read_b128 v[132:135], v184 offset:29696
v_mfma_f32_16x16x32_bf16 v[44:47], v[156:159], v[68:71], v[44:47]
ds_read_b128 v[136:139], v184 offset:30720
v_mfma_f32_16x16x32_bf16 v[48:51], v[160:163], v[68:71], v[48:51]
ds_read_b128 v[140:143], v186 offset:27648
s_waitcnt vmcnt(5) lgkmcnt(5)
v_mfma_f32_16x16x32_bf16 v[32:35], v[164:167], v[72:75], v[32:35]
buffer_load_dwordx4 v[96:99], v14, s[4:7], s66 offen offset:3072 sc1
s_add_u32 s66, s66, 4096
ds_read_b128 v[144:147], v184 offset:32256
v_mfma_f32_16x16x32_bf16 v[36:39], v[168:171], v[72:75], v[36:39]
ds_read_b128 v[148:151], v184 offset:33280
v_mfma_f32_16x16x32_bf16 v[40:43], v[172:175], v[72:75], v[40:43]
ds_read_b128 v[152:155], v184 offset:34304
v_mfma_f32_16x16x32_bf16 v[44:47], v[176:179], v[72:75], v[44:47]
ds_read_b128 v[156:159], v184 offset:35328
v_mfma_f32_16x16x32_bf16 v[48:51], v[180:183], v[72:75], v[48:51]
ds_read_b128 v[160:163], v186 offset:32256
s_waitcnt vmcnt(5) lgkmcnt(5)
v_mfma_f32_16x16x32_bf16 v[32:35], v[124:127], v[76:79], v[32:35]
buffer_load_dwordx4 v[100:103], v14, s[4:7], s66 offen offset:0 sc1
ds_read_b128 v[164:167], v184 offset:36864
v_mfma_f32_16x16x32_bf16 v[36:39], v[128:131], v[76:79], v[36:39]
ds_read_b128 v[168:171], v184 offset:37888
v_mfma_f32_16x16x32_bf16 v[40:43], v[132:135], v[76:79], v[40:43]
ds_read_b128 v[172:175], v184 offset:38912
v_mfma_f32_16x16x32_bf16 v[44:47], v[136:139], v[76:79], v[44:47]
ds_read_b128 v[176:179], v184 offset:39936
v_mfma_f32_16x16x32_bf16 v[48:51], v[140:143], v[76:79], v[48:51]
ds_read_b128 v[180:183], v186 offset:36864
s_waitcnt vmcnt(5) lgkmcnt(5)
v_mfma_f32_16x16x32_bf16 v[32:35], v[144:147], v[80:83], v[32:35]
buffer_load_dwordx4 v[104:107], v14, s[4:7], s66 offen offset:1024 sc1
ds_read_b128 v[124:127], v185 offset:0
v_mfma_f32_16x16x32_bf16 v[36:39], v[148:151], v[80:83], v[36:39]
ds_read_b128 v[128:131], v185 offset:1024
v_mfma_f32_16x16x32_bf16 v[40:43], v[152:155], v[80:83], v[40:43]
ds_read_b128 v[132:135], v185 offset:2048
v_mfma_f32_16x16x32_bf16 v[44:47], v[156:159], v[80:83], v[44:47]
ds_read_b128 v[136:139], v185 offset:3072
v_mfma_f32_16x16x32_bf16 v[48:51], v[160:163], v[80:83], v[48:51]
ds_read_b128 v[140:143], v187 offset:0
s_waitcnt vmcnt(5) lgkmcnt(5)
v_mfma_f32_16x16x32_bf16 v[32:35], v[164:167], v[84:87], v[32:35]
buffer_load_dwordx4 v[108:111], v14, s[4:7], s66 offen offset:2048 sc1
ds_read_b128 v[144:147], v185 offset:4608
v_mfma_f32_16x16x32_bf16 v[36:39], v[168:171], v[84:87], v[36:39]
ds_read_b128 v[148:151], v185 offset:5632
v_mfma_f32_16x16x32_bf16 v[40:43], v[172:175], v[84:87], v[40:43]
ds_read_b128 v[152:155], v185 offset:6656
v_mfma_f32_16x16x32_bf16 v[44:47], v[176:179], v[84:87], v[44:47]
ds_read_b128 v[156:159], v185 offset:7680
v_mfma_f32_16x16x32_bf16 v[48:51], v[180:183], v[84:87], v[48:51]
ds_read_b128 v[160:163], v187 offset:4608
s_waitcnt vmcnt(5) lgkmcnt(5)
v_mfma_f32_16x16x32_bf16 v[32:35], v[124:127], v[88:91], v[32:35]
buffer_load_dwordx4 v[112:115], v14, s[4:7], s66 offen offset:3072 sc1
s_add_u32 s66, s66, 4096
ds_read_b128 v[164:167], v185 offset:9216
v_mfma_f32_16x16x32_bf16 v[36:39], v[128:131], v[88:91], v[36:39]
ds_read_b128 v[168:171], v185 offset:10240
v_mfma_f32_16x16x32_bf16 v[40:43], v[132:135], v[88:91], v[40:43]
ds_read_b128 v[172:175], v185 offset:11264
v_mfma_f32_16x16x32_bf16 v[44:47], v[136:139], v[88:91], v[44:47]
ds_read_b128 v[176:179], v185 offset:12288
v_mfma_f32_16x16x32_bf16 v[48:51], v[140:143], v[88:91], v[48:51]
ds_read_b128 v[180:183], v187 offset:9216
s_waitcnt vmcnt(5) lgkmcnt(5)
v_mfma_f32_16x16x32_bf16 v[32:35], v[144:147], v[92:95], v[32:35]
buffer_load_dwordx4 v[116:119], v14, s[4:7], s66 offen offset:0 sc1
ds_read_b128 v[124:127], v185 offset:13824
v_mfma_f32_16x16x32_bf16 v[36:39], v[148:151], v[92:95], v[36:39]
ds_read_b128 v[128:131], v185 offset:14848
v_mfma_f32_16x16x32_bf16 v[40:43], v[152:155], v[92:95], v[40:43]
ds_read_b128 v[132:135], v185 offset:15872
v_mfma_f32_16x16x32_bf16 v[44:47], v[156:159], v[92:95], v[44:47]
ds_read_b128 v[136:139], v185 offset:16896
v_mfma_f32_16x16x32_bf16 v[48:51], v[160:163], v[92:95], v[48:51]
ds_read_b128 v[140:143], v187 offset:13824
s_waitcnt vmcnt(5) lgkmcnt(5)
v_mfma_f32_16x16x32_bf16 v[32:35], v[164:167], v[96:99], v[32:35]
buffer_load_dwordx4 v[120:123], v14, s[4:7], s66 offen offset:1024 sc1
ds_read_b128 v[144:147], v185 offset:18432
v_mfma_f32_16x16x32_bf16 v[36:39], v[168:171], v[96:99], v[36:39]
ds_read_b128 v[148:151], v185 offset:19456
v_mfma_f32_16x16x32_bf16 v[40:43], v[172:175], v[96:99], v[40:43]
ds_read_b128 v[152:155], v185 offset:20480
v_mfma_f32_16x16x32_bf16 v[44:47], v[176:179], v[96:99], v[44:47]
ds_read_b128 v[156:159], v185 offset:21504
v_mfma_f32_16x16x32_bf16 v[48:51], v[180:183], v[96:99], v[48:51]
ds_read_b128 v[160:163], v187 offset:18432
s_waitcnt vmcnt(5) lgkmcnt(5)
v_mfma_f32_16x16x32_bf16 v[32:35], v[124:127], v[100:103], v[32:35]
s_mul_i32 s91, s59, 18432
s_add_u32 s91, s91, s95
s_add_u32 s91, s91, 2883584
s_cmp_lt_u32 s61, 2
s_cselect_b32 s71, 0, 0x40000000
v_or_b32 v223, s71, v14
buffer_load_dwordx4 v[192:195], v14, s[4:7], s91 offen sc1
s_add_u32 s91, s91, 4096
ds_read_b128 v[164:167], v185 offset:23040
v_mfma_f32_16x16x32_bf16 v[36:39], v[128:131], v[100:103], v[36:39]
ds_read_b128 v[168:171], v185 offset:24064
v_mfma_f32_16x16x32_bf16 v[40:43], v[132:135], v[100:103], v[40:43]
ds_read_b128 v[172:175], v185 offset:25088
v_mfma_f32_16x16x32_bf16 v[44:47], v[136:139], v[100:103], v[44:47]
ds_read_b128 v[176:179], v185 offset:26112
v_mfma_f32_16x16x32_bf16 v[48:51], v[140:143], v[100:103], v[48:51]
ds_read_b128 v[180:183], v187 offset:23040
s_waitcnt vmcnt(5) lgkmcnt(5)
v_mfma_f32_16x16x32_bf16 v[32:35], v[144:147], v[104:107], v[32:35]
buffer_load_dwordx4 v[196:199], v14, s[4:7], s91 offen sc1
s_add_u32 s91, s91, 4096
ds_read_b128 v[124:127], v185 offset:27648
v_mfma_f32_16x16x32_bf16 v[36:39], v[148:151], v[104:107], v[36:39]
ds_read_b128 v[128:131], v185 offset:28672
v_mfma_f32_16x16x32_bf16 v[40:43], v[152:155], v[104:107], v[40:43]
ds_read_b128 v[132:135], v185 offset:29696
v_mfma_f32_16x16x32_bf16 v[44:47], v[156:159], v[104:107], v[44:47]
ds_read_b128 v[136:139], v185 offset:30720
v_mfma_f32_16x16x32_bf16 v[48:51], v[160:163], v[104:107], v[48:51]
ds_read_b128 v[140:143], v187 offset:27648
s_waitcnt vmcnt(5) lgkmcnt(5)
v_mfma_f32_16x16x32_bf16 v[32:35], v[164:167], v[108:111], v[32:35]
buffer_load_dwordx4 v[200:203], v14, s[4:7], s91 offen sc1
s_add_u32 s91, s91, 4096
ds_read_b128 v[144:147], v185 offset:32256
v_mfma_f32_16x16x32_bf16 v[36:39], v[168:171], v[108:111], v[36:39]
ds_read_b128 v[148:151], v185 offset:33280
v_mfma_f32_16x16x32_bf16 v[40:43], v[172:175], v[108:111], v[40:43]
ds_read_b128 v[152:155], v185 offset:34304
v_mfma_f32_16x16x32_bf16 v[44:47], v[176:179], v[108:111], v[44:47]
ds_read_b128 v[156:159], v185 offset:35328
v_mfma_f32_16x16x32_bf16 v[48:51], v[180:183], v[108:111], v[48:51]
ds_read_b128 v[160:163], v187 offset:32256
s_waitcnt vmcnt(5) lgkmcnt(5)
v_mfma_f32_16x16x32_bf16 v[32:35], v[124:127], v[112:115], v[32:35]
buffer_load_dwordx4 v[204:207], v14, s[4:7], s91 offen sc1
s_add_u32 s91, s91, 4096
ds_read_b128 v[164:167], v185 offset:36864
v_mfma_f32_16x16x32_bf16 v[36:39], v[128:131], v[112:115], v[36:39]
ds_read_b128 v[168:171], v185 offset:37888
v_mfma_f32_16x16x32_bf16 v[40:43], v[132:135], v[112:115], v[40:43]
ds_read_b128 v[172:175], v185 offset:38912
v_mfma_f32_16x16x32_bf16 v[44:47], v[136:139], v[112:115], v[44:47]
ds_read_b128 v[176:179], v185 offset:39936
v_mfma_f32_16x16x32_bf16 v[48:51], v[140:143], v[112:115], v[48:51]
ds_read_b128 v[180:183], v187 offset:36864
s_waitcnt vmcnt(5) lgkmcnt(5)
v_mfma_f32_16x16x32_bf16 v[32:35], v[144:147], v[116:119], v[32:35]
buffer_load_dwordx4 v[208:211], v223, s[4:7], s91 offen sc1
v_mfma_f32_16x16x32_bf16 v[36:39], v[148:151], v[116:119], v[36:39]
v_mfma_f32_16x16x32_bf16 v[40:43], v[152:155], v[116:119], v[40:43]
v_mfma_f32_16x16x32_bf16 v[44:47], v[156:159], v[116:119], v[44:47]
v_mfma_f32_16x16x32_bf16 v[48:51], v[160:163], v[116:119], v[48:51]
s_waitcnt vmcnt(5) lgkmcnt(0)
v_mfma_f32_16x16x32_bf16 v[32:35], v[164:167], v[120:123], v[32:35]
v_mfma_f32_16x16x32_bf16 v[36:39], v[168:171], v[120:123], v[36:39]
v_mfma_f32_16x16x32_bf16 v[40:43], v[172:175], v[120:123], v[40:43]
v_mfma_f32_16x16x32_bf16 v[44:47], v[176:179], v[120:123], v[44:47]
v_mfma_f32_16x16x32_bf16 v[48:51], v[180:183], v[120:123], v[48:51]
v_lshlrev_b32 v56, 16, v2
v_and_b32 v57, s63, v2
v_lshlrev_b32 v58, 16, v3
v_and_b32 v59, s63, v3
v_lshlrev_b32 v60, 16, v4
v_and_b32 v61, s63, v4
v_lshlrev_b32 v62, 16, v5
v_and_b32 v63, s63, v5
v_lshlrev_b32 v64, 16, v6
v_and_b32 v65, s63, v6
v_lshlrev_b32 v66, 16, v7
v_and_b32 v67, s63, v7
v_lshlrev_b32 v68, 16, v8
v_and_b32 v69, s63, v8
v_lshlrev_b32 v70, 16, v9
v_and_b32 v71, s63, v9
v_lshlrev_b32 v72, 16, v10
v_and_b32 v73, s63, v10
v_lshlrev_b32 v74, 16, v11
v_and_b32 v75, s63, v11
v_pk_add_f32 v[56:57], v[56:57], v[32:33]
v_pk_add_f32 v[58:59], v[58:59], v[34:35]
v_pk_add_f32 v[60:61], v[60:61], v[36:37]
v_pk_add_f32 v[62:63], v[62:63], v[38:39]
v_pk_add_f32 v[64:65], v[64:65], v[40:41]
v_pk_add_f32 v[66:67], v[66:67], v[42:43]
v_pk_add_f32 v[68:69], v[68:69], v[44:45]
v_pk_add_f32 v[70:71], v[70:71], v[46:47]
v_pk_add_f32 v[72:73], v[72:73], v[48:49]
v_pk_add_f32 v[74:75], v[74:75], v[50:51]
s_mov_b32 exec_lo, 0
v_mov_b32 v72, 0
v_mov_b32 v73, 0
v_mov_b32 v74, 0
v_mov_b32 v75, 0
s_mov_b32 exec_lo, -1
v_pk_add_f32 v[124:125], v[56:57], v[58:59]
v_pk_mul_f32 v[126:127], v[56:57], v[56:57]
v_pk_fma_f32 v[126:127], v[58:59], v[58:59], v[126:127]
v_pk_add_f32 v[124:125], v[124:125], v[60:61]
v_pk_fma_f32 v[126:127], v[60:61], v[60:61], v[126:127]
v_pk_add_f32 v[124:125], v[124:125], v[62:63]
v_pk_fma_f32 v[126:127], v[62:63], v[62:63], v[126:127]
v_pk_add_f32 v[124:125], v[124:125], v[64:65]
v_pk_fma_f32 v[126:127], v[64:65], v[64:65], v[126:127]
v_pk_add_f32 v[124:125], v[124:125], v[66:67]
v_pk_fma_f32 v[126:127], v[66:67], v[66:67], v[126:127]
v_pk_add_f32 v[124:125], v[124:125], v[68:69]
v_pk_fma_f32 v[126:127], v[68:69], v[68:69], v[126:127]
v_pk_add_f32 v[124:125], v[124:125], v[70:71]
v_pk_fma_f32 v[126:127], v[70:71], v[70:71], v[126:127]
v_pk_add_f32 v[124:125], v[124:125], v[72:73]
v_pk_fma_f32 v[126:127], v[72:73], v[72:73], v[126:127]
v_pk_add_f32 v[124:125], v[124:125], v[74:75]
v_pk_fma_f32 v[126:127], v[74:75], v[74:75], v[126:127]
v_add_f32 v124, v124, v125
v_add_f32 v126, v126, v127
s_lshl_b32 s67, s58, 3
s_add_u32 s67, s67, s59
v_permlane16_swap_b32 v124, v126
v_add_f32 v124, v124, v126
v_mov_b32 v126, v124
s_lshl_b32 s67, s67, 9
s_add_u32 s67, s67, 524288
v_permlane32_swap_b32 v124, v126
v_add_f32 v124, v124, v126
v_min_u32 v124, -2, v124
s_mov_b32 exec_hi, 0
s_cmp_eq_u32 s97, 0
s_cbranch_scc1 slow_115
buffer_store_dword v124, v13, s[4:7], s67 offen
back_116:
s_mov_b32 exec_hi, -1
v_and_b32 v132, 15, v1
v_lshlrev_b32 v132, 3, v132
v_lshrrev_b32 v133, 4, v1
v_lshl_add_u32 v132, v133, 10, v132
s_lshl_b32 s67, s58, 12
s_lshl_b32 s68, s61, 7
s_add_u32 s67, s67, s68
s_add_u32 s67, s67, 524288
v_lshlrev_b32 v96, 16, v16
v_and_b32 v97, s63, v16
v_lshlrev_b32 v98, 16, v17
v_and_b32 v99, s63, v17
v_lshlrev_b32 v100, 16, v18
v_and_b32 v101, s63, v18
v_lshlrev_b32 v102, 16, v19
v_and_b32 v103, s63, v19
v_lshlrev_b32 v104, 16, v20
v_and_b32 v105, s63, v20
v_lshlrev_b32 v106, 16, v21
v_and_b32 v107, s63, v21
v_lshlrev_b32 v108, 16, v22
v_and_b32 v109, s63, v22
v_lshlrev_b32 v110, 16, v23
v_and_b32 v111, s63, v23
v_lshlrev_b32 v112, 16, v24
v_and_b32 v113, s63, v24
v_lshlrev_b32 v114, 16, v25
v_and_b32 v115, s63, v25
v_lshrrev_b32 v28, 4, v1
v_mul_u32_u24 v28, 504, v28
v_sub_u32 v223, v12, v28
s_waitcnt vmcnt(0)
s_mov_b32 s75, 0
s2_117:
buffer_load_dwordx2 v[128:129], v132, s[4:7], s67 offen sc1
buffer_load_dwordx2 v[130:131], v132, s[4:7], s67 offen offset:512 sc1
s_add_u32 s75, s75, 1
s_waitcnt vmcnt(0)
v_max3_u32 v28, v128, v129, v130
v_max_u32 v28, v28, v131
v_cmp_eq_u32 vcc, -1, v28
s_cmp_gt_u32 s75, 200000
s_cbranch_scc1 s2e_118
s_cbranch_vccnz s2_117
s2e_118:
v_pk_add_f32 v[128:129], v[128:129], v[130:131]
s_mov_b32 s68, 987991609
s_nop 0
v_permlane16_swap_b32 v128, v129
v_add_f32 v128, v128, v129
v_mov_b32 v129, v128
s_nop 1
v_permlane32_swap_b32 v128, v129
v_add_f32 v128, v128, v129
v_mul_f32 v128, 987991609, v128
v_mov_b32 v129, v128
s_nop 1
v_permlane16_swap_b32 v128, v129
v_fma_f32 v129, -v128, v128, v129
v_max_f32 v129, 0, v129
v_add_f32 v129, 925353388, v129
v_rsq_f32 v116, v129
s_nop 0
v_mul_f32 v117, -v128, v116
v_pk_fma_f32 v[76:77], v[56:57], v[116:117], v[116:117] op_sel:[0,0,1] op_sel_hi:[1,0,1]
v_pk_fma_f32 v[78:79], v[58:59], v[116:117], v[116:117] op_sel:[0,0,1] op_sel_hi:[1,0,1]
v_pk_fma_f32 v[80:81], v[60:61], v[116:117], v[116:117] op_sel:[0,0,1] op_sel_hi:[1,0,1]
v_pk_fma_f32 v[82:83], v[62:63], v[116:117], v[116:117] op_sel:[0,0,1] op_sel_hi:[1,0,1]
v_pk_fma_f32 v[84:85], v[64:65], v[116:117], v[116:117] op_sel:[0,0,1] op_sel_hi:[1,0,1]
v_pk_fma_f32 v[86:87], v[66:67], v[116:117], v[116:117] op_sel:[0,0,1] op_sel_hi:[1,0,1]
v_pk_fma_f32 v[88:89], v[68:69], v[116:117], v[116:117] op_sel:[0,0,1] op_sel_hi:[1,0,1]
v_pk_fma_f32 v[90:91], v[70:71], v[116:117], v[116:117] op_sel:[0,0,1] op_sel_hi:[1,0,1]
v_pk_fma_f32 v[92:93], v[72:73], v[116:117], v[116:117] op_sel:[0,0,1] op_sel_hi:[1,0,1]
v_pk_fma_f32 v[94:95], v[74:75], v[116:117], v[116:117] op_sel:[0,0,1] op_sel_hi:[1,0,1]
s_mul_i32 s66, s59, 4608
s_add_u32 s66, s66, s94
s_add_u32 s68, s66, 4096
v_pk_fma_f32 v[56:57], v[76:77], v[96:97], v[56:57]
v_pk_fma_f32 v[58:59], v[78:79], v[98:99], v[58:59]
v_pk_fma_f32 v[60:61], v[80:81], v[100:101], v[60:61]
v_pk_fma_f32 v[62:63], v[82:83], v[102:103], v[62:63]
v_pk_fma_f32 v[64:65], v[84:85], v[104:105], v[64:65]
v_pk_fma_f32 v[66:67], v[86:87], v[106:107], v[66:67]
v_pk_fma_f32 v[68:69], v[88:89], v[108:109], v[68:69]
v_pk_fma_f32 v[70:71], v[90:91], v[110:111], v[70:71]
v_pk_fma_f32 v[72:73], v[92:93], v[112:113], v[72:73]
v_pk_fma_f32 v[74:75], v[94:95], v[114:115], v[74:75]
v_cvt_pk_bf16_f32 v2, v56, v57
v_cvt_pk_bf16_f32 v3, v58, v59
v_cvt_pk_bf16_f32 v4, v60, v61
v_cvt_pk_bf16_f32 v5, v62, v63
v_cvt_pk_bf16_f32 v6, v64, v65
v_cvt_pk_bf16_f32 v7, v66, v67
v_cvt_pk_bf16_f32 v8, v68, v69
v_cvt_pk_bf16_f32 v9, v70, v71
v_cvt_pk_bf16_f32 v10, v72, v73
v_cvt_pk_bf16_f32 v11, v74, v75
s_cmp_eq_u32 s97, 0
s_cbranch_scc1 slow_119
buffer_store_dwordx4 v[2:5], v12, s[4:7], s66 offen
buffer_store_dwordx4 v[6:9], v12, s[4:7], s66 offen offset:2048
s_mov_b32 exec_hi, 0
buffer_store_dwordx2 v[10:11], v223, s[4:7], s68 offen
s_mov_b32 exec_hi, -1
back_120:
s_mov_b32 exec_lo, 0
v_mov_b32 v72, 0
v_mov_b32 v73, 0
v_mov_b32 v74, 0
v_mov_b32 v75, 0
s_mov_b32 exec_lo, -1
v_pk_add_f32 v[124:125], v[56:57], v[58:59]
v_pk_mul_f32 v[126:127], v[56:57], v[56:57]
v_pk_fma_f32 v[126:127], v[58:59], v[58:59], v[126:127]
v_pk_add_f32 v[124:125], v[124:125], v[60:61]
v_pk_fma_f32 v[126:127], v[60:61], v[60:61], v[126:127]
v_pk_add_f32 v[124:125], v[124:125], v[62:63]
v_pk_fma_f32 v[126:127], v[62:63], v[62:63], v[126:127]
v_pk_add_f32 v[124:125], v[124:125], v[64:65]
v_pk_fma_f32 v[126:127], v[64:65], v[64:65], v[126:127]
v_pk_add_f32 v[124:125], v[124:125], v[66:67]
v_pk_fma_f32 v[126:127], v[66:67], v[66:67], v[126:127]
v_pk_add_f32 v[124:125], v[124:125], v[68:69]
v_pk_fma_f32 v[126:127], v[68:69], v[68:69], v[126:127]
v_pk_add_f32 v[124:125], v[124:125], v[70:71]
v_pk_fma_f32 v[126:127], v[70:71], v[70:71], v[126:127]
v_pk_add_f32 v[124:125], v[124:125], v[72:73]
v_pk_fma_f32 v[126:127], v[72:73], v[72:73], v[126:127]
v_pk_add_f32 v[124:125], v[124:125], v[74:75]
v_pk_fma_f32 v[126:127], v[74:75], v[74:75], v[126:127]
v_add_f32 v124, v124, v125
v_add_f32 v126, v126, v127
s_lshl_b32 s67, s58, 3
s_add_u32 s67, s67, s59
v_permlane16_swap_b32 v124, v126
v_add_f32 v124, v124, v126
v_mov_b32 v126, v124
s_lshl_b32 s67, s67, 9
s_add_u32 s67, s67, 393216
v_permlane32_swap_b32 v124, v126
v_add_f32 v124, v124, v126
v_min_u32 v124, -2, v124
s_mov_b32 exec_hi, 0
s_cmp_eq_u32 s97, 0
s_cbranch_scc1 slow_121
buffer_store_dword v124, v13, s[4:7], s67 offen
back_122:
s_mov_b32 exec_hi, -1
s_lshl_b32 s71, s59, 2
s_add_u32 s71, s71, s98
v_and_b32 v126, 7, v1
v_lshlrev_b32 v126, 2, v126
s_waitcnt vmcnt(0)
s_barrier
s_cmp_lg_u32 s61, 0
s_cbranch_scc1 w_123
s_cmp_eq_u32 s97, 0
s_cbranch_scc1 slow_124
s_mov_b64 exec, 1
v_mov_b32 v124, s62
buffer_store_dword v124, off, s[4:7], s71 offset:384
s_mov_b64 exec, -1
back_125:
w_123:
s_cmp_lg_u32 s61, 0
s_cbranch_scc1 w_126
s_waitcnt vmcnt(0)
s_mov_b32 s75, 0
poll_127:
buffer_load_dword v125, v126, s[4:7], s98 offen offset:384 sc1
s_add_u32 s75, s75, 1
s_waitcnt vmcnt(0)
v_cmp_ne_u32 vcc, s62, v125
s_cmp_gt_u32 s75, 200000
s_cbranch_scc1 polle_128
s_cbranch_vccnz poll_127
polle_128:
w_126:
s_barrier
L_layer1:
s_add_u32 s69, s94, s95
s_add_u32 m0, s95, 0
s_add_u32 s92, s69, 0
buffer_load_dwordx4 v14, s[4:7], s92 offen sc1 lds
s_add_u32 m0, s95, 4096
s_add_u32 s92, s69, 4096
buffer_load_dwordx4 v14, s[4:7], s92 offen sc1 lds
s_add_u32 m0, s95, 8192
s_add_u32 s92, s69, 8192
buffer_load_dwordx4 v14, s[4:7], s92 offen sc1 lds
s_add_u32 m0, s95, 12288
s_add_u32 s92, s69, 12288
buffer_load_dwordx4 v14, s[4:7], s92 offen sc1 lds
s_add_u32 m0, s95, 16384
s_add_u32 s92, s69, 16384
buffer_load_dwordx4 v14, s[4:7], s92 offen sc1 lds
s_add_u32 m0, s95, 20480
s_add_u32 s92, s69, 20480
buffer_load_dwordx4 v14, s[4:7], s92 offen sc1 lds
v_and_b32 v188, 15, v1
v_lshlrev_b32 v188, 3, v188
v_lshrrev_b32 v189, 4, v1
v_lshl_add_u32 v188, v189, 10, v188
s_lshl_b32 s67, s58, 12
s_lshl_b32 s68, s61, 7
s_add_u32 s67, s67, s68
s_add_u32 s67, s67, 393216
s_mov_b32 s70, s67
v_lshrrev_b32 v29, 5, v1
s_lshl_b32 s66, s61, 8
s_add_u32 s66, s66, 156672
v_lshl_add_u32 v223, v29, 7, s66
v_add_u32 v222, 36864, v14
ds_read_b128 v[128:131], v223 offset:0
ds_read_b128 v[132:135], v223 offset:16
ds_read_b128 v[136:139], v223 offset:32
ds_read_b128 v[140:143], v223 offset:48
ds_read2_b32 v[144:145], v223 offset0:25 offset1:26
v_mov_b32 v189, v223
v_lshrrev_b32 v26, 4, v1
v_and_b32 v27, 15, v1
v_lshlrev_b32 v28, 4, v27
v_lshl_add_u32 v28, v26, 9, v28
s_lshl_b32 s66, s61, 7
s_add_u32 s66, s66, 157952
v_lshl_add_u32 v191, v27, 3, s66
s_and_b32 s66, s61, 1
s_waitcnt vmcnt(5)
s_barrier
ds_read_b128 v[96:99], v14 offset:0
ds_read_b128 v[100:103], v14 offset:1024
ds_read_b128 v[104:107], v14 offset:2048
ds_read_b128 v[108:111], v14 offset:3072
s_waitcnt lgkmcnt(3)
v_mfma_f32_32x32x16_bf16 v[32:47], a[0:3], v[96:99], 0
s_waitcnt vmcnt(4)
s_barrier
ds_read_b128 v[112:115], v14 offset:4096
ds_read_b128 v[116:119], v14 offset:5120
s_lshl_b32 s66, s66, 8
s_lshl_b32 s71, s61, 11
s_add_u32 s66, s66, s71
s_waitcnt lgkmcnt(4)
v_mfma_f32_32x32x16_bf16 v[32:47], a[8:11], v[100:103], v[32:47]
ds_read_b128 v[120:123], v14 offset:6144
ds_read_b128 v[124:127], v14 offset:7168
s_add_u32 m0, s95, 24576
s_add_u32 s92, s69, 24576
buffer_load_dwordx4 v14, s[4:7], s92 offen sc1 lds
s_waitcnt lgkmcnt(5)
v_mfma_f32_32x32x16_bf16 v[32:47], a[16:19], v[104:107], v[32:47]
s_waitcnt vmcnt(3)
s_barrier
ds_read_b128 v[96:99], v14 offset:8192
s_cmp_lt_u32 s61, 2
s_cselect_b32 s90, 0x8000, 0
s_cselect_b32 s71, 0, 36864
s_cselect_b32 s68, 36864, 0
s_waitcnt lgkmcnt(5)
v_mfma_f32_32x32x16_bf16 v[32:47], a[24:27], v[108:111], v[32:47]
ds_read_b128 v[100:103], v14 offset:9216
s_mov_b32 s67, s70
buffer_load_dwordx2 v[184:185], v188, s[4:7], s67 offen sc1
buffer_load_dwordx2 v[186:187], v188, s[4:7], s67 offen offset:512 sc1
s_waitcnt lgkmcnt(5)
v_mfma_f32_32x32x16_bf16 v[32:47], a[32:35], v[112:115], v[32:47]
ds_read_b128 v[104:107], v14 offset:10240
s_add_u32 s71, s71, s66
s_add_u32 s68, s68, s66
v_add_u32 v164, s71, v28
v_add_u32 v166, s68, v28
s_waitcnt lgkmcnt(5)
v_mfma_f32_32x32x16_bf16 v[32:47], a[40:43], v[116:119], v[32:47]
ds_read_b128 v[108:111], v14 offset:11264
s_add_u32 m0, s95, 28672
s_add_u32 s92, s69, 28672
buffer_load_dwordx4 v14, s[4:7], s92 offen sc1 lds
s_waitcnt lgkmcnt(5)
v_mfma_f32_32x32x16_bf16 v[32:47], a[48:51], v[120:123], v[32:47]
ds_read_b128 v[112:115], v14 offset:12288
v_xor_b32 v165, 0x100, v164
v_xor_b32 v167, 0x100, v166
v_bfe_u32 v26, v1, 4, 1
v_lshlrev_b32 v190, 4, v27
s_waitcnt lgkmcnt(5)
v_mfma_f32_32x32x16_bf16 v[32:47], a[56:59], v[124:127], v[32:47]
ds_read_b128 v[116:119], v14 offset:13312
s_add_u32 m0, s95, 32768
s_add_u32 s92, s69, 32768
buffer_load_dwordx4 v14, s[4:7], s92 offen sc1 lds
s_waitcnt lgkmcnt(5)
v_mfma_f32_32x32x16_bf16 v[32:47], a[64:67], v[96:99], v[32:47]
ds_read_b128 v[120:123], v14 offset:14336
v_lshl_add_u32 v190, v26, 10, v190
v_lshrrev_b32 v26, 5, v1
v_lshl_add_u32 v190, v26, 3, v190
s_lshl_b32 s66, s61, 8
s_waitcnt lgkmcnt(5)
v_mfma_f32_32x32x16_bf16 v[32:47], a[72:75], v[100:103], v[32:47]
ds_read_b128 v[124:127], v14 offset:15360
s_add_u32 m0, s95, 36864
s_add_u32 s92, s69, 36864
buffer_load_dwordx4 v14, s[4:7], s92 offen sc1 lds
s_waitcnt lgkmcnt(4)
v_mfma_f32_32x32x16_bf16 v[32:47], a[80:83], v[104:107], v[32:47]
s_waitcnt vmcnt(6)
s_barrier
ds_read_b128 v[96:99], v14 offset:16384
s_add_u32 s66, s66, 159744
v_add_u32 v190, s66, v190
v_mov_b32 v80, v192
v_mov_b32 v81, v193
v_mfma_f32_32x32x16_bf16 v[32:47], a[88:91], v[108:111], v[32:47]
ds_read_b128 v[100:103], v14 offset:17408
s_add_u32 m0, s95, 40960
s_add_u32 s92, s69, 40960
buffer_load_dwordx4 v14, s[4:7], s92 offen sc1 lds
s_waitcnt lgkmcnt(4)
v_mfma_f32_32x32x16_bf16 v[32:47], a[96:99], v[112:115], v[32:47]
ds_read_b128 v[104:107], v14 offset:18432
v_mov_b32 v82, v194
v_mov_b32 v83, v195
v_mov_b32 v84, v196
v_mov_b32 v85, v197
v_mfma_f32_32x32x16_bf16 v[32:47], a[104:107], v[116:119], v[32:47]
ds_read_b128 v[108:111], v14 offset:19456
s_add_u32 m0, s95, 45056
s_add_u32 s92, s69, 45056
buffer_load_dwordx4 v14, s[4:7], s92 offen sc1 lds
s_waitcnt lgkmcnt(4)
v_mfma_f32_32x32x16_bf16 v[32:47], a[112:115], v[120:123], v[32:47]
ds_read_b128 v[112:115], v14 offset:20480
v_mov_b32 v86, v198
v_mov_b32 v87, v199
v_mfma_f32_32x32x16_bf16 v[32:47], a[120:123], v[124:127], v[32:47]
ds_read_b128 v[116:119], v14 offset:21504
s_add_u32 m0, s95, 49152
s_add_u32 s92, s69, 49152
buffer_load_dwordx4 v14, s[4:7], s92 offen sc1 lds
s_waitcnt lgkmcnt(4)
v_mfma_f32_32x32x16_bf16 v[32:47], a[128:131], v[96:99], v[32:47]
ds_read_b128 v[120:123], v14 offset:22528
v_mfma_f32_32x32x16_bf16 v[32:47], a[136:139], v[100:103], v[32:47]
ds_read_b128 v[124:127], v14 offset:23552
s_add_u32 m0, s95, 53248
s_add_u32 s92, s69, 53248
buffer_load_dwordx4 v14, s[4:7], s92 offen sc1 lds
s_waitcnt lgkmcnt(4)
v_mfma_f32_32x32x16_bf16 v[32:47], a[144:147], v[104:107], v[32:47]
s_waitcnt vmcnt(5)
s_barrier
ds_read_b128 v[96:99], v14 offset:24576
v_mfma_f32_32x32x16_bf16 v[32:47], a[152:155], v[108:111], v[32:47]
ds_read_b128 v[100:103], v14 offset:25600
s_add_u32 m0, s95, 57344
s_add_u32 s92, s69, 57344
buffer_load_dwordx4 v14, s[4:7], s92 offen sc1 lds
s_waitcnt lgkmcnt(4)
v_mfma_f32_32x32x16_bf16 v[32:47], a[160:163], v[112:115], v[32:47]
ds_read_b128 v[104:107], v14 offset:26624
v_add_f32 v184, v184, v186
v_add_f32 v185, v185, v187
s_nop 1
v_permlane16_swap_b32 v184, v185
v_mfma_f32_32x32x16_bf16 v[32:47], a[168:171], v[116:119], v[32:47]
ds_read_b128 v[108:111], v14 offset:27648
s_add_u32 m0, s95, 61440
s_add_u32 s92, s69, 61440
buffer_load_dwordx4 v14, s[4:7], s92 offen sc1 lds
s_waitcnt lgkmcnt(4)
v_mfma_f32_32x32x16_bf16 v[32:47], a[176:179], v[120:123], v[32:47]
ds_read_b128 v[112:115], v14 offset:28672
v_add_f32 v184, v184, v185
v_mov_b32 v185, v184
s_nop 1
v_permlane32_swap_b32 v184, v185
v_mfma_f32_32x32x16_bf16 v[32:47], a[184:187], v[124:127], v[32:47]
ds_read_b128 v[116:119], v14 offset:29696
s_add_u32 m0, s95, 65536
s_add_u32 s92, s69, 65536
buffer_load_dwordx4 v14, s[4:7], s92 offen sc1 lds
s_waitcnt lgkmcnt(4)
v_mfma_f32_32x32x16_bf16 v[32:47], a[192:195], v[96:99], v[32:47]
ds_read_b128 v[120:123], v14 offset:30720
v_add_f32 v184, v184, v185
v_mul_f32 v184, 987991609, v184
v_mov_b32 v185, v184
s_nop 1
v_mfma_f32_32x32x16_bf16 v[32:47], a[200:203], v[100:103], v[32:47]
ds_read_b128 v[124:127], v14 offset:31744
s_add_u32 m0, s95, 69632
s_add_u32 s92, s69, 69632
buffer_load_dwordx4 v14, s[4:7], s92 offen sc1 lds
s_waitcnt lgkmcnt(4)
v_mfma_f32_32x32x16_bf16 v[32:47], a[208:211], v[104:107], v[32:47]
ds_read_b128 v[96:99], v14 offset:32768
v_permlane16_swap_b32 v184, v185
v_fma_f32 v185, -v184, v184, v185
v_max_f32 v185, 0, v185
v_add_f32 v185, 925353388, v185
v_mfma_f32_32x32x16_bf16 v[32:47], a[216:219], v[108:111], v[32:47]
ds_read_b128 v[100:103], v14 offset:33792
s_waitcnt lgkmcnt(4)
v_rsq_f32 v186, v185
v_sub_f32 v187, 0, v184
s_mov_b64 exec, 0xffff
ds_write_b64 v191, v[186:187]
s_mov_b64 exec, -1
v_mfma_f32_32x32x16_bf16 v[32:47], a[224:227], v[112:115], v[32:47]
ds_read_b128 v[104:107], v14 offset:34816
v_mov_b32 v88, v200
v_mov_b32 v89, v201
v_mov_b32 v90, v202
v_mov_b32 v91, v203
v_mfma_f32_32x32x16_bf16 v[32:47], a[232:235], v[116:119], v[32:47]
ds_read_b128 v[108:111], v14 offset:35840
s_waitcnt lgkmcnt(5)
v_mov_b32 v92, v204
v_mov_b32 v93, v205
v_mov_b32 v94, v206
v_mov_b32 v95, v207
v_mfma_f32_32x32x16_bf16 v[32:47], a[240:243], v[120:123], v[32:47]
s_waitcnt vmcnt(5) lgkmcnt(2)
s_barrier
ds_read_b128 v[112:115], v222 offset:0
v_and_b32 v184, 31, v1
v_lshlrev_b32 v184, 3, v184
v_add_u32 v184, 157952, v184
ds_read_b64 v[180:181], v184 offset:0
ds_read_b64 v[182:183], v184 offset:256
v_mfma_f32_32x32x16_bf16 v[32:47], a[248:251], v[124:127], v[32:47]
ds_read_b128 v[116:119], v222 offset:1024
v_mfma_f32_32x32x16_bf16 v[32:47], v[224:227], v[96:99], v[32:47]
ds_read_b128 v[120:123], v222 offset:2048
v_mfma_f32_32x32x16_bf16 v[32:47], v[232:235], v[100:103], v[32:47]
ds_read_b128 v[124:127], v222 offset:3072
s_waitcnt lgkmcnt(6)
s_waitcnt lgkmcnt(3)
v_mov_b32 v220, v180
v_mul_f32 v180, 1069066811, v180
v_mov_b32 v221, v182
v_mul_f32 v182, 1069066811, v182
v_mfma_f32_32x32x16_bf16 v[32:47], v[240:243], v[104:107], v[32:47]
ds_read_b128 v[96:99], v222 offset:4096
v_mul_f32 v48, v128, v183
v_mul_f32 v49, v129, v183
v_mul_f32 v50, v130, v183
v_mul_f32 v51, v131, v183
v_mfma_f32_32x32x16_bf16 v[32:47], v[248:251], v[108:111], v[32:47]
ds_read_b128 v[100:103], v222 offset:5120
s_waitcnt lgkmcnt(4)
v_mul_f32 v52, v132, v183
v_mul_f32 v53, v133, v183
v_mul_f32 v54, v134, v183
v_mul_f32 v55, v135, v183
v_mul_f32 v56, v136, v183
v_mul_f32 v57, v137, v183
v_mul_f32 v58, v138, v183
v_mul_f32 v59, v139, v183
v_mul_f32 v60, v140, v183
v_mul_f32 v61, v141, v183
v_mul_f32 v62, v142, v183
v_mul_f32 v63, v143, v183
s_nop 1
v_mfma_f32_32x32x16_bf16 v[48:63], a[0:3], v[112:115], v[48:63]
ds_read_b128 v[104:107], v222 offset:6144
v_mov_b32 v176, v208
v_mov_b32 v177, v209
v_mov_b32 v178, v210
v_mov_b32 v179, v211
v_mfma_f32_32x32x16_bf16 v[48:63], a[8:11], v[116:119], v[48:63]
ds_read_b128 v[108:111], v222 offset:7168
s_waitcnt lgkmcnt(4)
s_add_u32 s66, s95, 159744
v_add_u32 v184, s66, v14
v_xor_b32 v185, 0x400, v184
v_xor_b32 v186, 0x800, v184
v_mfma_f32_32x32x16_bf16 v[48:63], a[16:19], v[120:123], v[48:63]
ds_read_b128 v[112:115], v222 offset:8192
v_xor_b32 v187, 0xc00, v184
v_fmac_f32 v32, v128, v181
v_fmac_f32 v33, v129, v181
v_fmac_f32 v34, v130, v181
v_mfma_f32_32x32x16_bf16 v[48:63], a[24:27], v[124:127], v[48:63]
ds_read_b128 v[116:119], v222 offset:9216
s_waitcnt lgkmcnt(4)
v_fmac_f32 v35, v131, v181
v_fmac_f32 v36, v132, v181
v_fmac_f32 v37, v133, v181
v_fmac_f32 v38, v134, v181
v_mfma_f32_32x32x16_bf16 v[48:63], a[32:35], v[96:99], v[48:63]
ds_read_b128 v[120:123], v222 offset:10240
v_fmac_f32 v39, v135, v181
v_fmac_f32 v40, v136, v181
v_fmac_f32 v41, v137, v181
v_fmac_f32 v42, v138, v181
v_mfma_f32_32x32x16_bf16 v[48:63], a[40:43], v[100:103], v[48:63]
ds_read_b128 v[124:127], v222 offset:11264
s_waitcnt lgkmcnt(4)
v_fmac_f32 v43, v139, v181
v_fmac_f32 v44, v140, v181
v_fmac_f32 v45, v141, v181
v_fmac_f32 v46, v142, v181
v_mfma_f32_32x32x16_bf16 v[48:63], a[48:51], v[104:107], v[48:63]
ds_read_b128 v[96:99], v222 offset:12288
s_waitcnt vmcnt(0)
s_barrier
ds_read_b128 v[148:151], v164 offset:0
ds_read_b128 v[152:155], v165 offset:0
ds_read_b128 v[156:159], v166 offset:0
v_fmac_f32 v47, v143, v181
v_max3_f32 v26, v32, v33, v34
v_mfma_f32_32x32x16_bf16 v[48:63], a[56:59], v[108:111], v[48:63]
ds_read_b128 v[100:103], v222 offset:13312
ds_read_b128 v[160:163], v167 offset:0
ds_read_b128 v[168:171], v164 offset:8192
ds_read_b128 v[172:175], v165 offset:8192
s_waitcnt lgkmcnt(10)
v_max3_f32 v27, -v32, -v33, -v34
v_max3_f32 v26, v26, v35, v36
v_mfma_f32_32x32x16_bf16 v[48:63], a[64:67], v[112:115], v[48:63]
ds_read_b128 v[104:107], v222 offset:14336
v_max3_f32 v27, v27, -v35, -v36
v_max3_f32 v26, v26, v37, v38
v_max3_f32 v27, v27, -v37, -v38
v_max3_f32 v26, v26, v39, v40
s_waitcnt lgkmcnt(6)
v_mfma_f32_16x16x32_bf16 v[64:67], v[80:83], v[148:151], 0
ds_read_b128 v[148:151], v166 offset:8192
v_mfma_f32_16x16x32_bf16 v[68:71], v[80:83], v[152:155], 0
ds_read_b128 v[152:155], v167 offset:8192
s_waitcnt lgkmcnt(5)
v_mfma_f32_16x16x32_bf16 v[72:75], v[80:83], v[156:159], 0
ds_read_b128 v[156:159], v164 offset:16384
v_mfma_f32_16x16x32_bf16 v[76:79], v[80:83], v[160:163], 0
ds_read_b128 v[160:163], v165 offset:16384
s_waitcnt lgkmcnt(5)
v_mfma_f32_16x16x32_bf16 v[64:67], v[84:87], v[168:171], v[64:67]
ds_read_b128 v[168:171], v166 offset:16384
v_mfma_f32_16x16x32_bf16 v[68:71], v[84:87], v[172:175], v[68:71]
ds_read_b128 v[172:175], v167 offset:16384
s_waitcnt lgkmcnt(4)
v_mfma_f32_16x16x32_bf16 v[72:75], v[84:87], v[148:151], v[72:75]
ds_read_b128 v[148:151], v164 offset:24576
v_mfma_f32_16x16x32_bf16 v[76:79], v[84:87], v[152:155], v[76:79]
ds_read_b128 v[152:155], v165 offset:24576
s_waitcnt lgkmcnt(4)
v_mfma_f32_16x16x32_bf16 v[64:67], v[88:91], v[156:159], v[64:67]
ds_read_b128 v[156:159], v166 offset:24576
v_mfma_f32_16x16x32_bf16 v[68:71], v[88:91], v[160:163], v[68:71]
ds_read_b128 v[160:163], v167 offset:24576
s_waitcnt lgkmcnt(4)
v_mfma_f32_16x16x32_bf16 v[72:75], v[88:91], v[168:171], v[72:75]
v_add_u32 v164, s90, v164
ds_read_b128 v[168:171], v164 offset:0
v_mfma_f32_16x16x32_bf16 v[76:79], v[88:91], v[172:175], v[76:79]
v_add_u32 v165, s90, v165
ds_read_b128 v[172:175], v165 offset:0
s_waitcnt lgkmcnt(4)
v_mfma_f32_16x16x32_bf16 v[64:67], v[92:95], v[148:151], v[64:67]
v_add_u32 v166, s90, v166
ds_read_b128 v[148:151], v166 offset:0
v_mfma_f32_16x16x32_bf16 v[68:71], v[92:95], v[152:155], v[68:71]
v_add_u32 v167, s90, v167
ds_read_b128 v[152:155], v167 offset:0
s_waitcnt lgkmcnt(4)
v_mfma_f32_16x16x32_bf16 v[72:75], v[92:95], v[156:159], v[72:75]
v_mfma_f32_16x16x32_bf16 v[76:79], v[92:95], v[160:163], v[76:79]
s_waitcnt lgkmcnt(2)
v_mfma_f32_16x16x32_bf16 v[64:67], v[176:179], v[168:171], v[64:67]
v_mfma_f32_16x16x32_bf16 v[68:71], v[176:179], v[172:175], v[68:71]
s_waitcnt lgkmcnt(0)
v_mfma_f32_16x16x32_bf16 v[72:75], v[176:179], v[148:151], v[72:75]
v_mfma_f32_16x16x32_bf16 v[76:79], v[176:179], v[152:155], v[76:79]
v_mfma_f32_32x32x16_bf16 v[48:63], a[72:75], v[116:119], v[48:63]
ds_read_b128 v[108:111], v222 offset:15360
v_max3_f32 v27, v27, -v39, -v40
s_nop 1
v_permlane32_swap_b32 v26, v27
v_mfma_f32_32x32x16_bf16 v[48:63], a[80:83], v[120:123], v[48:63]
ds_read_b128 v[112:115], v222 offset:16384
ds_write_b128 v184, v[64:67]
v_max_f32 v26, v26, v27
v_mul_f32 v28, -v26, v180
v_mfma_f32_32x32x16_bf16 v[48:63], a[88:91], v[124:127], v[48:63]
ds_read_b128 v[116:119], v222 offset:17408
v_mul_f32 v29, -v26, v180
s_nop 1
v_permlane32_swap_b32 v28, v29
v_mfma_f32_32x32x16_bf16 v[48:63], a[96:99], v[96:99], v[48:63]
ds_read_b128 v[120:123], v222 offset:18432
v_fma_f32 v192, v32, v180, v28
v_fma_f32 v202, -v32, v180, v29
v_fma_f32 v193, v33, v180, v28
v_fma_f32 v203, -v33, v180, v29
v_mfma_f32_32x32x16_bf16 v[48:63], a[104:107], v[100:103], v[48:63]
ds_read_b128 v[124:127], v222 offset:19456
s_waitcnt lgkmcnt(5)
v_fma_f32 v194, v34, v180, v28
v_fma_f32 v204, -v34, v180, v29
v_fma_f32 v195, v35, v180, v28
v_fma_f32 v205, -v35, v180, v29
v_mfma_f32_32x32x16_bf16 v[48:63], a[112:115], v[104:107], v[48:63]
ds_read_b128 v[96:99], v222 offset:20480
s_waitcnt lgkmcnt(4)
s_barrier
ds_read_b128 v[168:171], v185
v_fma_f32 v196, v36, v180, v28
v_fma_f32 v206, -v36, v180, v29
v_mfma_f32_32x32x16_bf16 v[48:63], a[120:123], v[108:111], v[48:63]
ds_read_b128 v[100:103], v222 offset:21504
s_waitcnt lgkmcnt(5)
v_fma_f32 v197, v37, v180, v28
v_fma_f32 v207, -v37, v180, v29
v_fma_f32 v198, v38, v180, v28
v_fma_f32 v208, -v38, v180, v29
v_mfma_f32_32x32x16_bf16 v[48:63], a[128:131], v[112:115], v[48:63]
ds_read_b128 v[104:107], v222 offset:22528
v_fma_f32 v199, v39, v180, v28
v_fma_f32 v209, -v39, v180, v29
v_fma_f32 v200, v40, v180, v28
v_fma_f32 v210, -v40, v180, v29
v_mfma_f32_32x32x16_bf16 v[48:63], a[136:139], v[116:119], v[48:63]
ds_read_b128 v[108:111], v222 offset:23552
s_waitcnt lgkmcnt(3)
v_add_f32 v68, v68, v168
v_add_f32 v69, v69, v169
v_add_f32 v70, v70, v170
v_add_f32 v71, v71, v171
ds_write_b128 v185, v[68:71]
v_exp_f32 v192, v192
v_mfma_f32_32x32x16_bf16 v[48:63], a[144:147], v[120:123], v[48:63]
ds_read_b128 v[112:115], v222 offset:24576
v_exp_f32 v202, v202
v_exp_f32 v193, v193
v_mfma_f32_32x32x16_bf16 v[48:63], a[152:155], v[124:127], v[48:63]
ds_read_b128 v[116:119], v222 offset:25600
s_waitcnt lgkmcnt(5)
v_exp_f32 v203, v203
v_exp_f32 v194, v194
v_mfma_f32_32x32x16_bf16 v[48:63], a[160:163], v[96:99], v[48:63]
ds_read_b128 v[120:123], v222 offset:26624
v_exp_f32 v204, v204
v_exp_f32 v195, v195
v_mfma_f32_32x32x16_bf16 v[48:63], a[168:171], v[100:103], v[48:63]
ds_read_b128 v[124:127], v222 offset:27648
s_waitcnt lgkmcnt(4)
s_barrier
ds_read_b128 v[168:171], v186
v_exp_f32 v205, v205
v_mfma_f32_32x32x16_bf16 v[48:63], a[176:179], v[104:107], v[48:63]
ds_read_b128 v[96:99], v222 offset:28672
v_exp_f32 v196, v196
v_exp_f32 v206, v206
v_mfma_f32_32x32x16_bf16 v[48:63], a[184:187], v[108:111], v[48:63]
ds_read_b128 v[100:103], v222 offset:29696
s_waitcnt lgkmcnt(5)
v_exp_f32 v197, v197
v_exp_f32 v207, v207
v_mfma_f32_32x32x16_bf16 v[48:63], a[192:195], v[112:115], v[48:63]
ds_read_b128 v[104:107], v222 offset:30720
s_waitcnt lgkmcnt(3)
v_add_f32 v72, v72, v168
v_add_f32 v73, v73, v169
v_add_f32 v74, v74, v170
v_add_f32 v75, v75, v171
ds_write_b128 v186, v[72:75]
v_exp_f32 v198, v198
v_mfma_f32_32x32x16_bf16 v[48:63], a[200:203], v[116:119], v[48:63]
ds_read_b128 v[108:111], v222 offset:31744
v_exp_f32 v208, v208
v_exp_f32 v199, v199
v_mfma_f32_32x32x16_bf16 v[48:63], a[208:211], v[120:123], v[48:63]
ds_read_b128 v[112:115], v222 offset:32768
v_exp_f32 v209, v209
v_exp_f32 v200, v200
v_mfma_f32_32x32x16_bf16 v[48:63], a[216:219], v[124:127], v[48:63]
ds_read_b128 v[116:119], v222 offset:33792
s_waitcnt lgkmcnt(5)
v_exp_f32 v210, v210
v_add_f32 v26, v192, v194
v_add_f32 v28, v202, v204
v_mfma_f32_32x32x16_bf16 v[48:63], a[224:227], v[96:99], v[48:63]
ds_read_b128 v[120:123], v222 offset:34816
s_waitcnt lgkmcnt(4)
s_barrier
ds_read_b128 v[168:171], v187
v_add_f32 v27, v193, v195
v_add_f32 v29, v203, v205
v_mfma_f32_32x32x16_bf16 v[48:63], a[232:235], v[100:103], v[48:63]
ds_read_b128 v[124:127], v222 offset:35840
s_waitcnt lgkmcnt(5)
v_add_f32 v26, v26, v196
v_add_f32 v28, v28, v206
v_add_f32 v27, v27, v197
v_add_f32 v29, v29, v207
v_mfma_f32_32x32x16_bf16 v[48:63], a[240:243], v[104:107], v[48:63]
v_add_f32 v26, v26, v198
v_add_f32 v28, v28, v208
v_add_f32 v27, v27, v199
v_add_f32 v29, v29, v209
v_mfma_f32_32x32x16_bf16 v[48:63], a[248:251], v[108:111], v[48:63]
s_waitcnt lgkmcnt(1)
v_add_f32 v76, v76, v168
v_add_f32 v77, v77, v169
v_add_f32 v78, v78, v170
v_add_f32 v79, v79, v171
ds_write_b128 v187, v[76:79]
v_add_f32 v26, v26, v27
v_add_f32 v28, v28, v29
v_mfma_f32_32x32x16_bf16 v[48:63], v[224:227], v[112:115], v[48:63]
v_add_f32 v26, v26, v200
v_add_f32 v28, v28, v210
v_mfma_f32_32x32x16_bf16 v[48:63], v[232:235], v[116:119], v[48:63]
s_waitcnt lgkmcnt(1)
v_permlane32_swap_b32 v26, v28
v_add_f32 v26, v26, v28
v_mfma_f32_32x32x16_bf16 v[48:63], v[240:243], v[120:123], v[48:63]
v_rcp_f32 v26, v26
s_nop 0
v_mov_b32 v27, v26
v_mfma_f32_32x32x16_bf16 v[48:63], v[248:251], v[124:127], v[48:63]
s_waitcnt lgkmcnt(0)
s_barrier
ds_read_b64 v[184:185], v190 offset:0
ds_read_b64 v[186:187], v190 offset:2048
v_permlane32_swap_b32 v26, v27
v_mul_f32 v192, v192, v26
v_mul_f32 v202, v202, v27
v_mul_f32 v193, v193, v26
v_mul_f32 v203, v203, v27
v_mul_f32 v194, v194, v26
v_mul_f32 v204, v204, v27
v_mul_f32 v195, v195, v26
v_mul_f32 v205, v205, v27
v_mul_f32 v196, v196, v26
v_mul_f32 v206, v206, v27
v_mul_f32 v197, v197, v26
v_mul_f32 v207, v207, v27
v_mul_f32 v198, v198, v26
v_mul_f32 v208, v208, v27
v_mul_f32 v199, v199, v26
v_mul_f32 v209, v209, v27
v_mul_f32 v200, v200, v26
v_mul_f32 v210, v210, v27
v_cvt_pk_bf16_f32 v148, v192, v193
v_cvt_pk_bf16_f32 v149, v194, v195
v_cvt_pk_bf16_f32 v150, v196, v197
v_cvt_pk_bf16_f32 v151, v198, v199
v_cvt_pk_bf16_f32 v152, v202, v203
v_cvt_pk_bf16_f32 v153, v204, v205
v_cvt_pk_bf16_f32 v154, v206, v207
v_cvt_pk_bf16_f32 v155, v208, v209
v_cvt_pk_bf16_f32 v161, v200, v210
v_mul_f32 v41, v41, v220
v_mul_f32 v42, v42, v220
v_mul_f32 v43, v43, v220
v_mul_f32 v44, v44, v220
v_mul_f32 v45, v45, v220
v_mul_f32 v46, v46, v220
v_mul_f32 v47, v47, v220
v_cvt_pk_bf16_f32 v156, v41, v42
v_cvt_pk_bf16_f32 v157, v43, v44
v_cvt_pk_bf16_f32 v158, v45, v46
v_mov_b32 v162, 0
v_mov_b32 v163, 0
s_waitcnt lgkmcnt(0)
v_fmac_f32 v184, v144, v181
v_fmac_f32 v185, v145, v181
v_mul_f32 v184, v184, v220
v_mul_f32 v185, v185, v220
v_cvt_pk_bf16_f32 v159, v47, v184
v_cvt_pk_bf16_f32 v160, v185, 1.0
v_mfma_f32_32x32x16_bf16 v[32:47], v[148:151], v[212:215], 0
v_max3_f32 v26, v48, v49, v50
v_max3_f32 v27, -v48, -v49, -v50
v_max3_f32 v26, v26, v51, v52
v_max3_f32 v27, v27, -v51, -v52
v_max3_f32 v26, v26, v53, v54
v_max3_f32 v27, v27, -v53, -v54
v_mfma_f32_32x32x16_bf16 v[96:111], v[156:159], v[212:215], 0
v_max3_f32 v26, v26, v55, v56
v_max3_f32 v27, v27, -v55, -v56
s_nop 1
v_permlane32_swap_b32 v26, v27
v_max_f32 v26, v26, v27
v_mfma_f32_32x32x16_bf16 v[32:47], v[152:155], v[216:219], v[32:47]
v_mul_f32 v28, -v26, v182
v_mul_f32 v29, -v26, v182
s_nop 1
v_permlane32_swap_b32 v28, v29
v_fma_f32 v192, v48, v182, v28
v_mfma_f32_32x32x16_bf16 v[96:111], v[160:163], v[216:219], v[96:111]
v_fma_f32 v202, -v48, v182, v29
v_fma_f32 v193, v49, v182, v28
v_fma_f32 v203, -v49, v182, v29
v_fma_f32 v194, v50, v182, v28
v_fma_f32 v204, -v50, v182, v29
v_fma_f32 v195, v51, v182, v28
v_fma_f32 v205, -v51, v182, v29
v_fma_f32 v196, v52, v182, v28
v_fma_f32 v206, -v52, v182, v29
v_fma_f32 v197, v53, v182, v28
v_fma_f32 v207, -v53, v182, v29
v_fma_f32 v198, v54, v182, v28
v_fma_f32 v208, -v54, v182, v29
v_fma_f32 v199, v55, v182, v28
v_fma_f32 v209, -v55, v182, v29
v_fma_f32 v200, v56, v182, v28
v_fma_f32 v210, -v56, v182, v29
v_exp_f32 v192, v192
v_cvt_pk_bf16_f32 v112, v32, v33
v_cvt_pk_bf16_f32 v113, v34, v35
v_cvt_pk_bf16_f32 v114, v36, v37
v_cvt_pk_bf16_f32 v115, v38, v39
v_cvt_pk_bf16_f32 v116, v40, v41
v_cvt_pk_bf16_f32 v117, v42, v43
v_cvt_pk_bf16_f32 v118, v44, v45
v_cvt_pk_bf16_f32 v119, v46, v47
v_cvt_pk_bf16_f32 v120, v96, v97
v_cvt_pk_bf16_f32 v121, v98, v99
v_cvt_pk_bf16_f32 v122, v100, v101
v_cvt_pk_bf16_f32 v123, v102, v103
v_cvt_pk_bf16_f32 v124, v104, v105
v_cvt_pk_bf16_f32 v125, v106, v107
v_cvt_pk_bf16_f32 v126, v108, v109
v_cvt_pk_bf16_f32 v127, v110, v111
v_mfma_f32_32x32x16_bf16 v[64:79], v[112:115], v[120:123], 0
v_exp_f32 v202, v202
v_exp_f32 v193, v193
v_exp_f32 v203, v203
v_mfma_f32_32x32x16_bf16 v[80:95], v[120:123], v[120:123], 0
v_exp_f32 v194, v194
v_exp_f32 v204, v204
v_exp_f32 v195, v195
v_mfma_f32_32x32x16_bf16 v[64:79], v[116:119], v[124:127], v[64:79]
v_exp_f32 v205, v205
v_exp_f32 v196, v196
v_exp_f32 v206, v206
v_mfma_f32_32x32x16_bf16 v[80:95], v[124:127], v[124:127], v[80:95]
v_exp_f32 v197, v197
v_exp_f32 v207, v207
v_exp_f32 v198, v198
v_exp_f32 v208, v208
v_exp_f32 v199, v199
v_exp_f32 v209, v209
v_exp_f32 v200, v200
v_exp_f32 v210, v210
v_pk_add_f32 v[26:27], v[192:193], v[194:195]
v_pk_add_f32 v[28:29], v[202:203], v[204:205]
v_pk_add_f32 v[26:27], v[26:27], v[196:197]
v_pk_add_f32 v[28:29], v[28:29], v[206:207]
v_pk_add_f32 v[26:27], v[26:27], v[198:199]
v_pk_add_f32 v[28:29], v[28:29], v[208:209]
v_add_f32 v26, v26, v27
v_add_f32 v28, v28, v29
v_add_f32 v26, v26, v200
v_add_f32 v28, v28, v210
s_nop 1
v_permlane32_swap_b32 v26, v28
v_add_f32 v26, v26, v28
v_rcp_f32 v26, v26
s_nop 0
v_mov_b32 v27, v26
s_nop 1
v_permlane32_swap_b32 v26, v27
v_pk_mul_f32 v[192:193], v[192:193], v[26:27] op_sel_hi:[1,0]
v_pk_mul_f32 v[202:203], v[202:203], v[26:27] op_sel:[0,1]
v_pk_mul_f32 v[194:195], v[194:195], v[26:27] op_sel_hi:[1,0]
v_pk_mul_f32 v[204:205], v[204:205], v[26:27] op_sel:[0,1]
v_pk_mul_f32 v[196:197], v[196:197], v[26:27] op_sel_hi:[1,0]
v_pk_mul_f32 v[206:207], v[206:207], v[26:27] op_sel:[0,1]
v_pk_mul_f32 v[198:199], v[198:199], v[26:27] op_sel_hi:[1,0]
v_pk_mul_f32 v[208:209], v[208:209], v[26:27] op_sel:[0,1]
v_mul_f32 v200, v200, v26
v_mul_f32 v210, v210, v27
v_cvt_pk_bf16_f32 v164, v192, v193
v_cvt_pk_bf16_f32 v165, v194, v195
v_cvt_pk_bf16_f32 v166, v196, v197
v_cvt_pk_bf16_f32 v167, v198, v199
v_cvt_pk_bf16_f32 v168, v202, v203
v_cvt_pk_bf16_f32 v169, v204, v205
v_cvt_pk_bf16_f32 v170, v206, v207
v_cvt_pk_bf16_f32 v171, v208, v209
v_cvt_pk_bf16_f32 v177, v200, v210
v_mul_f32 v57, v57, v221
v_pk_mul_f32 v[58:59], v[58:59], v[220:221] op_sel:[0,1]
v_pk_mul_f32 v[60:61], v[60:61], v[220:221] op_sel:[0,1]
v_pk_mul_f32 v[62:63], v[62:63], v[220:221] op_sel:[0,1]
v_cvt_pk_bf16_f32 v172, v57, v58
v_cvt_pk_bf16_f32 v173, v59, v60
v_cvt_pk_bf16_f32 v174, v61, v62
v_mov_b32 v178, 0
v_mov_b32 v179, 0
v_fmac_f32 v186, v144, v183
v_fmac_f32 v187, v145, v183
v_mul_f32 v186, v186, v221
v_mul_f32 v187, v187, v221
v_cvt_pk_bf16_f32 v175, v63, v186
v_cvt_pk_bf16_f32 v176, v187, 1.0
ds_read_b128 v[128:131], v189 offset:64
ds_read_b128 v[132:135], v189 offset:80
ds_read_b128 v[136:139], v189 offset:96
v_mfma_f32_32x32x16_bf16 v[32:47], v[164:167], v[212:215], 0
v_lshrrev_b32 v30, 5, v1
v_mul_u32_u24 v30, 20, v30
v_and_b32 v31, 31, v1
v_add_u32 v30, v30, v31
v_mfma_f32_32x32x16_bf16 v[96:111], v[172:175], v[212:215], 0
v_cmp_lt_u32 vcc, 19, v31
v_add_u32 v31, -2, v30
s_nop 0
v_cndmask_b32 v31, v30, v31, vcc
v_lshlrev_b32 v30, 4, v31
v_lshlrev_b32 v31, 2, v31
v_lshrrev_b32 v186, 9, v30
v_mul_u32_u24 v186, 17920, v186
v_mfma_f32_32x32x16_bf16 v[32:47], v[168:171], v[216:219], v[32:47]
v_add_u32 v184, v30, v186
v_add_u32 v187, 640, v30
v_lshrrev_b32 v186, 9, v187
v_mul_u32_u24 v186, 17920, v186
v_add_u32 v185, v187, v186
s_lshl_b32 s67, s61, 9
v_mfma_f32_32x32x16_bf16 v[96:111], v[176:179], v[216:219], v[96:111]
s_mul_i32 s68, s59, 2304
s_add_u32 s67, s67, s68
s_add_u32 s67, s67, s94
s_add_u32 s67, s67, 2359296
s_add_u32 s68, s67, 37120
v_cvt_pk_bf16_f32 v112, v32, v33
v_cvt_pk_bf16_f32 v113, v34, v35
v_cvt_pk_bf16_f32 v114, v36, v37
v_cvt_pk_bf16_f32 v115, v38, v39
v_cvt_pk_bf16_f32 v116, v40, v41
v_cvt_pk_bf16_f32 v117, v42, v43
v_cvt_pk_bf16_f32 v118, v44, v45
v_cvt_pk_bf16_f32 v119, v46, v47
v_cvt_pk_bf16_f32 v120, v96, v97
v_cvt_pk_bf16_f32 v121, v98, v99
v_cvt_pk_bf16_f32 v122, v100, v101
v_cvt_pk_bf16_f32 v123, v102, v103
v_cvt_pk_bf16_f32 v124, v104, v105
v_cvt_pk_bf16_f32 v125, v106, v107
v_cvt_pk_bf16_f32 v126, v108, v109
v_cvt_pk_bf16_f32 v127, v110, v111
v_mfma_f32_32x32x16_bf16 v[64:79], v[112:115], v[120:123], v[64:79]
v_mfma_f32_32x32x16_bf16 v[80:95], v[120:123], v[120:123], v[80:95]
v_mfma_f32_32x32x16_bf16 v[64:79], v[116:119], v[124:127], v[64:79]
v_mfma_f32_32x32x16_bf16 v[80:95], v[124:127], v[124:127], v[80:95]
ds_read_b128 v[96:99], v14 offset:0
ds_read_b128 v[100:103], v14 offset:1024
ds_read_b128 v[104:107], v14 offset:2048
ds_read_b128 v[108:111], v14 offset:3072
s_nop 6
v_cvt_pk_bf16_f32 v148, v64, v65
v_cvt_pk_bf16_f32 v149, v66, v67
v_cvt_pk_bf16_f32 v150, v68, v69
v_cvt_pk_bf16_f32 v151, v70, v71
v_cvt_pk_bf16_f32 v152, v72, v73
v_cvt_pk_bf16_f32 v153, v74, v75
v_cvt_pk_bf16_f32 v154, v76, v77
v_cvt_pk_bf16_f32 v155, v78, v79
v_cvt_pk_bf16_f32 v156, v90, v91
s_mov_b64 exec, s[76:77]
s_cmp_eq_u32 s97, 0
s_cbranch_scc1 slow_129
buffer_store_dwordx4 v[148:151], v184, s[4:7], s67 offen
buffer_store_dwordx4 v[152:155], v185, s[4:7], s67 offen
buffer_store_dword v156, v31, s[4:7], s68 offen
back_130:
s_mov_b64 exec, -1
s_waitcnt lgkmcnt(4)
v_mul_f32 v64, v128, v181
v_mul_f32 v65, v129, v181
v_mul_f32 v66, v130, v181
v_mul_f32 v67, v131, v181
v_mul_f32 v68, v132, v181
v_mul_f32 v69, v133, v181
v_mul_f32 v70, v134, v181
v_mul_f32 v71, v135, v181
v_mul_f32 v72, v136, v181
s_waitcnt lgkmcnt(3)
s_nop 0
v_mfma_f32_32x32x16_bf16 v[64:79], a[4:7], v[96:99], v[64:79]
ds_read_b128 v[112:115], v14 offset:4096
ds_read_b128 v[116:119], v14 offset:5120
s_lshl_b32 s66, s99, 5
s_add_u32 s66, s66, 32832
s_lshl_b32 s67, s60, 2
s_lshl_b32 s68, s61, 4
s_add_u32 s67, s67, s68
s_waitcnt lgkmcnt(4)
v_mfma_f32_32x32x16_bf16 v[64:79], a[12:15], v[100:103], v[64:79]
ds_read_b128 v[120:123], v14 offset:6144
ds_read_b128 v[124:127], v14 offset:7168
s_waitcnt lgkmcnt(4)
s_add_u32 s67, s67, s66
s_lshl_b32 s68, s60, 4
s_add_u32 s66, s66, s68
v_and_b32 v176, 3, v1
v_lshlrev_b32 v176, 2, v176
v_mfma_f32_32x32x16_bf16 v[64:79], a[20:23], v[104:107], v[64:79]
ds_read_b128 v[96:99], v14 offset:8192
v_lshlrev_b32 v178, 3, v0
v_mov_b32 v177, 0x40000000
v_cmp_gt_u32 vcc, 180, v0
s_mul_i32 s68, s56, 294912
s_lshl_b32 s69, s60, 9
v_cndmask_b32 v178, v177, v178, vcc
v_mfma_f32_32x32x16_bf16 v[64:79], a[28:31], v[108:111], v[64:79]
ds_read_b128 v[100:103], v14 offset:9216
s_waitcnt lgkmcnt(4)
s_mul_i32 s70, s61, 17920
v_add_u32 v179, s70, v178
s_add_u32 s68, s68, s69
s_mul_i32 s69, s59, 2304
s_add_u32 s68, s68, s69
s_add_u32 s68, s68, 9175040
v_mfma_f32_32x32x16_bf16 v[64:79], a[36:39], v[112:115], v[64:79]
ds_read_b128 v[104:107], v14 offset:10240
s_lshl_b32 s69, s59, 2
s_add_u32 s69, s69, s60
s_lshl_b32 s69, s69, 3
s_add_u32 s69, s69, s56
s_lshl_b32 s69, s69, 11
s_add_u32 s69, s69, 1179648
v_mfma_f32_32x32x16_bf16 v[64:79], a[44:47], v[116:119], v[64:79]
ds_read_b128 v[108:111], v14 offset:11264
s_waitcnt lgkmcnt(4)
v_mul_f32 v80, v128, v183
v_mul_f32 v81, v129, v183
v_mul_f32 v82, v130, v183
v_mul_f32 v83, v131, v183
v_mfma_f32_32x32x16_bf16 v[64:79], a[52:55], v[120:123], v[64:79]
ds_read_b128 v[112:115], v14 offset:12288
v_mul_f32 v84, v132, v183
v_mul_f32 v85, v133, v183
v_mul_f32 v86, v134, v183
v_mul_f32 v87, v135, v183
v_mfma_f32_32x32x16_bf16 v[64:79], a[60:63], v[124:127], v[64:79]
ds_read_b128 v[116:119], v14 offset:13312
s_waitcnt lgkmcnt(4)
v_mul_f32 v88, v136, v183
s_mul_i32 s90, s59, 2304
s_add_u32 s90, s90, s94
s_add_u32 s90, s90, 2359296
v_mfma_f32_32x32x16_bf16 v[64:79], a[68:71], v[96:99], v[64:79]
ds_read_b128 v[120:123], v14 offset:14336
s_add_u32 s72, s90, 36864
v_bfe_u32 v188, v1, 4, 1
v_mul_u32_u24 v188, 18432, v188
v_and_b32 v189, 15, v1
v_mfma_f32_32x32x16_bf16 v[64:79], a[76:79], v[100:103], v[64:79]
ds_read_b128 v[124:127], v14 offset:15360
s_waitcnt lgkmcnt(4)
v_lshl_add_u32 v188, v189, 4, v188
v_lshrrev_b32 v189, 5, v1
s_lshl_b32 s71, s61, 1
v_add_u32 v189, s71, v189
v_mfma_f32_32x32x16_bf16 v[64:79], a[84:87], v[104:107], v[64:79]
ds_read_b128 v[96:99], v14 offset:16384
s_waitcnt vmcnt(0)
s_cmp_eq_u32 s97, 0
s_cbranch_scc1 slow_131
s_mov_b64 exec, 1
v_mov_b32 v164, s62
buffer_store_dword v164, off, s[4:7], s67 offset:0
s_mov_b64 exec, -1
back_132:
v_lshrrev_b32 v190, 4, v1
v_mul_u32_u24 v190, 18176, v190
v_mfma_f32_32x32x16_bf16 v[64:79], a[92:95], v[108:111], v[64:79]
ds_read_b128 v[100:103], v14 offset:17408
s_waitcnt lgkmcnt(4)
s_lshl_b32 s71, s61, 2
v_add3_u32 v190, v190, v14, s71
v_lshl_add_u32 v188, v189, 8, v188
v_mfma_f32_32x32x16_bf16 v[64:79], a[100:103], v[112:115], v[64:79]
ds_read_b128 v[104:107], v14 offset:18432
v_mfma_f32_32x32x16_bf16 v[64:79], a[108:111], v[116:119], v[64:79]
ds_read_b128 v[108:111], v14 offset:19456
s_waitcnt lgkmcnt(4)
v_mfma_f32_32x32x16_bf16 v[64:79], a[116:119], v[120:123], v[64:79]
ds_read_b128 v[112:115], v14 offset:20480
v_mfma_f32_32x32x16_bf16 v[64:79], a[124:127], v[124:127], v[64:79]
ds_read_b128 v[116:119], v14 offset:21504
buffer_load_dword v165, v176, s[4:7], s66 offen sc1
s_waitcnt lgkmcnt(4)
v_mfma_f32_32x32x16_bf16 v[64:79], a[132:135], v[96:99], v[64:79]
ds_read_b128 v[120:123], v14 offset:22528
v_mfma_f32_32x32x16_bf16 v[64:79], a[140:143], v[100:103], v[64:79]
ds_read_b128 v[124:127], v14 offset:23552
s_waitcnt lgkmcnt(4)
v_mfma_f32_32x32x16_bf16 v[64:79], a[148:151], v[104:107], v[64:79]
ds_read_b128 v[96:99], v14 offset:24576
v_mfma_f32_32x32x16_bf16 v[64:79], a[156:159], v[108:111], v[64:79]
ds_read_b128 v[100:103], v14 offset:25600
s_waitcnt lgkmcnt(4)
v_mfma_f32_32x32x16_bf16 v[64:79], a[164:167], v[112:115], v[64:79]
ds_read_b128 v[104:107], v14 offset:26624
v_mfma_f32_32x32x16_bf16 v[64:79], a[172:175], v[116:119], v[64:79]
ds_read_b128 v[108:111], v14 offset:27648
s_waitcnt lgkmcnt(4)
v_mfma_f32_32x32x16_bf16 v[64:79], a[180:183], v[120:123], v[64:79]
ds_read_b128 v[112:115], v14 offset:28672
v_mfma_f32_32x32x16_bf16 v[64:79], a[188:191], v[124:127], v[64:79]
ds_read_b128 v[116:119], v14 offset:29696
s_waitcnt lgkmcnt(4)
v_mfma_f32_32x32x16_bf16 v[64:79], a[196:199], v[96:99], v[64:79]
ds_read_b128 v[120:123], v14 offset:30720
s_mov_b32 s75, 0
s_waitcnt vmcnt(0)
pr_133:
v_cmp_ne_u32 vcc, s62, v165
s_cbranch_vccnz po_134
pk_135:
buffer_load_dwordx2 v[164:165], v179, s[4:7], s68 offen sc1
s_add_u32 s68, s68, 73728
buffer_load_dwordx2 v[166:167], v179, s[4:7], s68 offen sc1
s_add_u32 s68, s68, 73728
buffer_load_dwordx2 v[168:169], v179, s[4:7], s68 offen sc1
s_add_u32 s68, s68, 73728
buffer_load_dwordx2 v[170:171], v179, s[4:7], s68 offen sc1
v_mfma_f32_32x32x16_bf16 v[64:79], a[204:207], v[100:103], v[64:79]
ds_read_b128 v[124:127], v14 offset:31744
s_waitcnt lgkmcnt(4)
v_mfma_f32_32x32x16_bf16 v[64:79], a[212:215], v[104:107], v[64:79]
ds_read_b128 v[96:99], v14 offset:32768
v_mfma_f32_32x32x16_bf16 v[64:79], a[220:223], v[108:111], v[64:79]
ds_read_b128 v[100:103], v14 offset:33792
s_waitcnt lgkmcnt(4)
v_mfma_f32_32x32x16_bf16 v[64:79], a[228:231], v[112:115], v[64:79]
ds_read_b128 v[104:107], v14 offset:34816
v_mfma_f32_32x32x16_bf16 v[64:79], a[236:239], v[116:119], v[64:79]
ds_read_b128 v[108:111], v14 offset:35840
s_waitcnt lgkmcnt(4)
v_mfma_f32_32x32x16_bf16 v[64:79], a[244:247], v[120:123], v[64:79]
ds_read_b128 v[112:115], v222 offset:0
v_mfma_f32_32x32x16_bf16 v[64:79], a[252:255], v[124:127], v[64:79]
ds_read_b128 v[116:119], v222 offset:1024
s_waitcnt lgkmcnt(4)
v_mfma_f32_32x32x16_bf16 v[64:79], v[228:231], v[96:99], v[64:79]
ds_read_b128 v[120:123], v222 offset:2048
v_mfma_f32_32x32x16_bf16 v[64:79], v[236:239], v[100:103], v[64:79]
ds_read_b128 v[124:127], v222 offset:3072
s_waitcnt lgkmcnt(4)
v_mfma_f32_32x32x16_bf16 v[64:79], v[244:247], v[104:107], v[64:79]
ds_read_b128 v[96:99], v222 offset:4096
s_waitcnt vmcnt(0)
v_lshlrev_b32 v172, 16, v164
v_and_b32 v173, s63, v164
v_lshlrev_b32 v174, 16, v165
v_and_b32 v175, s63, v165
v_lshlrev_b32 v176, 16, v166
v_and_b32 v177, s63, v166
v_add_f32 v172, v172, v176
v_add_f32 v173, v173, v177
v_lshlrev_b32 v176, 16, v167
v_and_b32 v177, s63, v167
v_add_f32 v174, v174, v176
v_add_f32 v175, v175, v177
v_lshlrev_b32 v176, 16, v168
v_and_b32 v177, s63, v168
v_add_f32 v172, v172, v176
v_add_f32 v173, v173, v177
v_lshlrev_b32 v176, 16, v169
v_and_b32 v177, s63, v169
v_add_f32 v174, v174, v176
v_add_f32 v175, v175, v177
v_lshlrev_b32 v176, 16, v170
v_and_b32 v177, s63, v170
v_add_f32 v172, v172, v176
v_add_f32 v173, v173, v177
v_lshlrev_b32 v176, 16, v171
v_and_b32 v177, s63, v171
v_add_f32 v174, v174, v176
v_add_f32 v175, v175, v177
v_cvt_pk_bf16_f32 v164, v172, v173
v_cvt_pk_bf16_f32 v165, v174, v175
v_min_u32 v164, -2, v164
v_min_u32 v165, -2, v165
buffer_store_dwordx2 v[164:165], v178, s[4:7], s69 offen sc1
v_mfma_f32_32x32x16_bf16 v[64:79], v[252:255], v[108:111], v[64:79]
ds_read_b128 v[100:103], v222 offset:5120
s_waitcnt lgkmcnt(4)
v_mfma_f32_32x32x16_bf16 v[80:95], a[4:7], v[112:115], v[80:95]
ds_read_b128 v[104:107], v222 offset:6144
v_mfma_f32_32x32x16_bf16 v[80:95], a[12:15], v[116:119], v[80:95]
ds_read_b128 v[108:111], v222 offset:7168
s_waitcnt lgkmcnt(4)
s_nop 4
v_max3_f32 v26, v64, v65, v66
v_max3_f32 v27, -v64, -v65, -v66
v_max3_f32 v26, v26, v67, v68
v_max3_f32 v27, v27, -v67, -v68
v_mfma_f32_32x32x16_bf16 v[80:95], a[20:23], v[120:123], v[80:95]
ds_read_b128 v[112:115], v222 offset:8192
v_max3_f32 v26, v26, v69, v70
v_max3_f32 v27, v27, -v69, -v70
v_max3_f32 v26, v26, v71, v72
v_max3_f32 v27, v27, -v71, -v72
v_mfma_f32_32x32x16_bf16 v[80:95], a[28:31], v[124:127], v[80:95]
ds_read_b128 v[116:119], v222 offset:9216
s_waitcnt lgkmcnt(4)
v_permlane32_swap_b32 v26, v27
v_max_f32 v26, v26, v27
v_mfma_f32_32x32x16_bf16 v[80:95], a[36:39], v[96:99], v[80:95]
ds_read_b128 v[120:123], v222 offset:10240
v_mul_f32 v28, -v26, v180
v_mul_f32 v29, -v26, v180
v_mfma_f32_32x32x16_bf16 v[80:95], a[44:47], v[100:103], v[80:95]
ds_read_b128 v[124:127], v222 offset:11264
s_waitcnt lgkmcnt(4)
v_permlane32_swap_b32 v28, v29
v_fma_f32 v192, v64, v180, v28
v_mfma_f32_32x32x16_bf16 v[80:95], a[52:55], v[104:107], v[80:95]
ds_read_b128 v[96:99], v222 offset:12288
v_fma_f32 v202, -v64, v180, v29
v_fma_f32 v193, v65, v180, v28
v_fma_f32 v203, -v65, v180, v29
v_fma_f32 v194, v66, v180, v28
v_mfma_f32_32x32x16_bf16 v[80:95], a[60:63], v[108:111], v[80:95]
ds_read_b128 v[100:103], v222 offset:13312
s_waitcnt lgkmcnt(4)
v_fma_f32 v204, -v66, v180, v29
v_fma_f32 v195, v67, v180, v28
v_fma_f32 v205, -v67, v180, v29
v_fma_f32 v196, v68, v180, v28
v_mfma_f32_32x32x16_bf16 v[80:95], a[68:71], v[112:115], v[80:95]
ds_read_b128 v[104:107], v222 offset:14336
v_fma_f32 v206, -v68, v180, v29
v_fma_f32 v197, v69, v180, v28
v_fma_f32 v207, -v69, v180, v29
v_fma_f32 v198, v70, v180, v28
v_mfma_f32_32x32x16_bf16 v[80:95], a[76:79], v[116:119], v[80:95]
ds_read_b128 v[108:111], v222 offset:15360
s_waitcnt lgkmcnt(4)
v_fma_f32 v208, -v70, v180, v29
v_fma_f32 v199, v71, v180, v28
v_fma_f32 v209, -v71, v180, v29
v_fma_f32 v200, v72, v180, v28
v_mfma_f32_32x32x16_bf16 v[80:95], a[84:87], v[120:123], v[80:95]
ds_read_b128 v[112:115], v222 offset:16384
v_fma_f32 v210, -v72, v180, v29
v_exp_f32 v192, v192
v_mfma_f32_32x32x16_bf16 v[80:95], a[92:95], v[124:127], v[80:95]
ds_read_b128 v[116:119], v222 offset:17408
s_waitcnt lgkmcnt(4)
v_exp_f32 v202, v202
v_exp_f32 v193, v193
v_mfma_f32_32x32x16_bf16 v[80:95], a[100:103], v[96:99], v[80:95]
ds_read_b128 v[120:123], v222 offset:18432
v_exp_f32 v203, v203
v_exp_f32 v194, v194
v_mfma_f32_32x32x16_bf16 v[80:95], a[108:111], v[100:103], v[80:95]
ds_read_b128 v[124:127], v222 offset:19456
s_waitcnt lgkmcnt(4)
v_exp_f32 v204, v204
v_exp_f32 v195, v195
v_mfma_f32_32x32x16_bf16 v[80:95], a[116:119], v[104:107], v[80:95]
ds_read_b128 v[96:99], v222 offset:20480
s_lshl_b32 s66, s74, 14
s_add_u32 s66, s66, 1179648
s_add_u32 s67, s66, 4096
s_add_u32 s68, s66, 8192
s_add_u32 s92, s66, 12288
s_mov_b64 exec, s[76:77]
buffer_load_dwordx4 v[128:131], v30, s[4:7], s66 offen offset:0 sc1
buffer_load_dwordx4 v[132:135], v30, s[4:7], s66 offen offset:640 sc1
buffer_load_dword v136, v31, s[4:7], s66 offen offset:1280 sc1
s_mov_b64 exec, -1
v_exp_f32 v205, v205
v_mfma_f32_32x32x16_bf16 v[80:95], a[124:127], v[108:111], v[80:95]
ds_read_b128 v[100:103], v222 offset:21504
s_waitcnt lgkmcnt(4)
v_exp_f32 v196, v196
v_exp_f32 v206, v206
v_mfma_f32_32x32x16_bf16 v[80:95], a[132:135], v[112:115], v[80:95]
ds_read_b128 v[104:107], v222 offset:22528
v_exp_f32 v197, v197
v_exp_f32 v207, v207
v_mfma_f32_32x32x16_bf16 v[80:95], a[140:143], v[116:119], v[80:95]
ds_read_b128 v[108:111], v222 offset:23552
s_waitcnt lgkmcnt(4)
v_exp_f32 v198, v198
v_exp_f32 v208, v208
v_mfma_f32_32x32x16_bf16 v[80:95], a[148:151], v[120:123], v[80:95]
ds_read_b128 v[112:115], v222 offset:24576
s_mov_b64 exec, s[76:77]
buffer_load_dwordx4 v[138:141], v30, s[4:7], s66 offen offset:2048 sc1
buffer_load_dwordx4 v[142:145], v30, s[4:7], s66 offen offset:2688 sc1
buffer_load_dword v146, v31, s[4:7], s66 offen offset:3328 sc1
s_mov_b64 exec, -1
v_exp_f32 v199, v199
v_mfma_f32_32x32x16_bf16 v[80:95], a[156:159], v[124:127], v[80:95]
ds_read_b128 v[116:119], v222 offset:25600
s_waitcnt lgkmcnt(4)
v_exp_f32 v209, v209
v_exp_f32 v200, v200
v_mfma_f32_32x32x16_bf16 v[80:95], a[164:167], v[96:99], v[80:95]
ds_read_b128 v[120:123], v222 offset:26624
v_exp_f32 v210, v210
v_add_f32 v26, v192, v194
v_add_f32 v28, v202, v204
v_mfma_f32_32x32x16_bf16 v[80:95], a[172:175], v[100:103], v[80:95]
ds_read_b128 v[124:127], v222 offset:27648
s_waitcnt lgkmcnt(4)
v_add_f32 v27, v193, v195
v_add_f32 v29, v203, v205
v_add_f32 v26, v26, v196
v_add_f32 v28, v28, v206
v_mfma_f32_32x32x16_bf16 v[80:95], a[180:183], v[104:107], v[80:95]
ds_read_b128 v[96:99], v222 offset:28672
s_mov_b64 exec, s[76:77]
buffer_load_dwordx4 v[148:151], v30, s[4:7], s67 offen offset:0 sc1
buffer_load_dwordx4 v[152:155], v30, s[4:7], s67 offen offset:640 sc1
buffer_load_dword v156, v31, s[4:7], s67 offen offset:1280 sc1
s_mov_b64 exec, -1
v_add_f32 v27, v27, v197
v_add_f32 v29, v29, v207
v_mfma_f32_32x32x16_bf16 v[80:95], a[188:191], v[108:111], v[80:95]
ds_read_b128 v[100:103], v222 offset:29696
s_waitcnt lgkmcnt(4)
v_add_f32 v26, v26, v198
v_add_f32 v28, v28, v208
v_add_f32 v27, v27, v199
v_add_f32 v29, v29, v209
v_mfma_f32_32x32x16_bf16 v[80:95], a[196:199], v[112:115], v[80:95]
ds_read_b128 v[104:107], v222 offset:30720
v_add_f32 v26, v26, v27
v_add_f32 v28, v28, v29
v_add_f32 v26, v26, v200
v_add_f32 v28, v28, v210
v_mfma_f32_32x32x16_bf16 v[80:95], a[204:207], v[116:119], v[80:95]
ds_read_b128 v[108:111], v222 offset:31744
s_waitcnt lgkmcnt(4)
v_permlane32_swap_b32 v26, v28
v_add_f32 v26, v26, v28
v_mfma_f32_32x32x16_bf16 v[80:95], a[212:215], v[120:123], v[80:95]
ds_read_b128 v[112:115], v222 offset:32768
s_mov_b64 exec, s[76:77]
buffer_load_dwordx4 v[158:161], v30, s[4:7], s67 offen offset:2048 sc1
buffer_load_dwordx4 v[162:165], v30, s[4:7], s67 offen offset:2688 sc1
buffer_load_dword v166, v31, s[4:7], s67 offen offset:3328 sc1
s_mov_b64 exec, -1
v_rcp_f32 v26, v26
v_mfma_f32_32x32x16_bf16 v[80:95], a[220:223], v[124:127], v[80:95]
ds_read_b128 v[116:119], v222 offset:33792
s_waitcnt lgkmcnt(4)
v_mov_b32 v27, v26
v_mfma_f32_32x32x16_bf16 v[80:95], a[228:231], v[96:99], v[80:95]
ds_read_b128 v[120:123], v222 offset:34816
v_permlane32_swap_b32 v26, v27
v_mul_f32 v192, v192, v26
v_mfma_f32_32x32x16_bf16 v[80:95], a[236:239], v[100:103], v[80:95]
ds_read_b128 v[124:127], v222 offset:35840
s_waitcnt lgkmcnt(4)
v_mul_f32 v202, v202, v27
v_mul_f32 v193, v193, v26
v_mul_f32 v203, v203, v27
v_mul_f32 v194, v194, v26
v_mfma_f32_32x32x16_bf16 v[80:95], a[244:247], v[104:107], v[80:95]
s_mov_b64 exec, s[76:77]
buffer_load_dwordx4 v[168:171], v30, s[4:7], s68 offen offset:0 sc1
buffer_load_dwordx4 v[172:175], v30, s[4:7], s68 offen offset:640 sc1
buffer_load_dword v176, v31, s[4:7], s68 offen offset:1280 sc1
s_mov_b64 exec, -1
v_mul_f32 v204, v204, v27
v_mul_f32 v195, v195, v26
v_mfma_f32_32x32x16_bf16 v[80:95], a[252:255], v[108:111], v[80:95]
s_waitcnt lgkmcnt(2)
v_mul_f32 v205, v205, v27
v_mul_f32 v196, v196, v26
v_mul_f32 v206, v206, v27
v_mul_f32 v197, v197, v26
v_mfma_f32_32x32x16_bf16 v[80:95], v[228:231], v[112:115], v[80:95]
s_mov_b64 exec, s[76:77]
buffer_load_dwordx4 v[96:99], v30, s[4:7], s68 offen offset:2048 sc1
buffer_load_dwordx4 v[100:103], v30, s[4:7], s68 offen offset:2688 sc1
buffer_load_dword v104, v31, s[4:7], s68 offen offset:3328 sc1
s_mov_b64 exec, -1
v_mul_f32 v207, v207, v27
v_mul_f32 v198, v198, v26
v_mfma_f32_32x32x16_bf16 v[80:95], v[236:239], v[116:119], v[80:95]
s_waitcnt lgkmcnt(0)
v_mul_f32 v208, v208, v27
v_mul_f32 v199, v199, v26
v_mul_f32 v209, v209, v27
v_mul_f32 v200, v200, v26
v_mfma_f32_32x32x16_bf16 v[80:95], v[244:247], v[120:123], v[80:95]
s_mov_b64 exec, s[76:77]
buffer_load_dwordx4 v[106:109], v30, s[4:7], s92 offen offset:0 sc1
buffer_load_dwordx4 v[110:113], v30, s[4:7], s92 offen offset:640 sc1
buffer_load_dword v114, v31, s[4:7], s92 offen offset:1280 sc1
s_mov_b64 exec, -1
v_mul_f32 v210, v210, v27
v_cvt_pk_bf16_f32 v32, v192, v193
v_mfma_f32_32x32x16_bf16 v[80:95], v[252:255], v[124:127], v[80:95]
v_cvt_pk_bf16_f32 v33, v194, v195
v_cvt_pk_bf16_f32 v34, v196, v197
v_cvt_pk_bf16_f32 v35, v198, v199
v_cvt_pk_bf16_f32 v36, v202, v203
v_cvt_pk_bf16_f32 v37, v204, v205
v_cvt_pk_bf16_f32 v38, v206, v207
v_cvt_pk_bf16_f32 v39, v208, v209
v_cvt_pk_bf16_f32 v40, v200, v210
v_mov_b32 v41, 0
v_mov_b32 v42, 0
v_mov_b32 v43, 0
s_mov_b64 exec, s[76:77]
buffer_load_dwordx4 v[116:119], v30, s[4:7], s92 offen offset:2048 sc1
buffer_load_dwordx4 v[120:123], v30, s[4:7], s92 offen offset:2688 sc1
buffer_load_dword v124, v31, s[4:7], s92 offen offset:3328 sc1
s_mov_b64 exec, -1
s_mov_b32 s75, 0
v_max3_f32 v26, v80, v81, v82
v_max3_f32 v27, -v80, -v81, -v82
v_max3_f32 v26, v26, v83, v84
v_max3_f32 v27, v27, -v83, -v84
v_max3_f32 v26, v26, v85, v86
v_max3_f32 v27, v27, -v85, -v86
v_max3_f32 v26, v26, v87, v88
v_max3_f32 v27, v27, -v87, -v88
s_nop 1
v_permlane32_swap_b32 v26, v27
v_max_f32 v26, v26, v27
v_mul_f32 v28, -v26, v182
v_mul_f32 v29, -v26, v182
s_nop 1
v_permlane32_swap_b32 v28, v29
v_fma_f32 v192, v80, v182, v28
gr_136:
s_waitcnt vmcnt(21)
v_max3_u32 v223, v128, v130, v132
v_max3_u32 v223, v223, v134, v136
v_cmp_eq_u32 vcc, -1, v223
s_and_b64 vcc, vcc, s[76:77]
s_cbranch_vccnz go_137
gk_138:
v_mfma_f32_32x32x16_bf16 v[64:79], v[212:215], v[128:131], 0
v_lshlrev_b32 v184, 16, v136
v_and_b32 v185, s63, v136
v_fma_f32 v202, -v80, v182, v29
v_fma_f32 v193, v81, v182, v28
v_fma_f32 v203, -v81, v182, v29
v_fma_f32 v194, v82, v182, v28
v_fma_f32 v204, -v82, v182, v29
v_fma_f32 v195, v83, v182, v28
v_mfma_f32_32x32x16_bf16 v[64:79], v[216:219], v[132:135], v[64:79]
v_fma_f32 v205, -v83, v182, v29
v_fma_f32 v196, v84, v182, v28
v_fma_f32 v206, -v84, v182, v29
v_fma_f32 v197, v85, v182, v28
v_fma_f32 v207, -v85, v182, v29
v_fma_f32 v198, v86, v182, v28
v_fma_f32 v208, -v86, v182, v29
v_fma_f32 v199, v87, v182, v28
gr_139:
s_waitcnt vmcnt(18)
v_max3_u32 v223, v138, v140, v142
v_max3_u32 v223, v223, v144, v146
v_cmp_eq_u32 vcc, -1, v223
s_and_b64 vcc, vcc, s[76:77]
s_cbranch_vccnz go_140
gk_141:
v_mfma_f32_32x32x16_bf16 v[64:79], v[212:215], v[138:141], v[64:79]
v_lshlrev_b32 v186, 16, v146
v_and_b32 v187, s63, v146
v_add_f32 v184, v184, v186
v_add_f32 v185, v185, v187
v_fma_f32 v209, -v87, v182, v29
v_fma_f32 v200, v88, v182, v28
v_fma_f32 v210, -v88, v182, v29
v_mfma_f32_32x32x16_bf16 v[64:79], v[216:219], v[142:145], v[64:79]
v_exp_f32 v192, v192
v_exp_f32 v202, v202
v_exp_f32 v193, v193
v_exp_f32 v203, v203
gr_142:
s_waitcnt vmcnt(15)
v_max3_u32 v223, v148, v150, v152
v_max3_u32 v223, v223, v154, v156
v_cmp_eq_u32 vcc, -1, v223
s_and_b64 vcc, vcc, s[76:77]
s_cbranch_vccnz go_143
gk_144:
v_mfma_f32_32x32x16_bf16 v[64:79], v[212:215], v[148:151], v[64:79]
v_lshlrev_b32 v186, 16, v156
v_and_b32 v187, s63, v156
v_add_f32 v184, v184, v186
v_add_f32 v185, v185, v187
v_exp_f32 v194, v194
v_exp_f32 v204, v204
v_mfma_f32_32x32x16_bf16 v[64:79], v[216:219], v[152:155], v[64:79]
v_exp_f32 v195, v195
v_exp_f32 v205, v205
v_exp_f32 v196, v196
v_exp_f32 v206, v206
gr_145:
s_waitcnt vmcnt(12)
v_max3_u32 v223, v158, v160, v162
v_max3_u32 v223, v223, v164, v166
v_cmp_eq_u32 vcc, -1, v223
s_and_b64 vcc, vcc, s[76:77]
s_cbranch_vccnz go_146
gk_147:
s_mov_b32 s69, s92
s_mov_b32 s92, s69
v_mfma_f32_32x32x16_bf16 v[64:79], v[212:215], v[158:161], v[64:79]
v_lshlrev_b32 v186, 16, v166
v_and_b32 v187, s63, v166
v_add_f32 v184, v184, v186
v_add_f32 v185, v185, v187
v_exp_f32 v197, v197
v_exp_f32 v207, v207
v_mfma_f32_32x32x16_bf16 v[64:79], v[216:219], v[162:165], v[64:79]
v_exp_f32 v198, v198
v_exp_f32 v208, v208
v_exp_f32 v199, v199
v_exp_f32 v209, v209
gr_148:
s_waitcnt vmcnt(9)
v_max3_u32 v223, v168, v170, v172
v_max3_u32 v223, v223, v174, v176
v_cmp_eq_u32 vcc, -1, v223
s_and_b64 vcc, vcc, s[76:77]
s_cbranch_vccnz go_149
gk_150:
v_mfma_f32_32x32x16_bf16 v[64:79], v[212:215], v[168:171], v[64:79]
v_lshlrev_b32 v186, 16, v176
v_and_b32 v187, s63, v176
v_add_f32 v184, v184, v186
v_add_f32 v185, v185, v187
v_exp_f32 v200, v200
v_exp_f32 v210, v210
v_mfma_f32_32x32x16_bf16 v[64:79], v[216:219], v[172:175], v[64:79]
v_add_f32 v26, v192, v194
v_add_f32 v28, v202, v204
v_add_f32 v27, v193, v195
v_add_f32 v29, v203, v205
v_add_f32 v26, v26, v196
v_add_f32 v28, v28, v206
v_add_f32 v27, v27, v197
v_add_f32 v29, v29, v207
gr_151:
s_waitcnt vmcnt(6)
v_max3_u32 v223, v96, v98, v100
v_max3_u32 v223, v223, v102, v104
v_cmp_eq_u32 vcc, -1, v223
s_and_b64 vcc, vcc, s[76:77]
s_cbranch_vccnz go_152
gk_153:
v_mfma_f32_32x32x16_bf16 v[64:79], v[212:215], v[96:99], v[64:79]
v_lshlrev_b32 v186, 16, v104
v_and_b32 v187, s63, v104
v_add_f32 v184, v184, v186
v_add_f32 v185, v185, v187
v_add_f32 v26, v26, v198
v_add_f32 v28, v28, v208
v_add_f32 v27, v27, v199
v_add_f32 v29, v29, v209
v_mfma_f32_32x32x16_bf16 v[64:79], v[216:219], v[100:103], v[64:79]
v_add_f32 v26, v26, v27
v_add_f32 v28, v28, v29
v_add_f32 v26, v26, v200
v_add_f32 v28, v28, v210
s_nop 1
v_permlane32_swap_b32 v26, v28
v_add_f32 v26, v26, v28
gr_154:
s_waitcnt vmcnt(3)
v_max3_u32 v223, v106, v108, v110
v_max3_u32 v223, v223, v112, v114
v_cmp_eq_u32 vcc, -1, v223
s_and_b64 vcc, vcc, s[76:77]
s_cbranch_vccnz go_155
gk_156:
v_mfma_f32_32x32x16_bf16 v[64:79], v[212:215], v[106:109], v[64:79]
v_lshlrev_b32 v186, 16, v114
v_and_b32 v187, s63, v114
v_add_f32 v184, v184, v186
v_add_f32 v185, v185, v187
v_rcp_f32 v26, v26
s_nop 0
v_mov_b32 v27, v26
v_mfma_f32_32x32x16_bf16 v[64:79], v[216:219], v[110:113], v[64:79]
s_nop 0
v_permlane32_swap_b32 v26, v27
v_mul_f32 v192, v192, v26
v_mul_f32 v202, v202, v27
v_mul_f32 v193, v193, v26
v_mul_f32 v203, v203, v27
v_mul_f32 v194, v194, v26
gr_157:
s_waitcnt vmcnt(0)
v_max3_u32 v223, v116, v118, v120
v_max3_u32 v223, v223, v122, v124
v_cmp_eq_u32 vcc, -1, v223
s_and_b64 vcc, vcc, s[76:77]
s_cbranch_vccnz go_158
gk_159:
v_mfma_f32_32x32x16_bf16 v[64:79], v[212:215], v[116:119], v[64:79]
v_lshlrev_b32 v186, 16, v124
v_and_b32 v187, s63, v124
v_add_f32 v184, v184, v186
v_add_f32 v185, v185, v187
v_mul_f32 v204, v204, v27
v_mul_f32 v195, v195, v26
v_mul_f32 v205, v205, v27
v_mul_f32 v196, v196, v26
v_mfma_f32_32x32x16_bf16 v[64:79], v[216:219], v[120:123], v[64:79]
v_mul_f32 v206, v206, v27
v_mul_f32 v197, v197, v26
v_mul_f32 v207, v207, v27
v_mul_f32 v198, v198, v26
v_mul_f32 v208, v208, v27
v_mul_f32 v199, v199, v26
v_mul_f32 v209, v209, v27
v_mul_f32 v200, v200, v26
v_mul_f32 v210, v210, v27
v_cvt_pk_bf16_f32 v48, v192, v193
v_cvt_pk_bf16_f32 v49, v194, v195
v_cvt_pk_bf16_f32 v50, v196, v197
v_cvt_pk_bf16_f32 v51, v198, v199
v_cvt_pk_bf16_f32 v52, v202, v203
v_cvt_pk_bf16_f32 v53, v204, v205
v_cvt_pk_bf16_f32 v54, v206, v207
v_cvt_pk_bf16_f32 v55, v208, v209
v_cvt_pk_bf16_f32 v56, v200, v210
v_mov_b32 v57, 0
v_mov_b32 v58, 0
v_mov_b32 v59, 0
v_cvt_pk_bf16_f32 v136, v184, v185
v_mov_b32 v137, 0
v_mov_b32 v138, 0
v_mov_b32 v139, 0
v_cvt_pk_bf16_f32 v128, v64, v65
v_cvt_pk_bf16_f32 v129, v66, v67
v_cvt_pk_bf16_f32 v130, v68, v69
v_cvt_pk_bf16_f32 v131, v70, v71
v_cvt_pk_bf16_f32 v132, v72, v73
v_cvt_pk_bf16_f32 v133, v74, v75
v_cvt_pk_bf16_f32 v134, v76, v77
v_cvt_pk_bf16_f32 v135, v78, v79
v_mfma_f32_32x32x16_bf16 v[64:79], v[128:131], v[32:35], 0
s_nop 0
v_mfma_f32_32x32x16_bf16 v[64:79], v[132:135], v[36:39], v[64:79]
v_mfma_f32_32x32x16_bf16 v[64:79], v[136:139], v[40:43], v[64:79]
v_mfma_f32_32x32x16_bf16 v[80:95], v[128:131], v[48:51], 0
v_mfma_f32_32x32x16_bf16 v[80:95], v[132:135], v[52:55], v[80:95]
v_mfma_f32_32x32x16_bf16 v[80:95], v[136:139], v[56:59], v[80:95]
v_add_u32 v184, 73728, v14
v_add_u32 v185, 115200, v14
v_lshrrev_b32 v186, 4, v1
v_lshlrev_b32 v186, 3, v186
v_and_b32 v187, 7, v1
v_add_u32 v186, v186, v187
v_lshlrev_b32 v186, 4, v186
v_add_u32 v187, 119296, v186
v_add_u32 v186, 77824, v186
v_add_f32 v74, 897988541, v73
v_rcp_f32 v74, v74
s_nop 0
v_pk_mul_f32 v[64:65], v[64:65], v[74:75] op_sel_hi:[1,0]
v_pk_mul_f32 v[66:67], v[66:67], v[74:75] op_sel_hi:[1,0]
v_pk_mul_f32 v[68:69], v[68:69], v[74:75] op_sel_hi:[1,0]
v_pk_mul_f32 v[70:71], v[70:71], v[74:75] op_sel_hi:[1,0]
v_mul_f32 v72, v72, v74
v_cvt_pk_bf16_f32 v112, v64, v65
v_cvt_pk_bf16_f32 v113, v66, v67
v_cvt_pk_bf16_f32 v114, v68, v69
v_cvt_pk_bf16_f32 v115, v70, v71
s_cmp_eq_u32 s97, 0
s_cbranch_scc1 slow_160
buffer_store_dwordx4 v[112:115], v188, s[4:7], s90 offen
back_161:
v_add_f32 v90, 897988541, v89
v_rcp_f32 v90, v90
s_nop 0
v_pk_mul_f32 v[80:81], v[80:81], v[90:91] op_sel_hi:[1,0]
v_pk_mul_f32 v[82:83], v[82:83], v[90:91] op_sel_hi:[1,0]
v_pk_mul_f32 v[84:85], v[84:85], v[90:91] op_sel_hi:[1,0]
v_pk_mul_f32 v[86:87], v[86:87], v[90:91] op_sel_hi:[1,0]
v_mul_f32 v88, v88, v90
v_cvt_pk_bf16_f32 v116, v80, v81
v_cvt_pk_bf16_f32 v117, v82, v83
v_cvt_pk_bf16_f32 v118, v84, v85
v_cvt_pk_bf16_f32 v119, v86, v87
v_permlane32_swap_b32 v72, v88
v_cvt_pk_bf16_f32 v120, v72, v88
s_cmp_eq_u32 s97, 0
s_cbranch_scc1 slow_162
buffer_store_dwordx4 v[116:119], v188, s[4:7], s72 offen
buffer_store_dword v120, v190, s[4:7], s90 offen offset:2048
back_163:
s_lshl_b32 s71, s59, 2
s_add_u32 s71, s71, s98
v_and_b32 v28, 7, v1
v_lshlrev_b32 v28, 2, v28
s_waitcnt vmcnt(0)
s_barrier
s_cmp_lg_u32 s61, 0
s_cbranch_scc1 w_164
s_cmp_eq_u32 s97, 0
s_cbranch_scc1 slow_165
s_mov_b64 exec, 1
v_mov_b32 v26, s62
buffer_store_dword v26, off, s[4:7], s71 offset:512
s_mov_b64 exec, -1
back_166:
w_164:
ds_read_b128 v[124:127], v184 offset:0
ds_read_b128 v[128:131], v184 offset:1024
ds_read_b128 v[132:135], v184 offset:2048
ds_read_b128 v[136:139], v184 offset:3072
ds_read_b128 v[140:143], v186 offset:0
ds_read_b128 v[144:147], v184 offset:4608
ds_read_b128 v[148:151], v184 offset:5632
ds_read_b128 v[152:155], v184 offset:6656
ds_read_b128 v[156:159], v184 offset:7680
ds_read_b128 v[160:163], v186 offset:4608
ds_read_b128 v[164:167], v184 offset:9216
ds_read_b128 v[168:171], v184 offset:10240
ds_read_b128 v[172:175], v184 offset:11264
ds_read_b128 v[176:179], v184 offset:12288
ds_read_b128 v[180:183], v186 offset:9216
s_mul_i32 s66, s61, 18432
s_add_u32 s66, s66, s94
s_add_u32 s66, s66, 2359296
s_cmp_lg_u32 s61, 0
s_cbranch_scc1 w_167
s_waitcnt vmcnt(0)
s_mov_b32 s75, 0
poll_168:
buffer_load_dword v27, v28, s[4:7], s98 offen offset:512 sc1
s_add_u32 s75, s75, 1
s_waitcnt vmcnt(0)
v_cmp_ne_u32 vcc, s62, v27
s_cmp_gt_u32 s75, 200000
s_cbranch_scc1 polle_169
s_cbranch_vccnz poll_168
polle_169:
w_167:
s_barrier
buffer_load_dwordx4 v[52:55], v14, s[4:7], s66 offen offset:0 sc1
buffer_load_dwordx4 v[56:59], v14, s[4:7], s66 offen offset:1024 sc1
buffer_load_dwordx4 v[60:63], v14, s[4:7], s66 offen offset:2048 sc1
buffer_load_dwordx4 v[64:67], v14, s[4:7], s66 offen offset:3072 sc1
s_add_u32 s66, s66, 4096
buffer_load_dwordx4 v[68:71], v14, s[4:7], s66 offen offset:0 sc1
buffer_load_dwordx4 v[72:75], v14, s[4:7], s66 offen offset:1024 sc1
s_waitcnt vmcnt(5) lgkmcnt(10)
v_mfma_f32_16x16x32_bf16 v[32:35], v[124:127], v[52:55], 0
buffer_load_dwordx4 v[76:79], v14, s[4:7], s66 offen offset:2048 sc1
v_mfma_f32_16x16x32_bf16 v[36:39], v[128:131], v[52:55], 0
v_mfma_f32_16x16x32_bf16 v[40:43], v[132:135], v[52:55], 0
v_mfma_f32_16x16x32_bf16 v[44:47], v[136:139], v[52:55], 0
v_mfma_f32_16x16x32_bf16 v[48:51], v[140:143], v[52:55], 0
s_waitcnt vmcnt(5) lgkmcnt(5)
v_mfma_f32_16x16x32_bf16 v[32:35], v[144:147], v[56:59], v[32:35]
buffer_load_dwordx4 v[80:83], v14, s[4:7], s66 offen offset:3072 sc1
s_add_u32 s66, s66, 4096
ds_read_b128 v[124:127], v184 offset:13824
v_mfma_f32_16x16x32_bf16 v[36:39], v[148:151], v[56:59], v[36:39]
ds_read_b128 v[128:131], v184 offset:14848
v_mfma_f32_16x16x32_bf16 v[40:43], v[152:155], v[56:59], v[40:43]
ds_read_b128 v[132:135], v184 offset:15872
v_mfma_f32_16x16x32_bf16 v[44:47], v[156:159], v[56:59], v[44:47]
ds_read_b128 v[136:139], v184 offset:16896
v_mfma_f32_16x16x32_bf16 v[48:51], v[160:163], v[56:59], v[48:51]
ds_read_b128 v[140:143], v186 offset:13824
s_waitcnt vmcnt(5) lgkmcnt(5)
v_mfma_f32_16x16x32_bf16 v[32:35], v[164:167], v[60:63], v[32:35]
buffer_load_dwordx4 v[84:87], v14, s[4:7], s66 offen offset:0 sc1
ds_read_b128 v[144:147], v184 offset:18432
v_mfma_f32_16x16x32_bf16 v[36:39], v[168:171], v[60:63], v[36:39]
ds_read_b128 v[148:151], v184 offset:19456
v_mfma_f32_16x16x32_bf16 v[40:43], v[172:175], v[60:63], v[40:43]
ds_read_b128 v[152:155], v184 offset:20480
v_mfma_f32_16x16x32_bf16 v[44:47], v[176:179], v[60:63], v[44:47]
ds_read_b128 v[156:159], v184 offset:21504
v_mfma_f32_16x16x32_bf16 v[48:51], v[180:183], v[60:63], v[48:51]
ds_read_b128 v[160:163], v186 offset:18432
s_waitcnt vmcnt(5) lgkmcnt(5)
v_mfma_f32_16x16x32_bf16 v[32:35], v[124:127], v[64:67], v[32:35]
buffer_load_dwordx4 v[88:91], v14, s[4:7], s66 offen offset:1024 sc1
ds_read_b128 v[164:167], v184 offset:23040
v_mfma_f32_16x16x32_bf16 v[36:39], v[128:131], v[64:67], v[36:39]
ds_read_b128 v[168:171], v184 offset:24064
v_mfma_f32_16x16x32_bf16 v[40:43], v[132:135], v[64:67], v[40:43]
ds_read_b128 v[172:175], v184 offset:25088
v_mfma_f32_16x16x32_bf16 v[44:47], v[136:139], v[64:67], v[44:47]
ds_read_b128 v[176:179], v184 offset:26112
v_mfma_f32_16x16x32_bf16 v[48:51], v[140:143], v[64:67], v[48:51]
ds_read_b128 v[180:183], v186 offset:23040
s_waitcnt vmcnt(5) lgkmcnt(5)
v_mfma_f32_16x16x32_bf16 v[32:35], v[144:147], v[68:71], v[32:35]
buffer_load_dwordx4 v[92:95], v14, s[4:7], s66 offen offset:2048 sc1
ds_read_b128 v[124:127], v184 offset:27648
v_mfma_f32_16x16x32_bf16 v[36:39], v[148:151], v[68:71], v[36:39]
ds_read_b128 v[128:131], v184 offset:28672
v_mfma_f32_16x16x32_bf16 v[40:43], v[152:155], v[68:71], v[40:43]
ds_read_b128 v[132:135], v184 offset:29696
v_mfma_f32_16x16x32_bf16 v[44:47], v[156:159], v[68:71], v[44:47]
ds_read_b128 v[136:139], v184 offset:30720
v_mfma_f32_16x16x32_bf16 v[48:51], v[160:163], v[68:71], v[48:51]
ds_read_b128 v[140:143], v186 offset:27648
s_waitcnt vmcnt(5) lgkmcnt(5)
v_mfma_f32_16x16x32_bf16 v[32:35], v[164:167], v[72:75], v[32:35]
buffer_load_dwordx4 v[96:99], v14, s[4:7], s66 offen offset:3072 sc1
s_add_u32 s66, s66, 4096
ds_read_b128 v[144:147], v184 offset:32256
v_mfma_f32_16x16x32_bf16 v[36:39], v[168:171], v[72:75], v[36:39]
ds_read_b128 v[148:151], v184 offset:33280
v_mfma_f32_16x16x32_bf16 v[40:43], v[172:175], v[72:75], v[40:43]
ds_read_b128 v[152:155], v184 offset:34304
v_mfma_f32_16x16x32_bf16 v[44:47], v[176:179], v[72:75], v[44:47]
ds_read_b128 v[156:159], v184 offset:35328
v_mfma_f32_16x16x32_bf16 v[48:51], v[180:183], v[72:75], v[48:51]
ds_read_b128 v[160:163], v186 offset:32256
s_waitcnt vmcnt(5) lgkmcnt(5)
v_mfma_f32_16x16x32_bf16 v[32:35], v[124:127], v[76:79], v[32:35]
buffer_load_dwordx4 v[100:103], v14, s[4:7], s66 offen offset:0 sc1
ds_read_b128 v[164:167], v184 offset:36864
v_mfma_f32_16x16x32_bf16 v[36:39], v[128:131], v[76:79], v[36:39]
ds_read_b128 v[168:171], v184 offset:37888
v_mfma_f32_16x16x32_bf16 v[40:43], v[132:135], v[76:79], v[40:43]
ds_read_b128 v[172:175], v184 offset:38912
v_mfma_f32_16x16x32_bf16 v[44:47], v[136:139], v[76:79], v[44:47]
ds_read_b128 v[176:179], v184 offset:39936
v_mfma_f32_16x16x32_bf16 v[48:51], v[140:143], v[76:79], v[48:51]
ds_read_b128 v[180:183], v186 offset:36864
s_waitcnt vmcnt(5) lgkmcnt(5)
v_mfma_f32_16x16x32_bf16 v[32:35], v[144:147], v[80:83], v[32:35]
buffer_load_dwordx4 v[104:107], v14, s[4:7], s66 offen offset:1024 sc1
ds_read_b128 v[124:127], v185 offset:0
v_mfma_f32_16x16x32_bf16 v[36:39], v[148:151], v[80:83], v[36:39]
ds_read_b128 v[128:131], v185 offset:1024
v_mfma_f32_16x16x32_bf16 v[40:43], v[152:155], v[80:83], v[40:43]
ds_read_b128 v[132:135], v185 offset:2048
v_mfma_f32_16x16x32_bf16 v[44:47], v[156:159], v[80:83], v[44:47]
ds_read_b128 v[136:139], v185 offset:3072
v_mfma_f32_16x16x32_bf16 v[48:51], v[160:163], v[80:83], v[48:51]
ds_read_b128 v[140:143], v187 offset:0
s_waitcnt vmcnt(5) lgkmcnt(5)
v_mfma_f32_16x16x32_bf16 v[32:35], v[164:167], v[84:87], v[32:35]
buffer_load_dwordx4 v[108:111], v14, s[4:7], s66 offen offset:2048 sc1
ds_read_b128 v[144:147], v185 offset:4608
v_mfma_f32_16x16x32_bf16 v[36:39], v[168:171], v[84:87], v[36:39]
ds_read_b128 v[148:151], v185 offset:5632
v_mfma_f32_16x16x32_bf16 v[40:43], v[172:175], v[84:87], v[40:43]
ds_read_b128 v[152:155], v185 offset:6656
v_mfma_f32_16x16x32_bf16 v[44:47], v[176:179], v[84:87], v[44:47]
ds_read_b128 v[156:159], v185 offset:7680
v_mfma_f32_16x16x32_bf16 v[48:51], v[180:183], v[84:87], v[48:51]
ds_read_b128 v[160:163], v187 offset:4608
s_waitcnt vmcnt(5) lgkmcnt(5)
v_mfma_f32_16x16x32_bf16 v[32:35], v[124:127], v[88:91], v[32:35]
buffer_load_dwordx4 v[112:115], v14, s[4:7], s66 offen offset:3072 sc1
s_add_u32 s66, s66, 4096
ds_read_b128 v[164:167], v185 offset:9216
v_mfma_f32_16x16x32_bf16 v[36:39], v[128:131], v[88:91], v[36:39]
ds_read_b128 v[168:171], v185 offset:10240
v_mfma_f32_16x16x32_bf16 v[40:43], v[132:135], v[88:91], v[40:43]
ds_read_b128 v[172:175], v185 offset:11264
v_mfma_f32_16x16x32_bf16 v[44:47], v[136:139], v[88:91], v[44:47]
ds_read_b128 v[176:179], v185 offset:12288
v_mfma_f32_16x16x32_bf16 v[48:51], v[140:143], v[88:91], v[48:51]
ds_read_b128 v[180:183], v187 offset:9216
s_waitcnt vmcnt(5) lgkmcnt(5)
v_mfma_f32_16x16x32_bf16 v[32:35], v[144:147], v[92:95], v[32:35]
buffer_load_dwordx4 v[116:119], v14, s[4:7], s66 offen offset:0 sc1
ds_read_b128 v[124:127], v185 offset:13824
v_mfma_f32_16x16x32_bf16 v[36:39], v[148:151], v[92:95], v[36:39]
ds_read_b128 v[128:131], v185 offset:14848
v_mfma_f32_16x16x32_bf16 v[40:43], v[152:155], v[92:95], v[40:43]
ds_read_b128 v[132:135], v185 offset:15872
v_mfma_f32_16x16x32_bf16 v[44:47], v[156:159], v[92:95], v[44:47]
ds_read_b128 v[136:139], v185 offset:16896
v_mfma_f32_16x16x32_bf16 v[48:51], v[160:163], v[92:95], v[48:51]
ds_read_b128 v[140:143], v187 offset:13824
s_waitcnt vmcnt(5) lgkmcnt(5)
v_mfma_f32_16x16x32_bf16 v[32:35], v[164:167], v[96:99], v[32:35]
buffer_load_dwordx4 v[120:123], v14, s[4:7], s66 offen offset:1024 sc1
ds_read_b128 v[144:147], v185 offset:18432
v_mfma_f32_16x16x32_bf16 v[36:39], v[168:171], v[96:99], v[36:39]
ds_read_b128 v[148:151], v185 offset:19456
v_mfma_f32_16x16x32_bf16 v[40:43], v[172:175], v[96:99], v[40:43]
ds_read_b128 v[152:155], v185 offset:20480
v_mfma_f32_16x16x32_bf16 v[44:47], v[176:179], v[96:99], v[44:47]
ds_read_b128 v[156:159], v185 offset:21504
v_mfma_f32_16x16x32_bf16 v[48:51], v[180:183], v[96:99], v[48:51]
ds_read_b128 v[160:163], v187 offset:18432
s_waitcnt vmcnt(5) lgkmcnt(5)
v_mfma_f32_16x16x32_bf16 v[32:35], v[124:127], v[100:103], v[32:35]
ds_read_b128 v[164:167], v185 offset:23040
v_mfma_f32_16x16x32_bf16 v[36:39], v[128:131], v[100:103], v[36:39]
ds_read_b128 v[168:171], v185 offset:24064
v_mfma_f32_16x16x32_bf16 v[40:43], v[132:135], v[100:103], v[40:43]
ds_read_b128 v[172:175], v185 offset:25088
v_mfma_f32_16x16x32_bf16 v[44:47], v[136:139], v[100:103], v[44:47]
ds_read_b128 v[176:179], v185 offset:26112
v_mfma_f32_16x16x32_bf16 v[48:51], v[140:143], v[100:103], v[48:51]
ds_read_b128 v[180:183], v187 offset:23040
s_waitcnt vmcnt(4) lgkmcnt(5)
v_mfma_f32_16x16x32_bf16 v[32:35], v[144:147], v[104:107], v[32:35]
ds_read_b128 v[124:127], v185 offset:27648
v_mfma_f32_16x16x32_bf16 v[36:39], v[148:151], v[104:107], v[36:39]
ds_read_b128 v[128:131], v185 offset:28672
v_mfma_f32_16x16x32_bf16 v[40:43], v[152:155], v[104:107], v[40:43]
ds_read_b128 v[132:135], v185 offset:29696
v_mfma_f32_16x16x32_bf16 v[44:47], v[156:159], v[104:107], v[44:47]
ds_read_b128 v[136:139], v185 offset:30720
v_mfma_f32_16x16x32_bf16 v[48:51], v[160:163], v[104:107], v[48:51]
ds_read_b128 v[140:143], v187 offset:27648
s_waitcnt vmcnt(3) lgkmcnt(5)
v_mfma_f32_16x16x32_bf16 v[32:35], v[164:167], v[108:111], v[32:35]
ds_read_b128 v[144:147], v185 offset:32256
v_mfma_f32_16x16x32_bf16 v[36:39], v[168:171], v[108:111], v[36:39]
ds_read_b128 v[148:151], v185 offset:33280
v_mfma_f32_16x16x32_bf16 v[40:43], v[172:175], v[108:111], v[40:43]
ds_read_b128 v[152:155], v185 offset:34304
v_mfma_f32_16x16x32_bf16 v[44:47], v[176:179], v[108:111], v[44:47]
ds_read_b128 v[156:159], v185 offset:35328
v_mfma_f32_16x16x32_bf16 v[48:51], v[180:183], v[108:111], v[48:51]
ds_read_b128 v[160:163], v187 offset:32256
s_waitcnt vmcnt(2) lgkmcnt(5)
v_mfma_f32_16x16x32_bf16 v[32:35], v[124:127], v[112:115], v[32:35]
ds_read_b128 v[164:167], v185 offset:36864
v_mfma_f32_16x16x32_bf16 v[36:39], v[128:131], v[112:115], v[36:39]
ds_read_b128 v[168:171], v185 offset:37888
v_mfma_f32_16x16x32_bf16 v[40:43], v[132:135], v[112:115], v[40:43]
ds_read_b128 v[172:175], v185 offset:38912
v_mfma_f32_16x16x32_bf16 v[44:47], v[136:139], v[112:115], v[44:47]
ds_read_b128 v[176:179], v185 offset:39936
v_mfma_f32_16x16x32_bf16 v[48:51], v[140:143], v[112:115], v[48:51]
ds_read_b128 v[180:183], v187 offset:36864
s_waitcnt vmcnt(1) lgkmcnt(5)
v_mfma_f32_16x16x32_bf16 v[32:35], v[144:147], v[116:119], v[32:35]
v_mfma_f32_16x16x32_bf16 v[36:39], v[148:151], v[116:119], v[36:39]
v_mfma_f32_16x16x32_bf16 v[40:43], v[152:155], v[116:119], v[40:43]
v_mfma_f32_16x16x32_bf16 v[44:47], v[156:159], v[116:119], v[44:47]
v_mfma_f32_16x16x32_bf16 v[48:51], v[160:163], v[116:119], v[48:51]
s_waitcnt vmcnt(0) lgkmcnt(0)
v_mfma_f32_16x16x32_bf16 v[32:35], v[164:167], v[120:123], v[32:35]
v_mfma_f32_16x16x32_bf16 v[36:39], v[168:171], v[120:123], v[36:39]
v_mfma_f32_16x16x32_bf16 v[40:43], v[172:175], v[120:123], v[40:43]
v_mfma_f32_16x16x32_bf16 v[44:47], v[176:179], v[120:123], v[44:47]
v_mfma_f32_16x16x32_bf16 v[48:51], v[180:183], v[120:123], v[48:51]
v_lshlrev_b32 v56, 16, v2
v_and_b32 v57, s63, v2
v_lshlrev_b32 v58, 16, v3
v_and_b32 v59, s63, v3
v_lshlrev_b32 v60, 16, v4
v_and_b32 v61, s63, v4
v_lshlrev_b32 v62, 16, v5
v_and_b32 v63, s63, v5
v_lshlrev_b32 v64, 16, v6
v_and_b32 v65, s63, v6
v_lshlrev_b32 v66, 16, v7
v_and_b32 v67, s63, v7
v_lshlrev_b32 v68, 16, v8
v_and_b32 v69, s63, v8
v_lshlrev_b32 v70, 16, v9
v_and_b32 v71, s63, v9
v_lshlrev_b32 v72, 16, v10
v_and_b32 v73, s63, v10
v_lshlrev_b32 v74, 16, v11
v_and_b32 v75, s63, v11
s_mov_b32 s36, s28
s_mov_b32 s37, s29
s_mov_b32 s38, 2359296
s_mov_b32 s39, 0x20000
v_and_b32 v26, 15, v1
v_mul_u32_u24 v26, 1152, v26
v_lshrrev_b32 v27, 4, v1
v_lshl_add_u32 v28, v27, 3, v26
v_and_b32 v29, 1, v27
v_lshl_add_u32 v26, v29, 5, v26
v_lshrrev_b32 v27, 1, v27
v_lshl_add_u32 v26, v27, 4, v26
s_lshl_b32 s66, s58, 2
s_add_u32 s66, s66, s61
s_mul_i32 s66, s66, 18432
s_mul_i32 s67, s59, 144
s_add_u32 s66, s66, s67
v_pk_add_f32 v[56:57], v[56:57], v[32:33]
v_pk_add_f32 v[58:59], v[58:59], v[34:35]
v_cvt_pk_bf16_f32 v96, v56, v57
v_cvt_pk_bf16_f32 v97, v58, v59
v_pk_add_f32 v[60:61], v[60:61], v[36:37]
v_pk_add_f32 v[62:63], v[62:63], v[38:39]
v_cvt_pk_bf16_f32 v98, v60, v61
v_cvt_pk_bf16_f32 v99, v62, v63
s_nop 0
v_permlane16_swap_b32 v96, v98
v_permlane16_swap_b32 v97, v99
buffer_store_dwordx4 v[96:99], v26, s[36:39], s66 offen offset:0
v_pk_add_f32 v[64:65], v[64:65], v[40:41]
v_pk_add_f32 v[66:67], v[66:67], v[42:43]
v_cvt_pk_bf16_f32 v100, v64, v65
v_cvt_pk_bf16_f32 v101, v66, v67
v_pk_add_f32 v[68:69], v[68:69], v[44:45]
v_pk_add_f32 v[70:71], v[70:71], v[46:47]
v_cvt_pk_bf16_f32 v102, v68, v69
v_cvt_pk_bf16_f32 v103, v70, v71
s_nop 0
v_permlane16_swap_b32 v100, v102
v_permlane16_swap_b32 v101, v103
buffer_store_dwordx4 v[100:103], v26, s[36:39], s66 offen offset:64
v_pk_add_f32 v[72:73], v[72:73], v[48:49]
v_pk_add_f32 v[74:75], v[74:75], v[50:51]
v_cvt_pk_bf16_f32 v104, v72, v73
v_cvt_pk_bf16_f32 v105, v74, v75
s_mov_b32 exec_hi, 0
buffer_store_dwordx2 v[104:105], v28, s[36:39], s66 offen offset:128
s_mov_b64 exec, -1
s_or_b32 s66, s2, s61
s_cmp_lg_u32 s66, 0
s_cbranch_scc1 ep_170
s_mov_b32 s66, 0
s_mov_b64 exec, 1
v_mov_b32 v26, s62
buffer_store_dword v26, off, s[4:7], s66 offset:0 sc1
s_mov_b64 exec, -1
ep_170:
L_end:
s_endpgm
slow_36:
buffer_store_dwordx2 v[72:73], v26, s[4:7], s67 offen sc1
s_branch back_37
slow_39:
s_mov_b64 exec, 1
v_mov_b32 v26, s62
buffer_store_dword v26, off, s[4:7], s67 offset:0 sc1
s_mov_b64 exec, -1
s_branch back_40
slow_41:
s_mov_b64 exec, 1
v_mov_b32 v26, s62
buffer_store_dword v26, off, s[4:7], s68 offset:0 sc1
s_mov_b64 exec, -1
s_branch back_42
pf_53:
s_add_u32 s89, s93, 36864
buffer_load_dwordx4 v[176:179], v160, s[4:7], s89 offen sc1
s_add_u32 s89, s93, 37888
buffer_load_dwordx4 v[176:179], v160, s[4:7], s89 offen sc1
s_add_u32 s89, s93, 38912
buffer_load_dwordx4 v[176:179], v160, s[4:7], s89 offen sc1
s_add_u32 s89, s93, 39936
buffer_load_dwordx4 v[176:179], v160, s[4:7], s89 offen sc1
s_add_u32 s89, s93, 40960
buffer_load_dwordx4 v[176:179], v160, s[4:7], s89 offen sc1
s_add_u32 s89, s93, 41984
buffer_load_dwordx4 v[176:179], v160, s[4:7], s89 offen sc1
s_add_u32 s89, s93, 43008
buffer_load_dwordx4 v[176:179], v160, s[4:7], s89 offen sc1
s_add_u32 s89, s93, 44032
buffer_load_dwordx4 v[176:179], v160, s[4:7], s89 offen sc1
s_branch pfe_54
po_56:
s_add_u32 s75, s75, 1
s_cmp_gt_u32 s75, 20000
s_cbranch_scc1 pk_57
s_sleep 2
s_add_u32 m0, s70, 0
s_nop 0
buffer_load_dwordx4 v27, s[4:7], s69 offen sc1 lds
s_add_u32 m0, s70, 1024
s_nop 0
buffer_load_dwordx4 v27, s[4:7], s91 offen sc1 lds
s_add_u32 m0, s70, 2048
s_nop 0
buffer_load_dwordx4 v29, s[4:7], s90 offen sc1 lds
s_waitcnt vmcnt(0)
s_branch py_55
slow_58:
buffer_store_dwordx4 v[2:5], v12, s[4:7], s66 offen sc1
buffer_store_dwordx4 v[6:9], v12, s[4:7], s66 offen offset:2048 sc1
s_mov_b32 exec_hi, 0
buffer_store_dwordx2 v[10:11], v223, s[4:7], s68 offen sc1
s_mov_b32 exec_hi, -1
s_branch back_59
slow_60:
buffer_store_dword v140, v13, s[4:7], s67 offen sc1
s_branch back_61
slow_63:
s_mov_b64 exec, 1
v_mov_b32 v140, s62
buffer_store_dword v140, off, s[4:7], s71 offset:0 sc1
s_mov_b64 exec, -1
s_branch back_64
fo_69:
s_add_u32 s75, s75, 1
s_cmp_gt_u32 s75, 200000
s_cbranch_scc1 fk_70
buffer_load_dword v188, v223, s[4:7], s72 offen sc1
s_waitcnt vmcnt(0)
s_branch fr_68
slow_71:
buffer_store_dwordx4 v[148:151], v184, s[4:7], s67 offen sc1
buffer_store_dwordx4 v[152:155], v185, s[4:7], s67 offen sc1
buffer_store_dword v156, v31, s[4:7], s68 offen sc1
s_branch back_72
slow_73:
s_mov_b64 exec, 1
v_mov_b32 v164, s62
buffer_store_dword v164, off, s[4:7], s67 offset:0 sc1
s_mov_b64 exec, -1
s_branch back_74
po_76:
s_add_u32 s75, s75, 1
s_cmp_gt_u32 s75, 200000
s_cbranch_scc1 pk_77
buffer_load_dword v165, v176, s[4:7], s66 offen sc1
s_waitcnt vmcnt(0)
s_branch pr_75
go_79:
s_add_u32 s75, s75, 1
s_cmp_gt_u32 s75, 20000
s_cbranch_scc1 gk_80
s_waitcnt vmcnt(0)
s_mov_b64 exec, s[76:77]
buffer_load_dwordx4 v[128:131], v30, s[4:7], s66 offen offset:0 sc1
buffer_load_dwordx4 v[132:135], v30, s[4:7], s66 offen offset:640 sc1
buffer_load_dword v136, v31, s[4:7], s66 offen offset:1280 sc1
buffer_load_dwordx4 v[138:141], v30, s[4:7], s66 offen offset:2048 sc1
buffer_load_dwordx4 v[142:145], v30, s[4:7], s66 offen offset:2688 sc1
buffer_load_dword v146, v31, s[4:7], s66 offen offset:3328 sc1
buffer_load_dwordx4 v[148:151], v30, s[4:7], s67 offen offset:0 sc1
buffer_load_dwordx4 v[152:155], v30, s[4:7], s67 offen offset:640 sc1
buffer_load_dword v156, v31, s[4:7], s67 offen offset:1280 sc1
buffer_load_dwordx4 v[158:161], v30, s[4:7], s67 offen offset:2048 sc1
buffer_load_dwordx4 v[162:165], v30, s[4:7], s67 offen offset:2688 sc1
buffer_load_dword v166, v31, s[4:7], s67 offen offset:3328 sc1
buffer_load_dwordx4 v[168:171], v30, s[4:7], s68 offen offset:0 sc1
buffer_load_dwordx4 v[172:175], v30, s[4:7], s68 offen offset:640 sc1
buffer_load_dword v176, v31, s[4:7], s68 offen offset:1280 sc1
buffer_load_dwordx4 v[96:99], v30, s[4:7], s68 offen offset:2048 sc1
buffer_load_dwordx4 v[100:103], v30, s[4:7], s68 offen offset:2688 sc1
buffer_load_dword v104, v31, s[4:7], s68 offen offset:3328 sc1
buffer_load_dwordx4 v[106:109], v30, s[4:7], s92 offen offset:0 sc1
buffer_load_dwordx4 v[110:113], v30, s[4:7], s92 offen offset:640 sc1
buffer_load_dword v114, v31, s[4:7], s92 offen offset:1280 sc1
buffer_load_dwordx4 v[116:119], v30, s[4:7], s92 offen offset:2048 sc1
buffer_load_dwordx4 v[120:123], v30, s[4:7], s92 offen offset:2688 sc1
buffer_load_dword v124, v31, s[4:7], s92 offen offset:3328 sc1
s_mov_b64 exec, -1
s_branch gr_78
go_82:
s_add_u32 s75, s75, 1
s_cmp_gt_u32 s75, 20000
s_cbranch_scc1 gk_83
s_waitcnt vmcnt(0)
s_mov_b64 exec, s[76:77]
buffer_load_dwordx4 v[138:141], v30, s[4:7], s66 offen offset:2048 sc1
buffer_load_dwordx4 v[142:145], v30, s[4:7], s66 offen offset:2688 sc1
buffer_load_dword v146, v31, s[4:7], s66 offen offset:3328 sc1
buffer_load_dwordx4 v[148:151], v30, s[4:7], s67 offen offset:0 sc1
buffer_load_dwordx4 v[152:155], v30, s[4:7], s67 offen offset:640 sc1
buffer_load_dword v156, v31, s[4:7], s67 offen offset:1280 sc1
buffer_load_dwordx4 v[158:161], v30, s[4:7], s67 offen offset:2048 sc1
buffer_load_dwordx4 v[162:165], v30, s[4:7], s67 offen offset:2688 sc1
buffer_load_dword v166, v31, s[4:7], s67 offen offset:3328 sc1
buffer_load_dwordx4 v[168:171], v30, s[4:7], s68 offen offset:0 sc1
buffer_load_dwordx4 v[172:175], v30, s[4:7], s68 offen offset:640 sc1
buffer_load_dword v176, v31, s[4:7], s68 offen offset:1280 sc1
buffer_load_dwordx4 v[96:99], v30, s[4:7], s68 offen offset:2048 sc1
buffer_load_dwordx4 v[100:103], v30, s[4:7], s68 offen offset:2688 sc1
buffer_load_dword v104, v31, s[4:7], s68 offen offset:3328 sc1
buffer_load_dwordx4 v[106:109], v30, s[4:7], s92 offen offset:0 sc1
buffer_load_dwordx4 v[110:113], v30, s[4:7], s92 offen offset:640 sc1
buffer_load_dword v114, v31, s[4:7], s92 offen offset:1280 sc1
buffer_load_dwordx4 v[116:119], v30, s[4:7], s92 offen offset:2048 sc1
buffer_load_dwordx4 v[120:123], v30, s[4:7], s92 offen offset:2688 sc1
buffer_load_dword v124, v31, s[4:7], s92 offen offset:3328 sc1
s_mov_b64 exec, -1
s_branch gr_81
go_85:
s_add_u32 s75, s75, 1
s_cmp_gt_u32 s75, 20000
s_cbranch_scc1 gk_86
s_waitcnt vmcnt(0)
s_mov_b64 exec, s[76:77]
buffer_load_dwordx4 v[148:151], v30, s[4:7], s67 offen offset:0 sc1
buffer_load_dwordx4 v[152:155], v30, s[4:7], s67 offen offset:640 sc1
buffer_load_dword v156, v31, s[4:7], s67 offen offset:1280 sc1
buffer_load_dwordx4 v[158:161], v30, s[4:7], s67 offen offset:2048 sc1
buffer_load_dwordx4 v[162:165], v30, s[4:7], s67 offen offset:2688 sc1
buffer_load_dword v166, v31, s[4:7], s67 offen offset:3328 sc1
buffer_load_dwordx4 v[168:171], v30, s[4:7], s68 offen offset:0 sc1
buffer_load_dwordx4 v[172:175], v30, s[4:7], s68 offen offset:640 sc1
buffer_load_dword v176, v31, s[4:7], s68 offen offset:1280 sc1
buffer_load_dwordx4 v[96:99], v30, s[4:7], s68 offen offset:2048 sc1
buffer_load_dwordx4 v[100:103], v30, s[4:7], s68 offen offset:2688 sc1
buffer_load_dword v104, v31, s[4:7], s68 offen offset:3328 sc1
buffer_load_dwordx4 v[106:109], v30, s[4:7], s92 offen offset:0 sc1
buffer_load_dwordx4 v[110:113], v30, s[4:7], s92 offen offset:640 sc1
buffer_load_dword v114, v31, s[4:7], s92 offen offset:1280 sc1
buffer_load_dwordx4 v[116:119], v30, s[4:7], s92 offen offset:2048 sc1
buffer_load_dwordx4 v[120:123], v30, s[4:7], s92 offen offset:2688 sc1
buffer_load_dword v124, v31, s[4:7], s92 offen offset:3328 sc1
s_mov_b64 exec, -1
s_branch gr_84
go_88:
s_add_u32 s75, s75, 1
s_cmp_gt_u32 s75, 20000
s_cbranch_scc1 gk_89
s_waitcnt vmcnt(0)
s_mov_b64 exec, s[76:77]
buffer_load_dwordx4 v[158:161], v30, s[4:7], s67 offen offset:2048 sc1
buffer_load_dwordx4 v[162:165], v30, s[4:7], s67 offen offset:2688 sc1
buffer_load_dword v166, v31, s[4:7], s67 offen offset:3328 sc1
buffer_load_dwordx4 v[168:171], v30, s[4:7], s68 offen offset:0 sc1
buffer_load_dwordx4 v[172:175], v30, s[4:7], s68 offen offset:640 sc1
buffer_load_dword v176, v31, s[4:7], s68 offen offset:1280 sc1
buffer_load_dwordx4 v[96:99], v30, s[4:7], s68 offen offset:2048 sc1
buffer_load_dwordx4 v[100:103], v30, s[4:7], s68 offen offset:2688 sc1
buffer_load_dword v104, v31, s[4:7], s68 offen offset:3328 sc1
buffer_load_dwordx4 v[106:109], v30, s[4:7], s92 offen offset:0 sc1
buffer_load_dwordx4 v[110:113], v30, s[4:7], s92 offen offset:640 sc1
buffer_load_dword v114, v31, s[4:7], s92 offen offset:1280 sc1
buffer_load_dwordx4 v[116:119], v30, s[4:7], s92 offen offset:2048 sc1
buffer_load_dwordx4 v[120:123], v30, s[4:7], s92 offen offset:2688 sc1
buffer_load_dword v124, v31, s[4:7], s92 offen offset:3328 sc1
s_mov_b64 exec, -1
s_branch gr_87
go_94:
s_add_u32 s75, s75, 1
s_cmp_gt_u32 s75, 20000
s_cbranch_scc1 gk_95
s_waitcnt vmcnt(0)
s_mov_b64 exec, s[76:77]
buffer_load_dwordx4 v[168:171], v30, s[4:7], s68 offen offset:0 sc1
buffer_load_dwordx4 v[172:175], v30, s[4:7], s68 offen offset:640 sc1
buffer_load_dword v176, v31, s[4:7], s68 offen offset:1280 sc1
buffer_load_dwordx4 v[96:99], v30, s[4:7], s68 offen offset:2048 sc1
buffer_load_dwordx4 v[100:103], v30, s[4:7], s68 offen offset:2688 sc1
buffer_load_dword v104, v31, s[4:7], s68 offen offset:3328 sc1
buffer_load_dwordx4 v[106:109], v30, s[4:7], s92 offen offset:0 sc1
buffer_load_dwordx4 v[110:113], v30, s[4:7], s92 offen offset:640 sc1
buffer_load_dword v114, v31, s[4:7], s92 offen offset:1280 sc1
buffer_load_dwordx4 v[116:119], v30, s[4:7], s92 offen offset:2048 sc1
buffer_load_dwordx4 v[120:123], v30, s[4:7], s92 offen offset:2688 sc1
buffer_load_dword v124, v31, s[4:7], s92 offen offset:3328 sc1
s_mov_b64 exec, -1
s_waitcnt vmcnt(0)
s_branch gr_93
go_97:
s_add_u32 s75, s75, 1
s_cmp_gt_u32 s75, 20000
s_cbranch_scc1 gk_98
s_waitcnt vmcnt(0)
s_mov_b64 exec, s[76:77]
buffer_load_dwordx4 v[96:99], v30, s[4:7], s68 offen offset:2048 sc1
buffer_load_dwordx4 v[100:103], v30, s[4:7], s68 offen offset:2688 sc1
buffer_load_dword v104, v31, s[4:7], s68 offen offset:3328 sc1
buffer_load_dwordx4 v[106:109], v30, s[4:7], s92 offen offset:0 sc1
buffer_load_dwordx4 v[110:113], v30, s[4:7], s92 offen offset:640 sc1
buffer_load_dword v114, v31, s[4:7], s92 offen offset:1280 sc1
buffer_load_dwordx4 v[116:119], v30, s[4:7], s92 offen offset:2048 sc1
buffer_load_dwordx4 v[120:123], v30, s[4:7], s92 offen offset:2688 sc1
buffer_load_dword v124, v31, s[4:7], s92 offen offset:3328 sc1
s_mov_b64 exec, -1
s_waitcnt vmcnt(0)
s_branch gr_96
go_100:
s_add_u32 s75, s75, 1
s_cmp_gt_u32 s75, 20000
s_cbranch_scc1 gk_101
s_waitcnt vmcnt(0)
s_mov_b64 exec, s[76:77]
buffer_load_dwordx4 v[106:109], v30, s[4:7], s92 offen offset:0 sc1
buffer_load_dwordx4 v[110:113], v30, s[4:7], s92 offen offset:640 sc1
buffer_load_dword v114, v31, s[4:7], s92 offen offset:1280 sc1
buffer_load_dwordx4 v[116:119], v30, s[4:7], s92 offen offset:2048 sc1
buffer_load_dwordx4 v[120:123], v30, s[4:7], s92 offen offset:2688 sc1
buffer_load_dword v124, v31, s[4:7], s92 offen offset:3328 sc1
s_mov_b64 exec, -1
s_waitcnt vmcnt(0)
s_branch gr_99
go_103:
s_add_u32 s75, s75, 1
s_cmp_gt_u32 s75, 20000
s_cbranch_scc1 gk_104
s_waitcnt vmcnt(0)
s_mov_b64 exec, s[76:77]
buffer_load_dwordx4 v[116:119], v30, s[4:7], s92 offen offset:2048 sc1
buffer_load_dwordx4 v[120:123], v30, s[4:7], s92 offen offset:2688 sc1
buffer_load_dword v124, v31, s[4:7], s92 offen offset:3328 sc1
s_mov_b64 exec, -1
s_waitcnt vmcnt(0)
s_branch gr_102
slow_105:
buffer_store_dwordx4 v[112:115], v188, s[4:7], s90 offen sc1
s_branch back_106
slow_107:
buffer_store_dwordx4 v[116:119], v188, s[4:7], s72 offen sc1
buffer_store_dword v120, v190, s[4:7], s90 offen offset:2048 sc1
s_branch back_108
slow_110:
s_mov_b64 exec, 1
v_mov_b32 v26, s62
buffer_store_dword v26, off, s[4:7], s71 offset:128 sc1
s_mov_b64 exec, -1
s_branch back_111
slow_115:
buffer_store_dword v124, v13, s[4:7], s67 offen sc1
s_branch back_116
slow_119:
buffer_store_dwordx4 v[2:5], v12, s[4:7], s66 offen sc1
buffer_store_dwordx4 v[6:9], v12, s[4:7], s66 offen offset:2048 sc1
s_mov_b32 exec_hi, 0
buffer_store_dwordx2 v[10:11], v223, s[4:7], s68 offen sc1
s_mov_b32 exec_hi, -1
s_branch back_120
slow_121:
buffer_store_dword v124, v13, s[4:7], s67 offen sc1
s_branch back_122
slow_124:
s_mov_b64 exec, 1
v_mov_b32 v124, s62
buffer_store_dword v124, off, s[4:7], s71 offset:384 sc1
s_mov_b64 exec, -1
s_branch back_125
slow_129:
buffer_store_dwordx4 v[148:151], v184, s[4:7], s67 offen sc1
buffer_store_dwordx4 v[152:155], v185, s[4:7], s67 offen sc1
buffer_store_dword v156, v31, s[4:7], s68 offen sc1
s_branch back_130
slow_131:
s_mov_b64 exec, 1
v_mov_b32 v164, s62
buffer_store_dword v164, off, s[4:7], s67 offset:0 sc1
s_mov_b64 exec, -1
s_branch back_132
po_134:
s_add_u32 s75, s75, 1
s_cmp_gt_u32 s75, 200000
s_cbranch_scc1 pk_135
buffer_load_dword v165, v176, s[4:7], s66 offen sc1
s_waitcnt vmcnt(0)
s_branch pr_133
go_137:
s_add_u32 s75, s75, 1
s_cmp_gt_u32 s75, 20000
s_cbranch_scc1 gk_138
s_waitcnt vmcnt(0)
s_mov_b64 exec, s[76:77]
buffer_load_dwordx4 v[128:131], v30, s[4:7], s66 offen offset:0 sc1
buffer_load_dwordx4 v[132:135], v30, s[4:7], s66 offen offset:640 sc1
buffer_load_dword v136, v31, s[4:7], s66 offen offset:1280 sc1
buffer_load_dwordx4 v[138:141], v30, s[4:7], s66 offen offset:2048 sc1
buffer_load_dwordx4 v[142:145], v30, s[4:7], s66 offen offset:2688 sc1
buffer_load_dword v146, v31, s[4:7], s66 offen offset:3328 sc1
buffer_load_dwordx4 v[148:151], v30, s[4:7], s67 offen offset:0 sc1
buffer_load_dwordx4 v[152:155], v30, s[4:7], s67 offen offset:640 sc1
buffer_load_dword v156, v31, s[4:7], s67 offen offset:1280 sc1
buffer_load_dwordx4 v[158:161], v30, s[4:7], s67 offen offset:2048 sc1
buffer_load_dwordx4 v[162:165], v30, s[4:7], s67 offen offset:2688 sc1
buffer_load_dword v166, v31, s[4:7], s67 offen offset:3328 sc1
buffer_load_dwordx4 v[168:171], v30, s[4:7], s68 offen offset:0 sc1
buffer_load_dwordx4 v[172:175], v30, s[4:7], s68 offen offset:640 sc1
buffer_load_dword v176, v31, s[4:7], s68 offen offset:1280 sc1
buffer_load_dwordx4 v[96:99], v30, s[4:7], s68 offen offset:2048 sc1
buffer_load_dwordx4 v[100:103], v30, s[4:7], s68 offen offset:2688 sc1
buffer_load_dword v104, v31, s[4:7], s68 offen offset:3328 sc1
buffer_load_dwordx4 v[106:109], v30, s[4:7], s92 offen offset:0 sc1
buffer_load_dwordx4 v[110:113], v30, s[4:7], s92 offen offset:640 sc1
buffer_load_dword v114, v31, s[4:7], s92 offen offset:1280 sc1
buffer_load_dwordx4 v[116:119], v30, s[4:7], s92 offen offset:2048 sc1
buffer_load_dwordx4 v[120:123], v30, s[4:7], s92 offen offset:2688 sc1
buffer_load_dword v124, v31, s[4:7], s92 offen offset:3328 sc1
s_mov_b64 exec, -1
s_branch gr_136
go_140:
s_add_u32 s75, s75, 1
s_cmp_gt_u32 s75, 20000
s_cbranch_scc1 gk_141
s_waitcnt vmcnt(0)
s_mov_b64 exec, s[76:77]
buffer_load_dwordx4 v[138:141], v30, s[4:7], s66 offen offset:2048 sc1
buffer_load_dwordx4 v[142:145], v30, s[4:7], s66 offen offset:2688 sc1
buffer_load_dword v146, v31, s[4:7], s66 offen offset:3328 sc1
buffer_load_dwordx4 v[148:151], v30, s[4:7], s67 offen offset:0 sc1
buffer_load_dwordx4 v[152:155], v30, s[4:7], s67 offen offset:640 sc1
buffer_load_dword v156, v31, s[4:7], s67 offen offset:1280 sc1
buffer_load_dwordx4 v[158:161], v30, s[4:7], s67 offen offset:2048 sc1
buffer_load_dwordx4 v[162:165], v30, s[4:7], s67 offen offset:2688 sc1
buffer_load_dword v166, v31, s[4:7], s67 offen offset:3328 sc1
buffer_load_dwordx4 v[168:171], v30, s[4:7], s68 offen offset:0 sc1
buffer_load_dwordx4 v[172:175], v30, s[4:7], s68 offen offset:640 sc1
buffer_load_dword v176, v31, s[4:7], s68 offen offset:1280 sc1
buffer_load_dwordx4 v[96:99], v30, s[4:7], s68 offen offset:2048 sc1
buffer_load_dwordx4 v[100:103], v30, s[4:7], s68 offen offset:2688 sc1
buffer_load_dword v104, v31, s[4:7], s68 offen offset:3328 sc1
buffer_load_dwordx4 v[106:109], v30, s[4:7], s92 offen offset:0 sc1
buffer_load_dwordx4 v[110:113], v30, s[4:7], s92 offen offset:640 sc1
buffer_load_dword v114, v31, s[4:7], s92 offen offset:1280 sc1
buffer_load_dwordx4 v[116:119], v30, s[4:7], s92 offen offset:2048 sc1
buffer_load_dwordx4 v[120:123], v30, s[4:7], s92 offen offset:2688 sc1
buffer_load_dword v124, v31, s[4:7], s92 offen offset:3328 sc1
s_mov_b64 exec, -1
s_branch gr_139
go_143:
s_add_u32 s75, s75, 1
s_cmp_gt_u32 s75, 20000
s_cbranch_scc1 gk_144
s_waitcnt vmcnt(0)
s_mov_b64 exec, s[76:77]
buffer_load_dwordx4 v[148:151], v30, s[4:7], s67 offen offset:0 sc1
buffer_load_dwordx4 v[152:155], v30, s[4:7], s67 offen offset:640 sc1
buffer_load_dword v156, v31, s[4:7], s67 offen offset:1280 sc1
buffer_load_dwordx4 v[158:161], v30, s[4:7], s67 offen offset:2048 sc1
buffer_load_dwordx4 v[162:165], v30, s[4:7], s67 offen offset:2688 sc1
buffer_load_dword v166, v31, s[4:7], s67 offen offset:3328 sc1
buffer_load_dwordx4 v[168:171], v30, s[4:7], s68 offen offset:0 sc1
buffer_load_dwordx4 v[172:175], v30, s[4:7], s68 offen offset:640 sc1
buffer_load_dword v176, v31, s[4:7], s68 offen offset:1280 sc1
buffer_load_dwordx4 v[96:99], v30, s[4:7], s68 offen offset:2048 sc1
buffer_load_dwordx4 v[100:103], v30, s[4:7], s68 offen offset:2688 sc1
buffer_load_dword v104, v31, s[4:7], s68 offen offset:3328 sc1
buffer_load_dwordx4 v[106:109], v30, s[4:7], s92 offen offset:0 sc1
buffer_load_dwordx4 v[110:113], v30, s[4:7], s92 offen offset:640 sc1
buffer_load_dword v114, v31, s[4:7], s92 offen offset:1280 sc1
buffer_load_dwordx4 v[116:119], v30, s[4:7], s92 offen offset:2048 sc1
buffer_load_dwordx4 v[120:123], v30, s[4:7], s92 offen offset:2688 sc1
buffer_load_dword v124, v31, s[4:7], s92 offen offset:3328 sc1
s_mov_b64 exec, -1
s_branch gr_142
go_146:
s_add_u32 s75, s75, 1
s_cmp_gt_u32 s75, 20000
s_cbranch_scc1 gk_147
s_waitcnt vmcnt(0)
s_mov_b64 exec, s[76:77]
buffer_load_dwordx4 v[158:161], v30, s[4:7], s67 offen offset:2048 sc1
buffer_load_dwordx4 v[162:165], v30, s[4:7], s67 offen offset:2688 sc1
buffer_load_dword v166, v31, s[4:7], s67 offen offset:3328 sc1
buffer_load_dwordx4 v[168:171], v30, s[4:7], s68 offen offset:0 sc1
buffer_load_dwordx4 v[172:175], v30, s[4:7], s68 offen offset:640 sc1
buffer_load_dword v176, v31, s[4:7], s68 offen offset:1280 sc1
buffer_load_dwordx4 v[96:99], v30, s[4:7], s68 offen offset:2048 sc1
buffer_load_dwordx4 v[100:103], v30, s[4:7], s68 offen offset:2688 sc1
buffer_load_dword v104, v31, s[4:7], s68 offen offset:3328 sc1
buffer_load_dwordx4 v[106:109], v30, s[4:7], s92 offen offset:0 sc1
buffer_load_dwordx4 v[110:113], v30, s[4:7], s92 offen offset:640 sc1
buffer_load_dword v114, v31, s[4:7], s92 offen offset:1280 sc1
buffer_load_dwordx4 v[116:119], v30, s[4:7], s92 offen offset:2048 sc1
buffer_load_dwordx4 v[120:123], v30, s[4:7], s92 offen offset:2688 sc1
buffer_load_dword v124, v31, s[4:7], s92 offen offset:3328 sc1
s_mov_b64 exec, -1
s_branch gr_145
go_149:
s_add_u32 s75, s75, 1
s_cmp_gt_u32 s75, 20000
s_cbranch_scc1 gk_150
s_waitcnt vmcnt(0)
s_mov_b64 exec, s[76:77]
buffer_load_dwordx4 v[168:171], v30, s[4:7], s68 offen offset:0 sc1
buffer_load_dwordx4 v[172:175], v30, s[4:7], s68 offen offset:640 sc1
buffer_load_dword v176, v31, s[4:7], s68 offen offset:1280 sc1
buffer_load_dwordx4 v[96:99], v30, s[4:7], s68 offen offset:2048 sc1
buffer_load_dwordx4 v[100:103], v30, s[4:7], s68 offen offset:2688 sc1
buffer_load_dword v104, v31, s[4:7], s68 offen offset:3328 sc1
buffer_load_dwordx4 v[106:109], v30, s[4:7], s92 offen offset:0 sc1
buffer_load_dwordx4 v[110:113], v30, s[4:7], s92 offen offset:640 sc1
buffer_load_dword v114, v31, s[4:7], s92 offen offset:1280 sc1
buffer_load_dwordx4 v[116:119], v30, s[4:7], s92 offen offset:2048 sc1
buffer_load_dwordx4 v[120:123], v30, s[4:7], s92 offen offset:2688 sc1
buffer_load_dword v124, v31, s[4:7], s92 offen offset:3328 sc1
s_mov_b64 exec, -1
s_waitcnt vmcnt(0)
s_branch gr_148
go_152:
s_add_u32 s75, s75, 1
s_cmp_gt_u32 s75, 20000
s_cbranch_scc1 gk_153
s_waitcnt vmcnt(0)
s_mov_b64 exec, s[76:77]
buffer_load_dwordx4 v[96:99], v30, s[4:7], s68 offen offset:2048 sc1
buffer_load_dwordx4 v[100:103], v30, s[4:7], s68 offen offset:2688 sc1
buffer_load_dword v104, v31, s[4:7], s68 offen offset:3328 sc1
buffer_load_dwordx4 v[106:109], v30, s[4:7], s92 offen offset:0 sc1
buffer_load_dwordx4 v[110:113], v30, s[4:7], s92 offen offset:640 sc1
buffer_load_dword v114, v31, s[4:7], s92 offen offset:1280 sc1
buffer_load_dwordx4 v[116:119], v30, s[4:7], s92 offen offset:2048 sc1
buffer_load_dwordx4 v[120:123], v30, s[4:7], s92 offen offset:2688 sc1
buffer_load_dword v124, v31, s[4:7], s92 offen offset:3328 sc1
s_mov_b64 exec, -1
s_waitcnt vmcnt(0)
s_branch gr_151
go_155:
s_add_u32 s75, s75, 1
s_cmp_gt_u32 s75, 20000
s_cbranch_scc1 gk_156
s_waitcnt vmcnt(0)
s_mov_b64 exec, s[76:77]
buffer_load_dwordx4 v[106:109], v30, s[4:7], s92 offen offset:0 sc1
buffer_load_dwordx4 v[110:113], v30, s[4:7], s92 offen offset:640 sc1
buffer_load_dword v114, v31, s[4:7], s92 offen offset:1280 sc1
buffer_load_dwordx4 v[116:119], v30, s[4:7], s92 offen offset:2048 sc1
buffer_load_dwordx4 v[120:123], v30, s[4:7], s92 offen offset:2688 sc1
buffer_load_dword v124, v31, s[4:7], s92 offen offset:3328 sc1
s_mov_b64 exec, -1
s_waitcnt vmcnt(0)
s_branch gr_154
go_158:
s_add_u32 s75, s75, 1
s_cmp_gt_u32 s75, 20000
s_cbranch_scc1 gk_159
s_waitcnt vmcnt(0)
s_mov_b64 exec, s[76:77]
buffer_load_dwordx4 v[116:119], v30, s[4:7], s92 offen offset:2048 sc1
buffer_load_dwordx4 v[120:123], v30, s[4:7], s92 offen offset:2688 sc1
buffer_load_dword v124, v31, s[4:7], s92 offen offset:3328 sc1
s_mov_b64 exec, -1
s_waitcnt vmcnt(0)
s_branch gr_157
slow_160:
buffer_store_dwordx4 v[112:115], v188, s[4:7], s90 offen sc1
s_branch back_161
slow_162:
buffer_store_dwordx4 v[116:119], v188, s[4:7], s72 offen sc1
buffer_store_dword v120, v190, s[4:7], s90 offen offset:2048 sc1
s_branch back_163
slow_165:
s_mov_b64 exec, 1
v_mov_b32 v26, s62
buffer_store_dword v26, off, s[4:7], s71 offset:512 sc1
s_mov_b64 exec, -1
s_branch back_166
L_code_end:
.section .rodata,"a"
.p2align 6
.amdhsa_kernel interleave_layers__ssm_conv_h3__linear_kernel_hedgehog__prompt_kernel
  .amdhsa_next_free_vgpr 512
  .amdhsa_next_free_sgpr 102
  .amdhsa_accum_offset 256
  .amdhsa_group_segment_fixed_size 0
  .amdhsa_kernarg_size 104
  .amdhsa_user_sgpr_count 2
  .amdhsa_user_sgpr_kernarg_segment_ptr 1
  .amdhsa_system_sgpr_workgroup_id_x 1
.end_amdhsa_kernel
```
